```python
import torch

def _softmax(x, axis=-1):
    return torch.softmax(x, dim=axis)

def _gelu(x):
    return torch.nn.functional.gelu(x, approximate='tanh')

def _silu(x):
    return torch.nn.functional.silu(x)

def _sigmoid(x):
    return torch.sigmoid(x)

def _layernorm(x, axis=-1, eps=1e-05):
    m = x.mean(dim=axis, keepdim=True)
    v = x.var(dim=axis, keepdim=True, unbiased=False)
    return (x - m) / torch.sqrt(v + eps)

def _scatter_add(tgt, idx, src, axis=0):
    return tgt.clone().index_add_(axis, idx, src)

def _segment_sum(src, seg, n):
    out = torch.zeros((n,) + src.shape[1:], dtype=src.dtype)
    return out.index_add_(0, seg, src)

def _pad(x, pw):
    flat = tuple((v for pair in reversed(pw) for v in pair))
    return torch.nn.functional.pad(x, flat)
kernel_name = 'sequential_preLN__memory_aug_recurrent_mem_tr__glu_gated_geglu__prompt'

def setup_inputs():

    _w = lambda a: (lambda t: t.to(torch.bfloat16) if t.is_floating_point() else t)(torch.as_tensor(a))

    def _A_setup():
        B, S, Dm = (1, 2048, 512)
        H, Dh = (32, 128)
        M, seg = (8, 32)
        seg = min(seg, S)
        S = S // seg * seg
        return {'x': _w((lambda *s: torch.randn(*s, dtype=torch.bfloat16) * 0.05)(B, S, Dm)), 'mem0': _w((lambda *s: torch.randn(*s, dtype=torch.bfloat16) * 0.2)(B, M, Dm)), 'Wq': _w((lambda *s: torch.randn(*s, dtype=torch.bfloat16) * 1.6)(Dm, H, Dh) * Dm ** (-0.5)), 'Wk': _w((lambda *s: torch.randn(*s, dtype=torch.bfloat16) * 1.6)(Dm, H, Dh) * Dm ** (-0.5)), 'Wv': _w((lambda *s: torch.randn(*s, dtype=torch.bfloat16) * 0.2)(Dm, H, Dh) * Dm ** (-0.5)), 'Wo': _w((lambda *s: torch.randn(*s, dtype=torch.bfloat16) * 0.2)(H, Dh, Dm) * (H * Dh) ** (-0.5)), 'seg_len': seg}
    _A_in = _A_setup()

    def _B_setup():
        B, S, Dm, Df = (1, 2048, 512, 1376)
        return {'x': _w((lambda *s: torch.randn(*s, dtype=torch.bfloat16) * 0.05)(B, S, Dm)), 'w_gate': _w((lambda *s: torch.randn(*s, dtype=torch.bfloat16) * 0.4)(Dm, Df) * Dm ** (-0.5)), 'w_up': _w((lambda *s: torch.randn(*s, dtype=torch.bfloat16) * 0.4)(Dm, Df) * Dm ** (-0.5)), 'w_down': _w((lambda *s: torch.randn(*s, dtype=torch.bfloat16) * 0.4)(Df, Dm) * Df ** (-0.5))}
    _B_in = _B_setup()
    return {'A_x': _A_in['x'], 'A_mem0': _A_in['mem0'], 'A_Wq': _A_in['Wq'], 'A_Wk': _A_in['Wk'], 'A_Wv': _A_in['Wv'], 'A_Wo': _A_in['Wo'], 'A_seg_len': _A_in['seg_len'], 'B_x': _B_in['x'], 'B_w_gate': _B_in['w_gate'], 'B_w_up': _B_in['w_up'], 'B_w_down': _B_in['w_down']}

def reference(A_x, A_mem0, A_Wq, A_Wk, A_Wv, A_Wo, A_seg_len, B_x, B_w_gate, B_w_up, B_w_down):

    def _A_ref(x, mem0, Wq, Wk, Wv, Wo, seg_len):
        B, S, Dm = x.shape
        H, Dh = (Wq.shape[1], Wq.shape[2])
        M = mem0.shape[1]
        scale = Dh ** (-0.5)
        n_seg = S // seg_len
        L = M + seg_len
        idx = torch.arange(L)
        mask = (idx[:, None] < M) | (idx[:, None] >= idx[None, :])
        mem = mem0
        outs = []
        for s in range(n_seg):
            xs = x[:, s * seg_len:(s + 1) * seg_len, :].clone()
            h = torch.concatenate([mem, xs], axis=1)
            q = torch.einsum('btd,dhe->bhte', h, Wq)
            k = torch.einsum('btd,dhe->bhte', h, Wk)
            v = torch.einsum('btd,dhe->bhte', h, Wv)
            scores = torch.einsum('bhqe,bhke->bhqk', q, k) * scale
            scores = torch.where(mask[None, None], scores, -1000000000.0)
            p = _softmax(scores, axis=-1)
            o = torch.einsum('bhqk,bhke->bhqe', p, v)
            o = torch.einsum('bhte,hed->btd', o, Wo)
            mem = o[:, :M, :].clone()
            outs.append(o[:, M:, :])
        return torch.concatenate(outs, axis=1)

    def _B_ref(x, w_gate, w_up, w_down):
        g = torch.einsum('bsd,df->bsf', x, w_gate)
        u = torch.einsum('bsd,df->bsf', x, w_up)
        h = _gelu(g) * u
        return torch.einsum('bsf,fd->bsd', h, w_down)
    x = A_x
    h = x + _A_ref(_layernorm(x, axis=-1), A_mem0, A_Wq, A_Wk, A_Wv, A_Wo, A_seg_len)
    h2 = h + _B_ref(_layernorm(h, axis=-1), B_w_gate, B_w_up, B_w_down)
    return h2
```

```asm
; @launch grid=(256,1,1) block=(256,1,1) lds=163840
.amdgcn_target "amdgcn-amd-amdhsa--gfx950"
.text
.globl sequential_preLN__memory_aug_recurrent_mem_tr__glu_gated_geglu__prompt_kernel
.p2align 8
.type sequential_preLN__memory_aug_recurrent_mem_tr__glu_gated_geglu__prompt_kernel,@function
sequential_preLN__memory_aug_recurrent_mem_tr__glu_gated_geglu__prompt_kernel:

  s_cmp_ge_u32 s2, 256
  s_cbranch_scc1 L_rec_end
  s_load_dwordx2 s[20:21], s[0:1], 8
  s_load_dwordx2 s[22:23], s[0:1], 16
  s_load_dwordx2 s[24:25], s[0:1], 24
  s_load_dwordx2 s[26:27], s[0:1], 32
  s_load_dwordx2 s[28:29], s[0:1], 40
  s_load_dwordx2 s[30:31], s[0:1], 96
  s_load_dwordx2 s[32:33], s[0:1], 104
  s_load_dwordx2 s[78:79], s[0:1], 0
  s_load_dwordx2 s[80:81], s[0:1], 16
  s_load_dwordx2 s[82:83], s[0:1], 24
  s_load_dwordx2 s[84:85], s[0:1], 32
  s_load_dwordx2 s[86:87], s[0:1], 40
  s_load_dwordx2 s[88:89], s[0:1], 64
  s_load_dwordx2 s[90:91], s[0:1], 72
  s_load_dwordx2 s[92:93], s[0:1], 80
  s_load_dwordx2 s[94:95], s[0:1], 88
  s_load_dwordx2 s[96:97], s[0:1], 96
  v_and_b32 v1, 63, v0
  v_readfirstlane_b32 s18, v0
  s_lshr_b32 s18, s18, 6
  s_waitcnt lgkmcnt(0)
  s_mov_b32 s4, s32
  s_mov_b32 s5, s33
  s_mov_b32 s6, 268435456
  s_mov_b32 s7, 0x00020000
  s_mov_b32 s8, s30
  s_mov_b32 s9, s31
  s_mov_b32 s10, 256
  s_mov_b32 s11, 0x00020000

  s_cmp_lg_u32 s18, 0
  s_cbranch_scc1 L_rec_rolewait
  s_getreg_b32 s63, hwreg(HW_REG_XCC_ID)
  s_and_b32 s63, s63, 7
  s_mov_b64 exec, 1
  s_and_b32 s34, s63, 3
  s_lshl_b32 s34, s34, 2
  s_lshr_b32 s35, s63, 2
  s_lshl_b32 s35, s35, 7
  s_add_u32 s34, s34, s35
  v_mov_b32 v2, 1
  v_mov_b32 v4, s34
  buffer_atomic_add v2, v4, s[8:11], 0 offen sc0 sc1
  s_memrealtime s[36:37]
  s_waitcnt vmcnt(0) lgkmcnt(0)
  s_and_b32 s36, s36, 0xfffffff0
  v_readfirstlane_b32 s64, v2
  v_mov_b32 v5, 36
  s_cmp_eq_u32 s64, 31
  s_cbranch_scc0 L_rec_nodecide
  s_add_u32 s34, s63, 1
  s_or_b32 s34, s34, s36
  v_mov_b32 v6, s34
  v_mov_b32 v7, 0
  buffer_atomic_cmpswap v[6:7], v5, s[8:11], 0 offen sc0 sc1
  s_waitcnt vmcnt(0)

L_rec_nodecide:
  s_mov_b32 s62, 0
L_rec_pollrole:
  buffer_load_dword v6, v5, s[8:11], 0 offen sc1
  s_waitcnt vmcnt(0)
  v_readfirstlane_b32 s69, v6
  s_cmp_lg_u32 s69, 0
  s_cbranch_scc1 L_rec_decided
  s_add_u32 s62, s62, 1
  s_cmp_lt_u32 s62, 400
  s_cbranch_scc1 L_rec_pollrole
  s_or_b32 s34, s36, 15
  v_mov_b32 v6, s34
  v_mov_b32 v7, 0
  buffer_atomic_cmpswap v[6:7], v5, s[8:11], 0 offen sc0 sc1
  s_waitcnt vmcnt(0)
  s_mov_b32 s62, 0
  s_branch L_rec_pollrole

L_rec_decided:
  s_and_b32 s66, s69, 15
  s_mov_b32 s16, -1
  s_mov_b32 s17, 0
  s_add_u32 s34, s63, 1
  s_cmp_eq_u32 s66, s34
  s_cbranch_scc0 L_rec_notfast
  s_cmp_lt_u32 s64, 32
  s_cbranch_scc0 L_rec_rolewr
  s_mov_b32 s16, s64
  s_branch L_rec_rolewr

L_rec_notfast:
  s_cmp_eq_u32 s66, 15
  s_cbranch_scc0 L_rec_rolewr
  v_mov_b32 v3, 1
  v_mov_b32 v5, 160
  buffer_atomic_add v3, v5, s[8:11], 0 offen sc0 sc1
  s_waitcnt vmcnt(0)
  v_readfirstlane_b32 s65, v3
  s_cmp_lt_u32 s65, 32
  s_cbranch_scc0 L_rec_rolewr
  s_mov_b32 s16, s65
  s_mov_b32 s17, 1

L_rec_rolewr:
  v_mov_b32 v2, s16
  v_mov_b32 v3, s17
  v_mov_b32 v4, 160912
  ds_write_b64 v4, v[2:3]
  v_mov_b32 v2, s69
  ds_write_b32 v4, v2 offset:8
  s_waitcnt lgkmcnt(0)
  s_mov_b64 exec, -1

L_rec_rolewait:
  s_barrier
  v_mov_b32 v4, 160912
  ds_read_b64 v[2:3], v4
  ds_read_b32 v5, v4 offset:8
  s_waitcnt lgkmcnt(0)
  v_readfirstlane_b32 s16, v2
  v_readfirstlane_b32 s17, v3
  v_readfirstlane_b32 s69, v5
  s_barrier

  s_cmp_lt_i32 s16, 0
  s_cbranch_scc1 L_worker

  v_lshlrev_b32 v120, 4, v1
  s_lshl_b32 s34, s16, 14
  s_lshl_b32 s35, s18, 12
  s_add_u32 s34, s34, s35
  s_add_u32 s34, s34, 94371840
  v_add_u32 v120, s34, v120
  v_mov_b32 v124, -1
  v_mov_b32 v125, -1
  v_mov_b32 v126, -1
  v_mov_b32 v127, -1

  buffer_store_dwordx4 v[124:127], v120, s[4:7], 0 offen offset:0 sc1
  buffer_store_dwordx4 v[124:127], v120, s[4:7], 0 offen offset:1024 sc1
  buffer_store_dwordx4 v[124:127], v120, s[4:7], 0 offen offset:2048 sc1
  buffer_store_dwordx4 v[124:127], v120, s[4:7], 0 offen offset:3072 sc1
  v_lshlrev_b32 v121, 4, v1
  s_mul_i32 s34, s16, 768
  s_mul_i32 s35, s18, 192
  s_add_u32 s34, s34, s35
  s_add_u32 s34, s34, 96468992
  v_add_u32 v121, s34, v121
  s_mov_b64 exec, 0xfff
  buffer_store_dwordx4 v[124:127], v121, s[4:7], 0 offen sc1
  s_mov_b64 exec, -1
  s_waitcnt vmcnt(0)
  s_barrier
  s_cmp_lg_u32 s18, 0
  s_cbranch_scc1 L_gbs_2
  v_mov_b32 v120, 48
  v_mov_b32 v121, 1
  s_mov_b64 exec, 1
  buffer_atomic_add v121, v120, s[8:11], 0 offen sc1
  s_mov_b64 exec, -1

L_gbs_2:
  v_lshrrev_b32 v30, 4, v1
  v_and_b32 v31, 15, v1
  s_lshl_b32 s34, s18, 7
  v_add_u32 v32, s34, v30
  v_lshlrev_b32 v33, 13, v32
  s_lshl_b32 s35, s16, 8
  v_lshl_add_u32 v33, v31, 4, v33
  v_add_u32 v33, s35, v33
  v_mul_u32_u24 v34, 272, v32
  v_lshl_add_u32 v34, v31, 4, v34
  v_lshrrev_b32 v35, 1, v30
  v_lshlrev_b32 v35, 4, v35
  v_and_b32 v36, 1, v30
  v_lshl_add_u32 v35, v36, 2, v35
  v_lshrrev_b32 v36, 2, v1
  v_and_b32 v36, 1, v36
  v_add_u32 v35, v35, v36
  v_lshrrev_b32 v36, 3, v1
  v_and_b32 v36, 1, v36
  v_lshl_add_u32 v35, v36, 3, v35
  v_mul_u32_u24 v35, 272, v35
  v_and_b32 v36, 3, v1
  s_lshl_b32 s34, s18, 6
  v_add_u32 v35, s34, v35
  v_lshl_add_u32 v37, v36, 3, v35
  v_add_u32 v38, 69632, v37
  v_add_u32 v39, 131072, v37

  s_lshl_b32 s34, s16, 17
  s_lshl_b32 s35, s18, 15
  s_add_u32 s34, s34, s35
  v_lshlrev_b32 v28, 4, v1
  v_add_u32 v28, s34, v28
  s_mul_i32 s35, s18, 33792
  v_lshlrev_b32 v29, 4, v1
  v_add_u32 v29, s35, v29
  v_lshrrev_b32 v26, 2, v1
  v_and_b32 v26, 3, v26
  v_lshl_add_u32 v26, v30, 2, v26
  v_mul_u32_u24 v26, 1056, v26
  v_lshl_add_u32 v26, v36, 3, v26
  s_lshl_b32 s34, s18, 8
  v_add_u32 v26, s34, v26
  v_add_u32 v27, 67584, v26
  s_lshl_b32 s34, s18, 4
  v_add_u32 v24, s34, v30
  v_lshlrev_b32 v25, 13, v24
  s_lshl_b32 s35, s16, 8
  v_lshl_add_u32 v25, v31, 4, v25
  v_add_u32 v25, s35, v25
  v_mul_u32_u24 v24, 272, v24
  v_lshl_add_u32 v24, v31, 4, v24
  v_add_u32 v24, 131072, v24
  v_lshlrev_b32 v12, 4, v1
  s_lshl_b32 s34, s18, 15
  v_add_u32 v12, s34, v12

  s_mov_b32 s12, s22
  s_mov_b32 s13, s23
  s_mov_b32 s14, 0x400000
  s_mov_b32 s15, 0x00020000
  s_mov_b32 s34, 0
  buffer_load_dwordx4 v[128:131], v33, s[12:15], s34 offen
  s_mov_b32 s34, 32768
  buffer_load_dwordx4 v[132:135], v33, s[12:15], s34 offen
  s_mov_b32 s34, 65536
  buffer_load_dwordx4 v[136:139], v33, s[12:15], s34 offen
  s_mov_b32 s34, 98304
  buffer_load_dwordx4 v[140:143], v33, s[12:15], s34 offen
  s_mov_b32 s34, 131072
  buffer_load_dwordx4 v[144:147], v33, s[12:15], s34 offen
  s_mov_b32 s34, 163840
  buffer_load_dwordx4 v[148:151], v33, s[12:15], s34 offen
  s_mov_b32 s34, 196608
  buffer_load_dwordx4 v[152:155], v33, s[12:15], s34 offen
  s_mov_b32 s34, 229376
  buffer_load_dwordx4 v[156:159], v33, s[12:15], s34 offen
  s_mov_b32 s34, 262144
  buffer_load_dwordx4 v[160:163], v33, s[12:15], s34 offen
  s_mov_b32 s34, 294912
  buffer_load_dwordx4 v[164:167], v33, s[12:15], s34 offen
  s_mov_b32 s34, 327680
  buffer_load_dwordx4 v[168:171], v33, s[12:15], s34 offen
  s_mov_b32 s34, 360448
  buffer_load_dwordx4 v[172:175], v33, s[12:15], s34 offen
  s_mov_b32 s34, 393216
  buffer_load_dwordx4 v[176:179], v33, s[12:15], s34 offen
  s_mov_b32 s34, 425984
  buffer_load_dwordx4 v[180:183], v33, s[12:15], s34 offen
  s_mov_b32 s34, 458752
  buffer_load_dwordx4 v[184:187], v33, s[12:15], s34 offen
  s_mov_b32 s34, 491520
  buffer_load_dwordx4 v[188:191], v33, s[12:15], s34 offen
  s_mov_b32 s34, 524288
  buffer_load_dwordx4 v[192:195], v33, s[12:15], s34 offen
  s_mov_b32 s34, 557056
  buffer_load_dwordx4 v[196:199], v33, s[12:15], s34 offen
  s_mov_b32 s34, 589824
  buffer_load_dwordx4 v[200:203], v33, s[12:15], s34 offen
  s_mov_b32 s34, 622592
  buffer_load_dwordx4 v[204:207], v33, s[12:15], s34 offen
  s_mov_b32 s34, 655360
  buffer_load_dwordx4 v[208:211], v33, s[12:15], s34 offen
  s_mov_b32 s34, 688128
  buffer_load_dwordx4 v[212:215], v33, s[12:15], s34 offen
  s_mov_b32 s34, 720896
  buffer_load_dwordx4 v[216:219], v33, s[12:15], s34 offen
  s_mov_b32 s34, 753664
  buffer_load_dwordx4 v[220:223], v33, s[12:15], s34 offen
  s_mov_b32 s34, 786432
  buffer_load_dwordx4 v[224:227], v33, s[12:15], s34 offen
  s_mov_b32 s34, 819200
  buffer_load_dwordx4 v[228:231], v33, s[12:15], s34 offen
  s_mov_b32 s34, 851968
  buffer_load_dwordx4 v[232:235], v33, s[12:15], s34 offen
  s_mov_b32 s34, 884736
  buffer_load_dwordx4 v[236:239], v33, s[12:15], s34 offen
  s_mov_b32 s34, 917504
  buffer_load_dwordx4 v[240:243], v33, s[12:15], s34 offen
  s_mov_b32 s34, 950272
  buffer_load_dwordx4 v[244:247], v33, s[12:15], s34 offen
  s_mov_b32 s34, 983040
  buffer_load_dwordx4 v[248:251], v33, s[12:15], s34 offen
  s_mov_b32 s34, 1015808
  buffer_load_dwordx4 v[252:255], v33, s[12:15], s34 offen
  s_mov_b32 s12, s24
  s_mov_b32 s13, s25
  s_mov_b32 s14, 0x400000
  s_mov_b32 s15, 0x00020000
  s_mov_b32 s34, 0
  buffer_load_dwordx4 a[128:131], v33, s[12:15], s34 offen
  s_mov_b32 s34, 32768
  buffer_load_dwordx4 a[132:135], v33, s[12:15], s34 offen
  s_mov_b32 s34, 65536
  buffer_load_dwordx4 a[136:139], v33, s[12:15], s34 offen
  s_mov_b32 s34, 98304
  buffer_load_dwordx4 a[140:143], v33, s[12:15], s34 offen
  s_mov_b32 s34, 131072
  buffer_load_dwordx4 a[144:147], v33, s[12:15], s34 offen
  s_mov_b32 s34, 163840
  buffer_load_dwordx4 a[148:151], v33, s[12:15], s34 offen
  s_mov_b32 s34, 196608
  buffer_load_dwordx4 a[152:155], v33, s[12:15], s34 offen
  s_mov_b32 s34, 229376
  buffer_load_dwordx4 a[156:159], v33, s[12:15], s34 offen
  s_mov_b32 s34, 262144
  buffer_load_dwordx4 a[160:163], v33, s[12:15], s34 offen
  s_mov_b32 s34, 294912
  buffer_load_dwordx4 a[164:167], v33, s[12:15], s34 offen
  s_mov_b32 s34, 327680
  buffer_load_dwordx4 a[168:171], v33, s[12:15], s34 offen
  s_mov_b32 s34, 360448
  buffer_load_dwordx4 a[172:175], v33, s[12:15], s34 offen
  s_mov_b32 s34, 393216
  buffer_load_dwordx4 a[176:179], v33, s[12:15], s34 offen
  s_mov_b32 s34, 425984
  buffer_load_dwordx4 a[180:183], v33, s[12:15], s34 offen
  s_mov_b32 s34, 458752
  buffer_load_dwordx4 a[184:187], v33, s[12:15], s34 offen
  s_mov_b32 s34, 491520
  buffer_load_dwordx4 a[188:191], v33, s[12:15], s34 offen
  s_mov_b32 s34, 524288
  buffer_load_dwordx4 a[192:195], v33, s[12:15], s34 offen
  s_mov_b32 s34, 557056
  buffer_load_dwordx4 a[196:199], v33, s[12:15], s34 offen
  s_mov_b32 s34, 589824
  buffer_load_dwordx4 a[200:203], v33, s[12:15], s34 offen
  s_mov_b32 s34, 622592
  buffer_load_dwordx4 a[204:207], v33, s[12:15], s34 offen
  s_mov_b32 s34, 655360
  buffer_load_dwordx4 a[208:211], v33, s[12:15], s34 offen
  s_mov_b32 s34, 688128
  buffer_load_dwordx4 a[212:215], v33, s[12:15], s34 offen
  s_mov_b32 s34, 720896
  buffer_load_dwordx4 a[216:219], v33, s[12:15], s34 offen
  s_mov_b32 s34, 753664
  buffer_load_dwordx4 a[220:223], v33, s[12:15], s34 offen
  s_mov_b32 s34, 786432
  buffer_load_dwordx4 a[224:227], v33, s[12:15], s34 offen
  s_mov_b32 s34, 819200
  buffer_load_dwordx4 a[228:231], v33, s[12:15], s34 offen
  s_mov_b32 s34, 851968
  buffer_load_dwordx4 a[232:235], v33, s[12:15], s34 offen
  s_mov_b32 s34, 884736
  buffer_load_dwordx4 a[236:239], v33, s[12:15], s34 offen
  s_mov_b32 s34, 917504
  buffer_load_dwordx4 a[240:243], v33, s[12:15], s34 offen
  s_mov_b32 s34, 950272
  buffer_load_dwordx4 a[244:247], v33, s[12:15], s34 offen
  s_waitcnt vmcnt(61)
  ds_write_b128 v34, v[128:131] offset:0
  s_waitcnt vmcnt(60)
  ds_write_b128 v34, v[132:135] offset:1088
  s_waitcnt vmcnt(59)
  ds_write_b128 v34, v[136:139] offset:2176
  s_waitcnt vmcnt(58)
  ds_write_b128 v34, v[140:143] offset:3264
  s_waitcnt vmcnt(57)
  ds_write_b128 v34, v[144:147] offset:4352
  s_waitcnt vmcnt(56)
  ds_write_b128 v34, v[148:151] offset:5440
  s_waitcnt vmcnt(55)
  ds_write_b128 v34, v[152:155] offset:6528
  s_waitcnt vmcnt(54)
  ds_write_b128 v34, v[156:159] offset:7616
  s_waitcnt vmcnt(53)
  ds_write_b128 v34, v[160:163] offset:8704
  s_waitcnt vmcnt(52)
  ds_write_b128 v34, v[164:167] offset:9792
  s_waitcnt vmcnt(51)
  ds_write_b128 v34, v[168:171] offset:10880
  s_waitcnt vmcnt(50)
  ds_write_b128 v34, v[172:175] offset:11968
  s_waitcnt vmcnt(49)
  ds_write_b128 v34, v[176:179] offset:13056
  s_waitcnt vmcnt(48)
  ds_write_b128 v34, v[180:183] offset:14144
  s_waitcnt vmcnt(47)
  ds_write_b128 v34, v[184:187] offset:15232
  s_waitcnt vmcnt(46)
  ds_write_b128 v34, v[188:191] offset:16320
  s_waitcnt vmcnt(45)
  ds_write_b128 v34, v[192:195] offset:17408
  s_waitcnt vmcnt(44)
  ds_write_b128 v34, v[196:199] offset:18496
  s_waitcnt vmcnt(43)
  ds_write_b128 v34, v[200:203] offset:19584
  s_waitcnt vmcnt(42)
  ds_write_b128 v34, v[204:207] offset:20672
  s_waitcnt vmcnt(41)
  ds_write_b128 v34, v[208:211] offset:21760
  s_waitcnt vmcnt(40)
  ds_write_b128 v34, v[212:215] offset:22848
  s_waitcnt vmcnt(39)
  ds_write_b128 v34, v[216:219] offset:23936
  s_waitcnt vmcnt(38)
  ds_write_b128 v34, v[220:223] offset:25024
  s_waitcnt vmcnt(37)
  ds_write_b128 v34, v[224:227] offset:26112
  s_waitcnt vmcnt(36)
  ds_write_b128 v34, v[228:231] offset:27200
  s_waitcnt vmcnt(35)
  ds_write_b128 v34, v[232:235] offset:28288
  s_waitcnt vmcnt(34)
  ds_write_b128 v34, v[236:239] offset:29376
  s_waitcnt vmcnt(33)
  ds_write_b128 v34, v[240:243] offset:30464
  s_waitcnt vmcnt(32)
  ds_write_b128 v34, v[244:247] offset:31552
  s_waitcnt vmcnt(31)
  ds_write_b128 v34, v[248:251] offset:32640
  s_waitcnt vmcnt(30)
  ds_write_b128 v34, v[252:255] offset:33728
  s_mov_b32 s34, 983040
  buffer_load_dwordx4 a[248:251], v33, s[12:15], s34 offen
  s_mov_b32 s34, 1015808
  buffer_load_dwordx4 a[252:255], v33, s[12:15], s34 offen
  s_waitcnt lgkmcnt(0)
  s_barrier
  s_mov_b32 s12, s28
  s_mov_b32 s13, s29
  s_mov_b32 s14, 0x400000
  s_mov_b32 s15, 0x00020000
  s_mov_b32 s34, 0
  buffer_load_dwordx4 v[128:131], v28, s[12:15], s34 offen
  s_mov_b32 s34, 1024
  buffer_load_dwordx4 v[132:135], v28, s[12:15], s34 offen
  s_mov_b32 s34, 2048
  buffer_load_dwordx4 v[136:139], v28, s[12:15], s34 offen
  s_mov_b32 s34, 3072
  buffer_load_dwordx4 v[140:143], v28, s[12:15], s34 offen
  s_mov_b32 s34, 4096
  buffer_load_dwordx4 v[144:147], v28, s[12:15], s34 offen
  s_mov_b32 s34, 5120
  buffer_load_dwordx4 v[148:151], v28, s[12:15], s34 offen
  s_mov_b32 s34, 6144
  buffer_load_dwordx4 v[152:155], v28, s[12:15], s34 offen
  s_mov_b32 s34, 7168
  buffer_load_dwordx4 v[156:159], v28, s[12:15], s34 offen
  s_mov_b32 s34, 8192
  buffer_load_dwordx4 v[160:163], v28, s[12:15], s34 offen
  s_mov_b32 s34, 9216
  buffer_load_dwordx4 v[164:167], v28, s[12:15], s34 offen
  s_mov_b32 s34, 10240
  buffer_load_dwordx4 v[168:171], v28, s[12:15], s34 offen
  s_mov_b32 s34, 11264
  buffer_load_dwordx4 v[172:175], v28, s[12:15], s34 offen
  s_mov_b32 s34, 12288
  buffer_load_dwordx4 v[176:179], v28, s[12:15], s34 offen
  s_mov_b32 s34, 13312
  buffer_load_dwordx4 v[180:183], v28, s[12:15], s34 offen
  s_mov_b32 s34, 14336
  buffer_load_dwordx4 v[184:187], v28, s[12:15], s34 offen
  s_mov_b32 s34, 15360
  buffer_load_dwordx4 v[188:191], v28, s[12:15], s34 offen
  s_mov_b32 s34, 16384
  buffer_load_dwordx4 v[192:195], v28, s[12:15], s34 offen
  s_mov_b32 s34, 17408
  buffer_load_dwordx4 v[196:199], v28, s[12:15], s34 offen
  s_mov_b32 s34, 18432
  buffer_load_dwordx4 v[200:203], v28, s[12:15], s34 offen
  s_mov_b32 s34, 19456
  buffer_load_dwordx4 v[204:207], v28, s[12:15], s34 offen
  s_mov_b32 s34, 20480
  buffer_load_dwordx4 v[208:211], v28, s[12:15], s34 offen
  s_mov_b32 s34, 21504
  buffer_load_dwordx4 v[212:215], v28, s[12:15], s34 offen
  s_mov_b32 s34, 22528
  buffer_load_dwordx4 v[216:219], v28, s[12:15], s34 offen
  s_mov_b32 s34, 23552
  buffer_load_dwordx4 v[220:223], v28, s[12:15], s34 offen
  ds_read_b64_tr_b16 a[0:1], v37 offset:0
  ds_read_b64_tr_b16 a[2:3], v37 offset:544
  ds_read_b64_tr_b16 a[4:5], v37 offset:8704
  ds_read_b64_tr_b16 a[6:7], v37 offset:9248
  ds_read_b64_tr_b16 a[8:9], v37 offset:17408
  ds_read_b64_tr_b16 a[10:11], v37 offset:17952
  ds_read_b64_tr_b16 a[12:13], v37 offset:26112
  ds_read_b64_tr_b16 a[14:15], v37 offset:26656
  s_waitcnt lgkmcnt(0)
  ds_read_b64_tr_b16 a[16:17], v37 offset:34816
  ds_read_b64_tr_b16 a[18:19], v37 offset:35360
  ds_read_b64_tr_b16 a[20:21], v37 offset:43520
  ds_read_b64_tr_b16 a[22:23], v37 offset:44064
  ds_read_b64_tr_b16 a[24:25], v37 offset:52224
  ds_read_b64_tr_b16 a[26:27], v37 offset:52768
  ds_read_b64_tr_b16 a[28:29], v37 offset:60928
  ds_read_b64_tr_b16 a[30:31], v37 offset:61472
  s_waitcnt lgkmcnt(0)
  ds_read_b64_tr_b16 a[32:33], v38 offset:0
  ds_read_b64_tr_b16 a[34:35], v38 offset:544
  ds_read_b64_tr_b16 a[36:37], v38 offset:8704
  ds_read_b64_tr_b16 a[38:39], v38 offset:9248
  ds_read_b64_tr_b16 a[40:41], v38 offset:17408
  ds_read_b64_tr_b16 a[42:43], v38 offset:17952
  ds_read_b64_tr_b16 a[44:45], v38 offset:26112
  ds_read_b64_tr_b16 a[46:47], v38 offset:26656
  s_waitcnt lgkmcnt(0)
  ds_read_b64_tr_b16 a[48:49], v38 offset:34816
  ds_read_b64_tr_b16 a[50:51], v38 offset:35360
  ds_read_b64_tr_b16 a[52:53], v38 offset:43520
  ds_read_b64_tr_b16 a[54:55], v38 offset:44064
  ds_read_b64_tr_b16 a[56:57], v38 offset:52224
  ds_read_b64_tr_b16 a[58:59], v38 offset:52768
  ds_read_b64_tr_b16 a[60:61], v38 offset:60928
  ds_read_b64_tr_b16 a[62:63], v38 offset:61472
  s_waitcnt lgkmcnt(0)
  ds_read_b64_tr_b16 a[64:65], v37 offset:32
  ds_read_b64_tr_b16 a[66:67], v37 offset:576
  ds_read_b64_tr_b16 a[68:69], v37 offset:8736
  ds_read_b64_tr_b16 a[70:71], v37 offset:9280
  ds_read_b64_tr_b16 a[72:73], v37 offset:17440
  ds_read_b64_tr_b16 a[74:75], v37 offset:17984
  ds_read_b64_tr_b16 a[76:77], v37 offset:26144
  ds_read_b64_tr_b16 a[78:79], v37 offset:26688
  s_waitcnt lgkmcnt(0)
  ds_read_b64_tr_b16 a[80:81], v37 offset:34848
  ds_read_b64_tr_b16 a[82:83], v37 offset:35392
  ds_read_b64_tr_b16 a[84:85], v37 offset:43552
  ds_read_b64_tr_b16 a[86:87], v37 offset:44096
  ds_read_b64_tr_b16 a[88:89], v37 offset:52256
  ds_read_b64_tr_b16 a[90:91], v37 offset:52800
  ds_read_b64_tr_b16 a[92:93], v37 offset:60960
  ds_read_b64_tr_b16 a[94:95], v37 offset:61504
  s_waitcnt lgkmcnt(0)
  ds_read_b64_tr_b16 a[96:97], v38 offset:32
  ds_read_b64_tr_b16 a[98:99], v38 offset:576
  ds_read_b64_tr_b16 a[100:101], v38 offset:8736
  ds_read_b64_tr_b16 a[102:103], v38 offset:9280
  ds_read_b64_tr_b16 a[104:105], v38 offset:17440
  ds_read_b64_tr_b16 a[106:107], v38 offset:17984
  ds_read_b64_tr_b16 a[108:109], v38 offset:26144
  ds_read_b64_tr_b16 a[110:111], v38 offset:26688
  s_waitcnt lgkmcnt(0)
  ds_read_b64_tr_b16 a[112:113], v38 offset:34848
  ds_read_b64_tr_b16 a[114:115], v38 offset:35392
  ds_read_b64_tr_b16 a[116:117], v38 offset:43552
  ds_read_b64_tr_b16 a[118:119], v38 offset:44096
  ds_read_b64_tr_b16 a[120:121], v38 offset:52256
  ds_read_b64_tr_b16 a[122:123], v38 offset:52800
  ds_read_b64_tr_b16 a[124:125], v38 offset:60960
  ds_read_b64_tr_b16 a[126:127], v38 offset:61504
  s_waitcnt lgkmcnt(0)
  s_barrier
  s_waitcnt vmcnt(24)
  s_mov_b32 s34, 24576
  buffer_load_dwordx4 v[224:227], v28, s[12:15], s34 offen
  s_mov_b32 s34, 25600
  buffer_load_dwordx4 v[228:231], v28, s[12:15], s34 offen
  s_mov_b32 s34, 26624
  buffer_load_dwordx4 v[232:235], v28, s[12:15], s34 offen
  s_mov_b32 s34, 27648
  buffer_load_dwordx4 v[236:239], v28, s[12:15], s34 offen
  s_mov_b32 s34, 28672
  buffer_load_dwordx4 v[240:243], v28, s[12:15], s34 offen
  s_mov_b32 s34, 29696
  buffer_load_dwordx4 v[244:247], v28, s[12:15], s34 offen
  s_mov_b32 s34, 30720
  buffer_load_dwordx4 v[248:251], v28, s[12:15], s34 offen
  s_mov_b32 s34, 31744
  buffer_load_dwordx4 v[252:255], v28, s[12:15], s34 offen
  s_mov_b32 s12, s26
  s_mov_b32 s13, s27
  s_mov_b32 s14, 0x400000
  s_mov_b32 s15, 0x00020000
  s_mov_b32 s34, 0
  buffer_load_dwordx4 v[40:43], v25, s[12:15], s34 offen
  s_mov_b32 s34, 32768
  buffer_load_dwordx4 v[44:47], v25, s[12:15], s34 offen
  s_mov_b32 s34, 65536
  buffer_load_dwordx4 v[48:51], v25, s[12:15], s34 offen
  s_mov_b32 s34, 98304
  buffer_load_dwordx4 v[52:55], v25, s[12:15], s34 offen
  s_mov_b32 s34, 524288
  buffer_load_dwordx4 v[56:59], v25, s[12:15], s34 offen
  s_mov_b32 s34, 557056
  buffer_load_dwordx4 v[60:63], v25, s[12:15], s34 offen
  s_mov_b32 s34, 589824
  buffer_load_dwordx4 v[64:67], v25, s[12:15], s34 offen
  s_mov_b32 s34, 622592
  buffer_load_dwordx4 v[68:71], v25, s[12:15], s34 offen
  s_mov_b32 s34, 1048576
  buffer_load_dwordx4 v[72:75], v25, s[12:15], s34 offen
  s_mov_b32 s34, 1081344
  buffer_load_dwordx4 v[76:79], v25, s[12:15], s34 offen
  s_mov_b32 s34, 1114112
  buffer_load_dwordx4 v[80:83], v25, s[12:15], s34 offen
  s_mov_b32 s34, 1146880
  buffer_load_dwordx4 v[84:87], v25, s[12:15], s34 offen
  s_mov_b32 s34, 1572864
  buffer_load_dwordx4 v[88:91], v25, s[12:15], s34 offen
  s_mov_b32 s34, 1605632
  buffer_load_dwordx4 v[92:95], v25, s[12:15], s34 offen
  s_mov_b32 s34, 1638400
  buffer_load_dwordx4 v[96:99], v25, s[12:15], s34 offen
  s_mov_b32 s34, 1671168
  buffer_load_dwordx4 v[100:103], v25, s[12:15], s34 offen
  ds_write_b128 v34, a[128:131] offset:0
  ds_write_b128 v34, a[132:135] offset:1088
  ds_write_b128 v34, a[136:139] offset:2176
  ds_write_b128 v34, a[140:143] offset:3264
  ds_write_b128 v34, a[144:147] offset:4352
  ds_write_b128 v34, a[148:151] offset:5440
  ds_write_b128 v34, a[152:155] offset:6528
  ds_write_b128 v34, a[156:159] offset:7616
  ds_write_b128 v34, a[160:163] offset:8704
  ds_write_b128 v34, a[164:167] offset:9792
  ds_write_b128 v34, a[168:171] offset:10880
  ds_write_b128 v34, a[172:175] offset:11968
  ds_write_b128 v34, a[176:179] offset:13056
  ds_write_b128 v34, a[180:183] offset:14144
  ds_write_b128 v34, a[184:187] offset:15232
  ds_write_b128 v34, a[188:191] offset:16320
  ds_write_b128 v34, a[192:195] offset:17408
  ds_write_b128 v34, a[196:199] offset:18496
  ds_write_b128 v34, a[200:203] offset:19584
  ds_write_b128 v34, a[204:207] offset:20672
  ds_write_b128 v34, a[208:211] offset:21760
  ds_write_b128 v34, a[212:215] offset:22848
  ds_write_b128 v34, a[216:219] offset:23936
  ds_write_b128 v34, a[220:223] offset:25024
  ds_write_b128 v34, a[224:227] offset:26112
  ds_write_b128 v34, a[228:231] offset:27200
  ds_write_b128 v34, a[232:235] offset:28288
  ds_write_b128 v34, a[236:239] offset:29376
  ds_write_b128 v34, a[240:243] offset:30464
  ds_write_b128 v34, a[244:247] offset:31552
  ds_write_b128 v34, a[248:251] offset:32640
  ds_write_b128 v34, a[252:255] offset:33728
  s_waitcnt lgkmcnt(0)
  s_barrier
  ds_read_b64_tr_b16 a[128:129], v37 offset:0
  ds_read_b64_tr_b16 a[130:131], v37 offset:544
  ds_read_b64_tr_b16 a[132:133], v37 offset:8704
  ds_read_b64_tr_b16 a[134:135], v37 offset:9248
  ds_read_b64_tr_b16 a[136:137], v37 offset:17408
  ds_read_b64_tr_b16 a[138:139], v37 offset:17952
  ds_read_b64_tr_b16 a[140:141], v37 offset:26112
  ds_read_b64_tr_b16 a[142:143], v37 offset:26656
  s_waitcnt lgkmcnt(0)
  ds_read_b64_tr_b16 a[144:145], v37 offset:34816
  ds_read_b64_tr_b16 a[146:147], v37 offset:35360
  ds_read_b64_tr_b16 a[148:149], v37 offset:43520
  ds_read_b64_tr_b16 a[150:151], v37 offset:44064
  ds_read_b64_tr_b16 a[152:153], v37 offset:52224
  ds_read_b64_tr_b16 a[154:155], v37 offset:52768
  ds_read_b64_tr_b16 a[156:157], v37 offset:60928
  ds_read_b64_tr_b16 a[158:159], v37 offset:61472
  s_waitcnt lgkmcnt(0)
  ds_read_b64_tr_b16 a[160:161], v38 offset:0
  ds_read_b64_tr_b16 a[162:163], v38 offset:544
  ds_read_b64_tr_b16 a[164:165], v38 offset:8704
  ds_read_b64_tr_b16 a[166:167], v38 offset:9248
  ds_read_b64_tr_b16 a[168:169], v38 offset:17408
  ds_read_b64_tr_b16 a[170:171], v38 offset:17952
  ds_read_b64_tr_b16 a[172:173], v38 offset:26112
  ds_read_b64_tr_b16 a[174:175], v38 offset:26656
  s_waitcnt lgkmcnt(0)
  ds_read_b64_tr_b16 a[176:177], v38 offset:34816
  ds_read_b64_tr_b16 a[178:179], v38 offset:35360
  ds_read_b64_tr_b16 a[180:181], v38 offset:43520
  ds_read_b64_tr_b16 a[182:183], v38 offset:44064
  ds_read_b64_tr_b16 a[184:185], v38 offset:52224
  ds_read_b64_tr_b16 a[186:187], v38 offset:52768
  ds_read_b64_tr_b16 a[188:189], v38 offset:60928
  ds_read_b64_tr_b16 a[190:191], v38 offset:61472
  s_waitcnt lgkmcnt(0)
  ds_read_b64_tr_b16 a[192:193], v37 offset:32
  ds_read_b64_tr_b16 a[194:195], v37 offset:576
  ds_read_b64_tr_b16 a[196:197], v37 offset:8736
  ds_read_b64_tr_b16 a[198:199], v37 offset:9280
  ds_read_b64_tr_b16 a[200:201], v37 offset:17440
  ds_read_b64_tr_b16 a[202:203], v37 offset:17984
  ds_read_b64_tr_b16 a[204:205], v37 offset:26144
  ds_read_b64_tr_b16 a[206:207], v37 offset:26688
  s_waitcnt lgkmcnt(0)
  ds_read_b64_tr_b16 a[208:209], v37 offset:34848
  ds_read_b64_tr_b16 a[210:211], v37 offset:35392
  ds_read_b64_tr_b16 a[212:213], v37 offset:43552
  ds_read_b64_tr_b16 a[214:215], v37 offset:44096
  ds_read_b64_tr_b16 a[216:217], v37 offset:52256
  ds_read_b64_tr_b16 a[218:219], v37 offset:52800
  ds_read_b64_tr_b16 a[220:221], v37 offset:60960
  ds_read_b64_tr_b16 a[222:223], v37 offset:61504
  s_waitcnt lgkmcnt(0)
  ds_read_b64_tr_b16 a[224:225], v38 offset:32
  ds_read_b64_tr_b16 a[226:227], v38 offset:576
  ds_read_b64_tr_b16 a[228:229], v38 offset:8736
  ds_read_b64_tr_b16 a[230:231], v38 offset:9280
  ds_read_b64_tr_b16 a[232:233], v38 offset:17440
  ds_read_b64_tr_b16 a[234:235], v38 offset:17984
  ds_read_b64_tr_b16 a[236:237], v38 offset:26144
  ds_read_b64_tr_b16 a[238:239], v38 offset:26688
  s_waitcnt lgkmcnt(0)
  ds_read_b64_tr_b16 a[240:241], v38 offset:34848
  ds_read_b64_tr_b16 a[242:243], v38 offset:35392
  ds_read_b64_tr_b16 a[244:245], v38 offset:43552
  ds_read_b64_tr_b16 a[246:247], v38 offset:44096
  ds_read_b64_tr_b16 a[248:249], v38 offset:52256
  ds_read_b64_tr_b16 a[250:251], v38 offset:52800
  ds_read_b64_tr_b16 a[252:253], v38 offset:60960
  ds_read_b64_tr_b16 a[254:255], v38 offset:61504
  s_waitcnt lgkmcnt(0)
  s_barrier
  s_waitcnt vmcnt(16)
  ds_write_b128 v29, v[128:131] offset:0
  ds_write_b128 v29, v[132:135] offset:1056
  ds_write_b128 v29, v[136:139] offset:2112
  ds_write_b128 v29, v[140:143] offset:3168
  ds_write_b128 v29, v[144:147] offset:4224
  ds_write_b128 v29, v[148:151] offset:5280
  ds_write_b128 v29, v[152:155] offset:6336
  ds_write_b128 v29, v[156:159] offset:7392
  ds_write_b128 v29, v[160:163] offset:8448
  ds_write_b128 v29, v[164:167] offset:9504
  ds_write_b128 v29, v[168:171] offset:10560
  ds_write_b128 v29, v[172:175] offset:11616
  ds_write_b128 v29, v[176:179] offset:12672
  ds_write_b128 v29, v[180:183] offset:13728
  ds_write_b128 v29, v[184:187] offset:14784
  ds_write_b128 v29, v[188:191] offset:15840
  ds_write_b128 v29, v[192:195] offset:16896
  ds_write_b128 v29, v[196:199] offset:17952
  ds_write_b128 v29, v[200:203] offset:19008
  ds_write_b128 v29, v[204:207] offset:20064
  ds_write_b128 v29, v[208:211] offset:21120
  ds_write_b128 v29, v[212:215] offset:22176
  ds_write_b128 v29, v[216:219] offset:23232
  ds_write_b128 v29, v[220:223] offset:24288
  ds_write_b128 v29, v[224:227] offset:25344
  ds_write_b128 v29, v[228:231] offset:26400
  ds_write_b128 v29, v[232:235] offset:27456
  ds_write_b128 v29, v[236:239] offset:28512
  ds_write_b128 v29, v[240:243] offset:29568
  ds_write_b128 v29, v[244:247] offset:30624
  ds_write_b128 v29, v[248:251] offset:31680
  ds_write_b128 v29, v[252:255] offset:32736
  s_waitcnt lgkmcnt(0)
  s_barrier
  ds_read_b64_tr_b16 v[128:129], v26 offset:0
  ds_read_b64_tr_b16 v[130:131], v26 offset:16896
  ds_read_b64_tr_b16 v[132:133], v26 offset:33792
  ds_read_b64_tr_b16 v[134:135], v26 offset:50688
  ds_read_b64_tr_b16 v[136:137], v27 offset:0
  ds_read_b64_tr_b16 v[138:139], v27 offset:16896
  ds_read_b64_tr_b16 v[140:141], v27 offset:33792
  ds_read_b64_tr_b16 v[142:143], v27 offset:50688
  s_waitcnt lgkmcnt(0)
  ds_read_b64_tr_b16 v[144:145], v26 offset:32
  ds_read_b64_tr_b16 v[146:147], v26 offset:16928
  ds_read_b64_tr_b16 v[148:149], v26 offset:33824
  ds_read_b64_tr_b16 v[150:151], v26 offset:50720
  ds_read_b64_tr_b16 v[152:153], v27 offset:32
  ds_read_b64_tr_b16 v[154:155], v27 offset:16928
  ds_read_b64_tr_b16 v[156:157], v27 offset:33824
  ds_read_b64_tr_b16 v[158:159], v27 offset:50720
  s_waitcnt lgkmcnt(0)
  ds_read_b64_tr_b16 v[160:161], v26 offset:64
  ds_read_b64_tr_b16 v[162:163], v26 offset:16960
  ds_read_b64_tr_b16 v[164:165], v26 offset:33856
  ds_read_b64_tr_b16 v[166:167], v26 offset:50752
  ds_read_b64_tr_b16 v[168:169], v27 offset:64
  ds_read_b64_tr_b16 v[170:171], v27 offset:16960
  ds_read_b64_tr_b16 v[172:173], v27 offset:33856
  ds_read_b64_tr_b16 v[174:175], v27 offset:50752
  s_waitcnt lgkmcnt(0)
  ds_read_b64_tr_b16 v[176:177], v26 offset:96
  ds_read_b64_tr_b16 v[178:179], v26 offset:16992
  ds_read_b64_tr_b16 v[180:181], v26 offset:33888
  ds_read_b64_tr_b16 v[182:183], v26 offset:50784
  ds_read_b64_tr_b16 v[184:185], v27 offset:96
  ds_read_b64_tr_b16 v[186:187], v27 offset:16992
  ds_read_b64_tr_b16 v[188:189], v27 offset:33888
  ds_read_b64_tr_b16 v[190:191], v27 offset:50784
  s_waitcnt lgkmcnt(0)
  ds_read_b64_tr_b16 v[192:193], v26 offset:128
  ds_read_b64_tr_b16 v[194:195], v26 offset:17024
  ds_read_b64_tr_b16 v[196:197], v26 offset:33920
  ds_read_b64_tr_b16 v[198:199], v26 offset:50816
  ds_read_b64_tr_b16 v[200:201], v27 offset:128
  ds_read_b64_tr_b16 v[202:203], v27 offset:17024
  ds_read_b64_tr_b16 v[204:205], v27 offset:33920
  ds_read_b64_tr_b16 v[206:207], v27 offset:50816
  s_waitcnt lgkmcnt(0)
  ds_read_b64_tr_b16 v[208:209], v26 offset:160
  ds_read_b64_tr_b16 v[210:211], v26 offset:17056
  ds_read_b64_tr_b16 v[212:213], v26 offset:33952
  ds_read_b64_tr_b16 v[214:215], v26 offset:50848
  ds_read_b64_tr_b16 v[216:217], v27 offset:160
  ds_read_b64_tr_b16 v[218:219], v27 offset:17056
  ds_read_b64_tr_b16 v[220:221], v27 offset:33952
  ds_read_b64_tr_b16 v[222:223], v27 offset:50848
  s_waitcnt lgkmcnt(0)
  ds_read_b64_tr_b16 v[224:225], v26 offset:192
  ds_read_b64_tr_b16 v[226:227], v26 offset:17088
  ds_read_b64_tr_b16 v[228:229], v26 offset:33984
  ds_read_b64_tr_b16 v[230:231], v26 offset:50880
  ds_read_b64_tr_b16 v[232:233], v27 offset:192
  ds_read_b64_tr_b16 v[234:235], v27 offset:17088
  ds_read_b64_tr_b16 v[236:237], v27 offset:33984
  ds_read_b64_tr_b16 v[238:239], v27 offset:50880
  s_waitcnt lgkmcnt(0)
  ds_read_b64_tr_b16 v[240:241], v26 offset:224
  ds_read_b64_tr_b16 v[242:243], v26 offset:17120
  ds_read_b64_tr_b16 v[244:245], v26 offset:34016
  ds_read_b64_tr_b16 v[246:247], v26 offset:50912
  ds_read_b64_tr_b16 v[248:249], v27 offset:224
  ds_read_b64_tr_b16 v[250:251], v27 offset:17120
  ds_read_b64_tr_b16 v[252:253], v27 offset:34016
  ds_read_b64_tr_b16 v[254:255], v27 offset:50912
  s_waitcnt lgkmcnt(0)
  s_barrier
  ds_write_b128 v12, v[128:131] offset:0
  ds_write_b128 v12, v[132:135] offset:1024
  ds_write_b128 v12, v[136:139] offset:2048
  ds_write_b128 v12, v[140:143] offset:3072
  ds_write_b128 v12, v[144:147] offset:4096
  ds_write_b128 v12, v[148:151] offset:5120
  ds_write_b128 v12, v[152:155] offset:6144
  ds_write_b128 v12, v[156:159] offset:7168
  ds_write_b128 v12, v[160:163] offset:8192
  ds_write_b128 v12, v[164:167] offset:9216
  ds_write_b128 v12, v[168:171] offset:10240
  ds_write_b128 v12, v[172:175] offset:11264
  ds_write_b128 v12, v[176:179] offset:12288
  ds_write_b128 v12, v[180:183] offset:13312
  ds_write_b128 v12, v[184:187] offset:14336
  ds_write_b128 v12, v[188:191] offset:15360
  ds_write_b128 v12, v[192:195] offset:16384
  ds_write_b128 v12, v[196:199] offset:17408
  ds_write_b128 v12, v[200:203] offset:18432
  ds_write_b128 v12, v[204:207] offset:19456
  ds_write_b128 v12, v[208:211] offset:20480
  ds_write_b128 v12, v[212:215] offset:21504
  ds_write_b128 v12, v[216:219] offset:22528
  ds_write_b128 v12, v[220:223] offset:23552
  ds_write_b128 v12, v[224:227] offset:24576
  ds_write_b128 v12, v[228:231] offset:25600
  ds_write_b128 v12, v[232:235] offset:26624
  ds_write_b128 v12, v[236:239] offset:27648
  ds_write_b128 v12, v[240:243] offset:28672
  ds_write_b128 v12, v[244:247] offset:29696
  ds_write_b128 v12, v[248:251] offset:30720
  ds_write_b128 v12, v[252:255] offset:31744
  s_waitcnt lgkmcnt(0)
  s_waitcnt vmcnt(12)
  s_barrier
  ds_write_b128 v24, v[40:43] offset:0
  ds_write_b128 v24, v[44:47] offset:1088
  ds_write_b128 v24, v[48:51] offset:2176
  ds_write_b128 v24, v[52:55] offset:3264
  s_waitcnt lgkmcnt(0)
  s_mov_b32 s34, 2097152
  buffer_load_dwordx4 v[40:43], v25, s[12:15], s34 offen
  s_mov_b32 s34, 2129920
  buffer_load_dwordx4 v[44:47], v25, s[12:15], s34 offen
  s_mov_b32 s34, 2162688
  buffer_load_dwordx4 v[48:51], v25, s[12:15], s34 offen
  s_mov_b32 s34, 2195456
  buffer_load_dwordx4 v[52:55], v25, s[12:15], s34 offen
  s_barrier
  ds_read_b64_tr_b16 v[128:129], v39 offset:0
  ds_read_b64_tr_b16 v[130:131], v39 offset:544
  ds_read_b64_tr_b16 v[132:133], v39 offset:8704
  ds_read_b64_tr_b16 v[134:135], v39 offset:9248
  ds_read_b64_tr_b16 v[192:193], v39 offset:32
  ds_read_b64_tr_b16 v[194:195], v39 offset:576
  ds_read_b64_tr_b16 v[196:197], v39 offset:8736
  ds_read_b64_tr_b16 v[198:199], v39 offset:9280
  s_waitcnt lgkmcnt(0)
  s_waitcnt vmcnt(12)
  s_barrier
  ds_write_b128 v24, v[56:59] offset:0
  ds_write_b128 v24, v[60:63] offset:1088
  ds_write_b128 v24, v[64:67] offset:2176
  ds_write_b128 v24, v[68:71] offset:3264
  s_waitcnt lgkmcnt(0)
  s_mov_b32 s34, 2621440
  buffer_load_dwordx4 v[56:59], v25, s[12:15], s34 offen
  s_mov_b32 s34, 2654208
  buffer_load_dwordx4 v[60:63], v25, s[12:15], s34 offen
  s_mov_b32 s34, 2686976
  buffer_load_dwordx4 v[64:67], v25, s[12:15], s34 offen
  s_mov_b32 s34, 2719744
  buffer_load_dwordx4 v[68:71], v25, s[12:15], s34 offen
  s_barrier
  ds_read_b64_tr_b16 v[136:137], v39 offset:0
  ds_read_b64_tr_b16 v[138:139], v39 offset:544
  ds_read_b64_tr_b16 v[140:141], v39 offset:8704
  ds_read_b64_tr_b16 v[142:143], v39 offset:9248
  ds_read_b64_tr_b16 v[200:201], v39 offset:32
  ds_read_b64_tr_b16 v[202:203], v39 offset:576
  ds_read_b64_tr_b16 v[204:205], v39 offset:8736
  ds_read_b64_tr_b16 v[206:207], v39 offset:9280
  s_waitcnt lgkmcnt(0)
  s_waitcnt vmcnt(12)
  s_barrier
  ds_write_b128 v24, v[72:75] offset:0
  ds_write_b128 v24, v[76:79] offset:1088
  ds_write_b128 v24, v[80:83] offset:2176
  ds_write_b128 v24, v[84:87] offset:3264
  s_waitcnt lgkmcnt(0)
  s_mov_b32 s34, 3145728
  buffer_load_dwordx4 v[72:75], v25, s[12:15], s34 offen
  s_mov_b32 s34, 3178496
  buffer_load_dwordx4 v[76:79], v25, s[12:15], s34 offen
  s_mov_b32 s34, 3211264
  buffer_load_dwordx4 v[80:83], v25, s[12:15], s34 offen
  s_mov_b32 s34, 3244032
  buffer_load_dwordx4 v[84:87], v25, s[12:15], s34 offen
  s_barrier
  ds_read_b64_tr_b16 v[144:145], v39 offset:0
  ds_read_b64_tr_b16 v[146:147], v39 offset:544
  ds_read_b64_tr_b16 v[148:149], v39 offset:8704
  ds_read_b64_tr_b16 v[150:151], v39 offset:9248
  ds_read_b64_tr_b16 v[208:209], v39 offset:32
  ds_read_b64_tr_b16 v[210:211], v39 offset:576
  ds_read_b64_tr_b16 v[212:213], v39 offset:8736
  ds_read_b64_tr_b16 v[214:215], v39 offset:9280
  s_waitcnt lgkmcnt(0)
  s_waitcnt vmcnt(12)
  s_barrier
  ds_write_b128 v24, v[88:91] offset:0
  ds_write_b128 v24, v[92:95] offset:1088
  ds_write_b128 v24, v[96:99] offset:2176
  ds_write_b128 v24, v[100:103] offset:3264
  s_waitcnt lgkmcnt(0)
  s_mov_b32 s34, 3670016
  buffer_load_dwordx4 v[88:91], v25, s[12:15], s34 offen
  s_mov_b32 s34, 3702784
  buffer_load_dwordx4 v[92:95], v25, s[12:15], s34 offen
  s_mov_b32 s34, 3735552
  buffer_load_dwordx4 v[96:99], v25, s[12:15], s34 offen
  s_mov_b32 s34, 3768320
  buffer_load_dwordx4 v[100:103], v25, s[12:15], s34 offen
  s_barrier
  ds_read_b64_tr_b16 v[152:153], v39 offset:0
  ds_read_b64_tr_b16 v[154:155], v39 offset:544
  ds_read_b64_tr_b16 v[156:157], v39 offset:8704
  ds_read_b64_tr_b16 v[158:159], v39 offset:9248
  ds_read_b64_tr_b16 v[216:217], v39 offset:32
  ds_read_b64_tr_b16 v[218:219], v39 offset:576
  ds_read_b64_tr_b16 v[220:221], v39 offset:8736
  ds_read_b64_tr_b16 v[222:223], v39 offset:9280
  s_waitcnt lgkmcnt(0)
  s_waitcnt vmcnt(12)
  s_barrier
  ds_write_b128 v24, v[40:43] offset:0
  ds_write_b128 v24, v[44:47] offset:1088
  ds_write_b128 v24, v[48:51] offset:2176
  ds_write_b128 v24, v[52:55] offset:3264
  s_waitcnt lgkmcnt(0)
  s_barrier
  ds_read_b64_tr_b16 v[160:161], v39 offset:0
  ds_read_b64_tr_b16 v[162:163], v39 offset:544
  ds_read_b64_tr_b16 v[164:165], v39 offset:8704
  ds_read_b64_tr_b16 v[166:167], v39 offset:9248
  ds_read_b64_tr_b16 v[224:225], v39 offset:32
  ds_read_b64_tr_b16 v[226:227], v39 offset:576
  ds_read_b64_tr_b16 v[228:229], v39 offset:8736
  ds_read_b64_tr_b16 v[230:231], v39 offset:9280
  s_waitcnt lgkmcnt(0)
  s_waitcnt vmcnt(8)
  s_barrier
  ds_write_b128 v24, v[56:59] offset:0
  ds_write_b128 v24, v[60:63] offset:1088
  ds_write_b128 v24, v[64:67] offset:2176
  ds_write_b128 v24, v[68:71] offset:3264
  s_waitcnt lgkmcnt(0)
  s_barrier
  ds_read_b64_tr_b16 v[168:169], v39 offset:0
  ds_read_b64_tr_b16 v[170:171], v39 offset:544
  ds_read_b64_tr_b16 v[172:173], v39 offset:8704
  ds_read_b64_tr_b16 v[174:175], v39 offset:9248
  ds_read_b64_tr_b16 v[232:233], v39 offset:32
  ds_read_b64_tr_b16 v[234:235], v39 offset:576
  ds_read_b64_tr_b16 v[236:237], v39 offset:8736
  ds_read_b64_tr_b16 v[238:239], v39 offset:9280
  s_waitcnt lgkmcnt(0)
  s_waitcnt vmcnt(4)
  s_barrier
  ds_write_b128 v24, v[72:75] offset:0
  ds_write_b128 v24, v[76:79] offset:1088
  ds_write_b128 v24, v[80:83] offset:2176
  ds_write_b128 v24, v[84:87] offset:3264
  s_waitcnt lgkmcnt(0)
  s_barrier
  ds_read_b64_tr_b16 v[176:177], v39 offset:0
  ds_read_b64_tr_b16 v[178:179], v39 offset:544
  ds_read_b64_tr_b16 v[180:181], v39 offset:8704
  ds_read_b64_tr_b16 v[182:183], v39 offset:9248
  ds_read_b64_tr_b16 v[240:241], v39 offset:32
  ds_read_b64_tr_b16 v[242:243], v39 offset:576
  ds_read_b64_tr_b16 v[244:245], v39 offset:8736
  ds_read_b64_tr_b16 v[246:247], v39 offset:9280
  s_waitcnt lgkmcnt(0)
  s_waitcnt vmcnt(0)
  s_barrier
  ds_write_b128 v24, v[88:91] offset:0
  ds_write_b128 v24, v[92:95] offset:1088
  ds_write_b128 v24, v[96:99] offset:2176
  ds_write_b128 v24, v[100:103] offset:3264
  s_waitcnt lgkmcnt(0)
  s_barrier
  ds_read_b64_tr_b16 v[184:185], v39 offset:0
  ds_read_b64_tr_b16 v[186:187], v39 offset:544
  ds_read_b64_tr_b16 v[188:189], v39 offset:8704
  ds_read_b64_tr_b16 v[190:191], v39 offset:9248
  ds_read_b64_tr_b16 v[248:249], v39 offset:32
  ds_read_b64_tr_b16 v[250:251], v39 offset:576
  ds_read_b64_tr_b16 v[252:253], v39 offset:8736
  ds_read_b64_tr_b16 v[254:255], v39 offset:9280
  s_waitcnt lgkmcnt(0)
  s_barrier
  v_mov_b32 v33, 2147483632
  v_lshlrev_b32 v32, 4, v1
  s_lshl_b32 s34, s18, 11
  s_add_u32 s34, s34, 96468992
  v_add_u32 v2, s34, v32
  s_mul_i32 s34, s18, 2080
  s_add_u32 s34, s34, 151808
  v_add_u32 v13, s34, v32
  v_and_b32 v32, 7, v31
  v_mul_u32_u24 v32, 1040, v32
  v_lshl_add_u32 v32, v30, 5, v32
  v_lshrrev_b32 v35, 3, v31
  v_lshl_add_u32 v32, v35, 4, v32
  v_add_u32 v17, 151808, v32
  v_mov_b32 v32, 0x44444444
  v_mov_b32 v35, 0xeeeeeeee
  v_cmp_gt_u32 vcc, 8, v31
  s_nop 1
  v_cndmask_b32 v18, v35, v32, vcc
  s_mov_b32 s12, s20
  s_mov_b32 s13, s21
  s_mov_b32 s14, 8192
  s_mov_b32 s15, 0x00020000
  v_lshlrev_b32 v32, 8, v31
  v_lshl_add_u32 v32, v30, 4, v32
  s_lshl_b32 s34, s16, 11
  s_lshl_b32 s35, s18, 6
  s_add_u32 s34, s34, s35
  s_add_u32 s34, s34, 71303168
  v_add_u32 v32, s34, v32
  v_cndmask_b32 v6, v33, v32, vcc
  v_and_b32 v32, 7, v31
  v_lshlrev_b32 v32, 6, v32
  v_lshl_add_u32 v32, v30, 4, v32
  v_lshrrev_b32 v35, 3, v31
  v_lshl_add_u32 v32, v35, 14, v32
  s_lshl_b32 s34, s18, 17
  s_lshl_b32 s35, s16, 9
  s_add_u32 s34, s34, s35
  s_add_u32 s34, s34, 94371840
  v_add_u32 v14, s34, v32
  v_lshrrev_b32 v32, 2, v31
  v_lshlrev_b32 v32, 3, v32
  v_and_b32 v35, 3, v31
  v_add_u32 v32, v32, v35
  v_lshlrev_b32 v32, 13, v32
  v_lshl_add_u32 v32, v30, 4, v32
  s_lshl_b32 s34, s16, 8
  s_lshl_b32 s35, s18, 6
  s_add_u32 s34, s34, s35
  s_add_u32 s34, s34, 20971520
  v_add_u32 v3, s34, v32
  s_lshl_b32 s77, s18, 10
  s_add_u32 s77, s77, 131072
  v_lshlrev_b32 v19, 4, v1
  v_add_u32 v19, 131072, v19
  v_add_u32 v4, 32768, v3
  v_lshlrev_b32 v32, 6, v31
  v_lshl_add_u32 v32, v30, 4, v32
  s_lshl_b32 s34, s16, 13
  s_lshl_b32 s35, s18, 11
  s_add_u32 s34, s34, s35
  s_add_u32 s34, s34, 37748736
  v_add_u32 v5, s34, v32
  v_lshrrev_b32 v32, 5, v1
  v_lshl_add_u32 v32, v32, 4, v31
  v_lshlrev_b32 v32, 4, v32
  v_and_b32 v35, 1, v30
  v_lshl_add_u32 v32, v35, 3, v32
  s_lshl_b32 s34, s16, 11
  s_lshl_b32 s35, s18, 9
  s_add_u32 s34, s34, s35
  s_add_u32 s34, s34, 75497472
  v_add_u32 v7, s34, v32
  s_lshl_b32 s34, s18, 9
  s_add_u32 s34, s34, 147456
  v_add_u32 v8, s34, v32
  v_lshrrev_b32 v32, 2, v1
  v_and_b32 v32, 3, v32
  v_lshl_add_u32 v32, v30, 3, v32
  v_lshlrev_b32 v32, 4, v32
  v_and_b32 v35, 3, v1
  v_lshl_add_u32 v32, v35, 3, v32
  v_add_u32 v9, 147456, v32
  v_cmp_gt_u32 vcc, 2, v30
  s_mov_b64 s[58:59], vcc
  v_lshlrev_b32 v32, 4, v1
  s_lshl_b32 s34, s18, 10
  s_add_u32 s34, s34, 151808
  v_add_u32 v10, s34, v32
  v_add_u32 v11, 151808, v32
  v_lshrrev_b32 v32, 3, v1
  v_lshlrev_b32 v32, 9, v32
  v_and_b32 v35, 7, v1
  v_lshl_add_u32 v32, v35, 4, v32
  s_lshl_b32 s34, s16, 14
  s_lshl_b32 s35, s18, 7
  s_add_u32 s34, s34, s35
  s_add_u32 s34, s34, 94371840
  v_add_u32 v15, s34, v32
  v_lshrrev_b32 v32, 2, v1
  v_lshlrev_b32 v32, 10, v32
  v_and_b32 v35, 3, v1
  v_lshl_add_u32 v32, v35, 3, v32
  s_lshl_b32 s34, s16, 5
  s_lshl_b32 s35, s18, 11
  s_add_u32 s34, s34, s35
  s_add_u32 s34, s34, 96468992
  v_add_u32 v32, s34, v32
  v_cmp_gt_u32 vcc, 8, v1
  s_nop 1
  v_cndmask_b32 v16, v33, v32, vcc
  v_lshrrev_b32 v32, 1, v1
  v_lshlrev_b32 v32, 13, v32
  v_and_b32 v35, 1, v1
  v_lshl_add_u32 v32, v35, 7, v32
  s_lshl_b32 s34, s16, 8
  s_add_u32 s34, s34, 21233664
  v_add_u32 v32, s34, v32
  v_lshlrev_b32 v35, 7, v1
  s_lshl_b32 s34, s16, 13
  s_add_u32 s34, s34, 38010880
  v_add_u32 v35, s34, v35
  s_cmp_eq_u32 s18, 0
  s_cselect_b64 vcc, -1, 0
  v_cndmask_b32 v0, v35, v32, vcc
  s_cmp_lt_u32 s18, 2
  s_cselect_b64 vcc, -1, 0
  v_cndmask_b32 v0, v33, v0, vcc
  v_mov_b32 v20, -1
  v_mov_b32 v21, -1
  v_mov_b32 v22, -1
  v_mov_b32 v23, -1
  s_mov_b32 s68, 0x3e0293ee
  s_mov_b32 s51, 0
  s_mov_b32 s53, 0
  s_mov_b32 s19, 0
  s_mov_b32 s70, 0
  s_mov_b32 s71, 2
  v_mov_b32 v1, 1
  s_mov_b32 s73, 8192
  s_mov_b32 s74, 0
  s_mov_b32 s75, 16384

  v_mov_b32 v120, 48
  s_mov_b32 s62, 0
L_gw_3:
  buffer_load_dword v121, v120, s[8:11], 0 offen sc1
  s_waitcnt vmcnt(0)
  v_readfirstlane_b32 s34, v121
  s_add_u32 s62, s62, 1
  s_cmp_gt_u32 s62, 0x80000
  s_cbranch_scc1 L_rec_end
  s_cmp_lt_u32 s34, 32
  s_cbranch_scc1 L_gw_3

  s_mov_b32 s76, 0
  s_mov_b32 s72, 0
  s_cmp_lt_u32 s76, s72
  s_cbranch_scc1 L_kvk_6
  v_mbcnt_lo_u32_b32 v126, -1, 0
  v_mbcnt_hi_u32_b32 v126, -1, v126
  v_lshlrev_b32 v126, 9, v126
  s_lshl_b32 s34, s16, 4
  s_add_u32 s34, s34, 98566148
  v_add_u32 v126, s34, v126
  s_mov_b32 s62, 0
  s_mov_b64 exec, 0xffff

L_kvl_5:
  buffer_load_dwordx2 v[124:125], v126, s[4:7], 0 offen sc1
  s_waitcnt vmcnt(0)
  v_cmp_eq_u32 vcc, s69, v124
  v_cmp_eq_u32 s[34:35], s69, v125
  s_nop 3
  s_and_b64 s[34:35], s[34:35], vcc
  s_ff0_i32_b64 s72, s[34:35]
  s_add_u32 s62, s62, 1
  s_cmp_gt_u32 s62, 0x80000
  s_cbranch_scc1 L_rec_end
  s_cmp_lt_u32 s76, s72
  s_cbranch_scc0 L_kvl_5
  s_mov_b64 exec, -1

L_kvk_6:
  s_add_u32 s76, s76, 1
L_kvs_4:
  s_add_u32 m0, s77, 0
  s_nop 0
  buffer_load_dwordx4 v3, s[4:7], s51 offen sc1 lds
  s_add_u32 m0, s77, 4096
  s_nop 0
  buffer_load_dwordx4 v4, s[4:7], s51 offen sc1 lds
  s_xor_b32 s77, s77, 8192
  buffer_load_dwordx4 v[96:99], v5, s[4:7], s51 offen sc1
  buffer_load_dwordx4 v[100:103], v5, s[4:7], s51 offen offset:1024 sc1
  s_add_u32 s51, s51, 262144
  v_mbcnt_lo_u32_b32 v24, -1, 0
  v_mbcnt_hi_u32_b32 v24, -1, v24
  v_lshlrev_b32 v24, 4, v24
  s_lshl_b32 s34, s18, 11
  v_add_u32 v24, s34, v24
  buffer_load_dwordx4 v[120:123], v24, s[12:15], 0 offen
  buffer_load_dwordx4 v[124:127], v24, s[12:15], 0 offen offset:1024

  v_mov_b32 v56, 0
  v_mov_b32 v57, 0
  v_mov_b32 v58, 0
  v_mov_b32 v59, 0
  v_mov_b32 v60, 0
  v_mov_b32 v61, 0
  v_mov_b32 v62, 0
  v_mov_b32 v63, 0
  v_mov_b32 v64, 0
  v_mov_b32 v65, 0
  v_mov_b32 v66, 0
  v_mov_b32 v67, 0
  v_mov_b32 v68, 0
  v_mov_b32 v69, 0
  v_mov_b32 v70, 0
  v_mov_b32 v71, 0
  v_mov_b32 v72, 0
  v_mov_b32 v73, 0
  v_mov_b32 v74, 0
  v_mov_b32 v75, 0
  v_mov_b32 v76, 0
  v_mov_b32 v77, 0
  v_mov_b32 v78, 0
  v_mov_b32 v79, 0
  s_waitcnt vmcnt(0) lgkmcnt(0)
  v_mov_b32 v112, v96
  v_mov_b32 v113, v97
  v_mov_b32 v114, v98
  v_mov_b32 v115, v99
  v_mov_b32 v116, v100
  v_mov_b32 v117, v101
  v_mov_b32 v118, v102
  v_mov_b32 v119, v103
  s_barrier
  s_cmp_lg_u32 s17, 0
  s_cbranch_scc1 L_recS_entry0
  s_branch L_recF_entry0
L_recF_loop:
  s_mov_b32 s62, 0
  s_waitcnt vmcnt(2)
  v_mov_b32 v56, 0
  v_mov_b32 v57, 0
  v_mov_b32 v58, 0
  v_mov_b32 v59, 0
  v_mov_b32 v60, 0
  v_mov_b32 v61, 0
  v_mov_b32 v62, 0
  v_mov_b32 v63, 0
  v_mov_b32 v64, 0
  v_mov_b32 v65, 0
  v_mov_b32 v66, 0
  v_mov_b32 v67, 0
  v_mov_b32 v68, 0
  v_mov_b32 v69, 0
  v_mov_b32 v70, 0
  v_mov_b32 v71, 0
  v_mov_b32 v72, 0
  v_mov_b32 v73, 0
  v_mov_b32 v74, 0
  v_mov_b32 v75, 0
  v_mov_b32 v76, 0
  v_mov_b32 v77, 0
  v_mov_b32 v78, 0
  v_mov_b32 v79, 0
  v_mov_b32 v112, v96
  v_mov_b32 v113, v97
  v_mov_b32 v114, v98
  v_mov_b32 v115, v99
  v_mov_b32 v116, v100
  v_mov_b32 v117, v101
  v_mov_b32 v118, v102
  v_mov_b32 v119, v103
  v_xor_b32 v19, 8192, v19
  buffer_load_dwordx4 v[120:123], v2, s[4:7], s74 offen sc1
  buffer_load_dwordx4 v[124:127], v2, s[4:7], s74 offen offset:1024 sc1
L_recFa_pa:
  s_waitcnt vmcnt(0)
  v_max3_u32 v24, v120, v121, v122
  v_max3_u32 v24, v24, v123, v124
  v_max3_u32 v24, v24, v125, v126
  v_max_u32 v24, v24, v127
  v_cmp_eq_u32 vcc, -1, v24
  s_cbranch_vccz L_recFa_pa0

  buffer_load_dwordx4 v[120:123], v2, s[4:7], s74 offen sc1
  buffer_load_dwordx4 v[124:127], v2, s[4:7], s74 offen offset:1024 sc1
  s_add_u32 s62, s62, 1
  s_cmp_gt_u32 s62, 0x40000
  s_cbranch_scc1 L_rec_end
  s_branch L_recFa_pa

L_recFa_pa0:
  ds_write_b128 v13, v[120:123]
  ds_write_b128 v13, v[124:127] offset:1040
L_recFa_paX:
  s_waitcnt lgkmcnt(0)
  s_barrier
  ds_read_b128 v[24:27], v17 offset:0
  ds_read_b128 v[28:31], v17 offset:128
  ds_read_b128 v[32:35], v17 offset:256
  s_and_b32 s34, s19, 3
  s_cbranch_scc1 L_pub_7
  s_cmp_eq_u32 s19, 0
  s_cbranch_scc1 L_pub_7
  s_cmp_lg_u32 s18, 0
  s_cbranch_scc1 L_pub_7
  s_lshl_b32 s34, s19, 5
  s_lshl_b32 s35, s16, 2
  s_add_u32 s34, s34, s35
  s_add_u32 s34, s34, 98631552
  v_mov_b32 v126, s34
  v_mov_b32 v127, s69
  s_mov_b64 exec, 1
  buffer_store_dword v127, v126, s[4:7], 0 offen sc1
  s_mov_b64 exec, -1

L_pub_7:
  s_add_u32 s34, s19, 1
  s_and_b32 s34, s34, 3
  s_cbranch_scc1 L_kvs_8
  s_cmp_lt_u32 s76, s72
  s_cbranch_scc1 L_kvk_10
  v_mbcnt_lo_u32_b32 v126, -1, 0
  v_mbcnt_hi_u32_b32 v126, -1, v126
  v_lshlrev_b32 v126, 9, v126
  s_lshl_b32 s34, s16, 4
  s_add_u32 s34, s34, 98566148
  v_add_u32 v126, s34, v126
  s_mov_b32 s62, 0
  s_mov_b64 exec, 0xffff

L_kvl_9:
  buffer_load_dwordx2 v[124:125], v126, s[4:7], 0 offen sc1
  s_waitcnt vmcnt(0)
  v_cmp_eq_u32 vcc, s69, v124
  v_cmp_eq_u32 s[34:35], s69, v125
  s_nop 3
  s_and_b64 s[34:35], s[34:35], vcc
  s_ff0_i32_b64 s72, s[34:35]
  s_add_u32 s62, s62, 1
  s_cmp_gt_u32 s62, 0x80000
  s_cbranch_scc1 L_rec_end
  s_cmp_lt_u32 s76, s72
  s_cbranch_scc0 L_kvl_9
  s_mov_b64 exec, -1

L_kvk_10:
  s_add_u32 s76, s76, 1
L_kvs_8:
  s_cmp_ge_u32 s19, 62
  s_cbranch_scc1 L_nopf_11
  s_add_u32 m0, s77, 0
  s_nop 0
  buffer_load_dwordx4 v3, s[4:7], s51 offen sc1 lds
  s_add_u32 m0, s77, 4096
  s_nop 0
  buffer_load_dwordx4 v4, s[4:7], s51 offen sc1 lds
  s_xor_b32 s77, s77, 8192
  buffer_load_dwordx4 v[96:99], v5, s[4:7], s51 offen sc1
  buffer_load_dwordx4 v[100:103], v5, s[4:7], s51 offen offset:1024 sc1
  s_add_u32 s51, s51, 262144
L_nopf_11:
  s_waitcnt lgkmcnt(2)
  v_smfmac_f32_16x16x64_bf16 v[56:59], v[24:27], a[0:7], v18
  v_smfmac_f32_16x16x64_bf16 v[60:63], v[24:27], a[64:71], v18
  ds_read_b128 v[36:39], v17 offset:384
  v_smfmac_f32_16x16x64_bf16 v[64:67], v[24:27], a[128:135], v18
  v_smfmac_f32_16x16x64_bf16 v[68:71], v[24:27], a[192:199], v18
  v_smfmac_f32_16x16x64_bf16 v[72:75], v[24:27], v[128:135], v18
  v_smfmac_f32_16x16x64_bf16 v[76:79], v[24:27], v[192:199], v18
  s_waitcnt lgkmcnt(2)
  v_smfmac_f32_16x16x64_bf16 v[56:59], v[28:31], a[8:15], v18
  v_smfmac_f32_16x16x64_bf16 v[60:63], v[28:31], a[72:79], v18
  ds_read_b128 v[40:43], v17 offset:512
  v_smfmac_f32_16x16x64_bf16 v[64:67], v[28:31], a[136:143], v18
  v_smfmac_f32_16x16x64_bf16 v[68:71], v[28:31], a[200:207], v18
  v_smfmac_f32_16x16x64_bf16 v[72:75], v[28:31], v[136:143], v18
  v_smfmac_f32_16x16x64_bf16 v[76:79], v[28:31], v[200:207], v18
  s_waitcnt lgkmcnt(2)
  v_smfmac_f32_16x16x64_bf16 v[56:59], v[32:35], a[16:23], v18
  v_smfmac_f32_16x16x64_bf16 v[60:63], v[32:35], a[80:87], v18
  ds_read_b128 v[44:47], v17 offset:640
  v_smfmac_f32_16x16x64_bf16 v[64:67], v[32:35], a[144:151], v18
  v_smfmac_f32_16x16x64_bf16 v[68:71], v[32:35], a[208:215], v18
  v_smfmac_f32_16x16x64_bf16 v[72:75], v[32:35], v[144:151], v18
  v_smfmac_f32_16x16x64_bf16 v[76:79], v[32:35], v[208:215], v18
  s_waitcnt lgkmcnt(2)
  v_smfmac_f32_16x16x64_bf16 v[56:59], v[36:39], a[24:31], v18
  v_smfmac_f32_16x16x64_bf16 v[60:63], v[36:39], a[88:95], v18
  ds_read_b128 v[48:51], v17 offset:768
  v_smfmac_f32_16x16x64_bf16 v[64:67], v[36:39], a[152:159], v18
  v_smfmac_f32_16x16x64_bf16 v[68:71], v[36:39], a[216:223], v18
  v_smfmac_f32_16x16x64_bf16 v[72:75], v[36:39], v[152:159], v18
  v_smfmac_f32_16x16x64_bf16 v[76:79], v[36:39], v[216:223], v18
  s_waitcnt lgkmcnt(2)
  v_smfmac_f32_16x16x64_bf16 v[56:59], v[40:43], a[32:39], v18
  v_smfmac_f32_16x16x64_bf16 v[60:63], v[40:43], a[96:103], v18
  ds_read_b128 v[52:55], v17 offset:896
  v_smfmac_f32_16x16x64_bf16 v[64:67], v[40:43], a[160:167], v18
  v_smfmac_f32_16x16x64_bf16 v[68:71], v[40:43], a[224:231], v18
  v_smfmac_f32_16x16x64_bf16 v[72:75], v[40:43], v[160:167], v18
  v_smfmac_f32_16x16x64_bf16 v[76:79], v[40:43], v[224:231], v18
  s_waitcnt lgkmcnt(2)
  v_smfmac_f32_16x16x64_bf16 v[56:59], v[44:47], a[40:47], v18
  v_smfmac_f32_16x16x64_bf16 v[60:63], v[44:47], a[104:111], v18
  v_smfmac_f32_16x16x64_bf16 v[64:67], v[44:47], a[168:175], v18
  v_smfmac_f32_16x16x64_bf16 v[68:71], v[44:47], a[232:239], v18
  ds_read_b128 v[80:83], v19 offset:0
  ds_read_b128 v[84:87], v19 offset:4096
  v_smfmac_f32_16x16x64_bf16 v[72:75], v[44:47], v[168:175], v18
  v_smfmac_f32_16x16x64_bf16 v[76:79], v[44:47], v[232:239], v18
  s_waitcnt lgkmcnt(1)
  v_smfmac_f32_16x16x64_bf16 v[56:59], v[48:51], a[48:55], v18
  v_smfmac_f32_16x16x64_bf16 v[60:63], v[48:51], a[112:119], v18
  v_smfmac_f32_16x16x64_bf16 v[64:67], v[48:51], a[176:183], v18
  v_smfmac_f32_16x16x64_bf16 v[68:71], v[48:51], a[240:247], v18
  ds_read_b128 v[88:91], v19 offset:1024
  ds_read_b128 v[92:95], v19 offset:5120
  v_smfmac_f32_16x16x64_bf16 v[72:75], v[48:51], v[176:183], v18
  v_smfmac_f32_16x16x64_bf16 v[76:79], v[48:51], v[240:247], v18
  s_waitcnt lgkmcnt(0)
  v_smfmac_f32_16x16x64_bf16 v[56:59], v[52:55], a[56:63], v18
  v_smfmac_f32_16x16x64_bf16 v[60:63], v[52:55], a[120:127], v18
  v_smfmac_f32_16x16x64_bf16 v[64:67], v[52:55], a[184:191], v18
  v_smfmac_f32_16x16x64_bf16 v[68:71], v[52:55], a[248:255], v18
  v_smfmac_f32_16x16x64_bf16 v[72:75], v[52:55], v[184:191], v18
  v_smfmac_f32_16x16x64_bf16 v[76:79], v[52:55], v[248:255], v18
  s_nop 4
  v_permlane32_swap_b32 v56, v60
  v_permlane32_swap_b32 v57, v61
  v_permlane32_swap_b32 v58, v62
  v_permlane32_swap_b32 v59, v63
  v_pk_add_f32 v[56:57], v[56:57], v[60:61]
  v_pk_add_f32 v[58:59], v[58:59], v[62:63]
  v_cvt_pk_bf16_f32 v56, v56, v57
  v_cvt_pk_bf16_f32 v57, v58, v59
  ds_write_b64 v8, v[56:57] offset:0
  v_permlane32_swap_b32 v64, v68
  v_permlane32_swap_b32 v65, v69
  v_permlane32_swap_b32 v66, v70
  v_permlane32_swap_b32 v67, v71
  v_pk_add_f32 v[64:65], v[64:65], v[68:69]
  v_pk_add_f32 v[66:67], v[66:67], v[70:71]
  v_cvt_pk_bf16_f32 v64, v64, v65
  v_cvt_pk_bf16_f32 v65, v66, v67
  ds_write_b64 v8, v[64:65] offset:2176
  v_permlane32_swap_b32 v72, v76
  v_permlane32_swap_b32 v73, v77
  v_permlane32_swap_b32 v74, v78
  v_permlane32_swap_b32 v75, v79
  v_pk_add_f32 v[72:73], v[72:73], v[76:77]
  v_pk_add_f32 v[74:75], v[74:75], v[78:79]
  v_cvt_pk_bf16_f32 v72, v72, v73
  v_cvt_pk_bf16_f32 v73, v74, v75
  buffer_store_dwordx2 v[72:73], v7, s[4:7], s53 offen sc1
  v_mov_b32 v76, 0
  v_mov_b32 v77, 0
  v_mov_b32 v78, 0
  v_mov_b32 v79, 0
  v_mov_b32 v74, 0
  v_mov_b32 v75, 0
  s_waitcnt lgkmcnt(0)
  s_barrier

  ds_read_b64_tr_b16 v[24:25], v9 offset:0
  ds_read_b64_tr_b16 v[26:27], v9 offset:64
  ds_read_b64_tr_b16 v[40:41], v9 offset:2176
  ds_read_b64_tr_b16 v[42:43], v9 offset:2240
  ds_read_b64_tr_b16 v[28:29], v9 offset:512
  ds_read_b64_tr_b16 v[30:31], v9 offset:576
  ds_read_b64_tr_b16 v[44:45], v9 offset:2688
  ds_read_b64_tr_b16 v[46:47], v9 offset:2752
  ds_read_b64_tr_b16 v[32:33], v9 offset:1024
  ds_read_b64_tr_b16 v[34:35], v9 offset:1088
  ds_read_b64_tr_b16 v[48:49], v9 offset:3200
  ds_read_b64_tr_b16 v[50:51], v9 offset:3264
  ds_read_b64_tr_b16 v[36:37], v9 offset:1536
  ds_read_b64_tr_b16 v[38:39], v9 offset:1600
  ds_read_b64_tr_b16 v[52:53], v9 offset:3712
  ds_read_b64_tr_b16 v[54:55], v9 offset:3776
  v_permlane32_swap_b32 v72, v76
  v_permlane32_swap_b32 v73, v77
  s_waitcnt lgkmcnt(12)
  v_mfma_f32_16x16x32_bf16 v[56:59], v[40:43], v[24:27], 0
  v_mfma_f32_16x16x32_bf16 v[60:63], v[80:83], v[24:27], 0
  v_mfma_f32_16x16x32_bf16 v[64:67], v[84:87], v[24:27], 0
  ds_read_b128 v[80:83], v19 offset:2048
  ds_read_b128 v[84:87], v19 offset:6144
  s_waitcnt lgkmcnt(10)
  v_mfma_f32_16x16x32_bf16 v[56:59], v[44:47], v[28:31], v[56:59]
  v_mfma_f32_16x16x32_bf16 v[60:63], v[88:91], v[28:31], v[60:63]
  v_mfma_f32_16x16x32_bf16 v[64:67], v[92:95], v[28:31], v[64:67]
  ds_read_b128 v[88:91], v19 offset:3072
  ds_read_b128 v[92:95], v19 offset:7168
  s_waitcnt lgkmcnt(2)
  v_mfma_f32_16x16x32_bf16 v[56:59], v[48:51], v[32:35], v[56:59]
  v_mfma_f32_16x16x32_bf16 v[60:63], v[80:83], v[32:35], v[60:63]
  v_mfma_f32_16x16x32_bf16 v[64:67], v[84:87], v[32:35], v[64:67]
  s_waitcnt lgkmcnt(0)
  v_mfma_f32_16x16x32_bf16 v[56:59], v[52:55], v[36:39], v[56:59]
  v_mfma_f32_16x16x32_bf16 v[60:63], v[88:91], v[36:39], v[60:63]
  v_mfma_f32_16x16x32_bf16 v[64:67], v[92:95], v[36:39], v[64:67]
  s_cmp_eq_u32 s18, 0
  s_cbranch_scc1 L_km_12
  s_cmp_eq_u32 s18, 1
  s_cbranch_scc1 L_km_13
  s_cmp_eq_u32 s18, 2
  s_cbranch_scc1 L_km_14
  buffer_store_dwordx4 v[52:55], v6, s[4:7], s53 offen sc1
  s_branch L_kmd_16
L_km_14:
  buffer_store_dwordx4 v[48:51], v6, s[4:7], s53 offen sc1
  s_branch L_kmd_16
L_km_13:
  buffer_store_dwordx4 v[44:47], v6, s[4:7], s53 offen sc1
  s_branch L_kmd_16
L_km_12:
  buffer_store_dwordx4 v[40:43], v6, s[4:7], s53 offen sc1
L_kmd_16:
  s_add_u32 s53, s53, 65536
  s_nop 3
  v_mov_b32 v121, 0xf149f2ca
  v_cndmask_b32 v56, v121, v56, s[58:59]
  v_cndmask_b32 v57, v121, v57, s[58:59]
  v_cndmask_b32 v58, v121, v58, s[58:59]
  v_cndmask_b32 v59, v121, v59, s[58:59]
  v_max3_f32 v120, v60, v61, v62
  v_max3_f32 v121, v63, v64, v65
  v_max3_f32 v120, v120, v66, v67
  v_max3_f32 v121, v121, v56, v57
  v_max3_f32 v120, v120, v58, v59
  v_max_f32 v120, v120, v121
  v_mov_b32 v121, v120
  s_nop 1
  v_permlane16_swap_b32 v120, v121
  v_max_f32 v120, v120, v121
  v_mov_b32 v121, v120
  s_nop 1
  v_permlane32_swap_b32 v120, v121
  v_max_f32 v120, v120, v121
  v_mul_f32 v120, s68, v120

  v_fma_f32 v56, v56, s68, -v120
  v_fma_f32 v57, v57, s68, -v120
  v_fma_f32 v58, v58, s68, -v120
  v_fma_f32 v59, v59, s68, -v120
  v_fma_f32 v60, v60, s68, -v120
  v_fma_f32 v61, v61, s68, -v120
  v_fma_f32 v62, v62, s68, -v120
  v_fma_f32 v63, v63, s68, -v120
  v_fma_f32 v64, v64, s68, -v120
  v_fma_f32 v65, v65, s68, -v120
  v_fma_f32 v66, v66, s68, -v120
  v_fma_f32 v67, v67, s68, -v120
  v_exp_f32 v56, v56
  v_exp_f32 v57, v57
  v_exp_f32 v58, v58
  v_exp_f32 v59, v59
  v_exp_f32 v60, v60
  v_exp_f32 v61, v61
  v_exp_f32 v62, v62
  v_exp_f32 v63, v63
  v_exp_f32 v64, v64
  v_exp_f32 v65, v65
  v_exp_f32 v66, v66
  v_exp_f32 v67, v67
  s_nop 0
  v_add_f32 v122, v56, v57
  v_add_f32 v123, v58, v59
  v_cvt_pk_bf16_f32 v56, v56, v57
  v_cvt_pk_bf16_f32 v57, v58, v59
  v_mov_b32 v58, 0
  v_mov_b32 v59, 0
  v_add_f32 v122, v122, v60
  v_add_f32 v123, v123, v61
  v_add_f32 v122, v122, v62
  v_add_f32 v123, v123, v63
  v_cvt_pk_bf16_f32 v60, v60, v61
  v_cvt_pk_bf16_f32 v61, v62, v63
  v_add_f32 v122, v122, v64
  v_add_f32 v123, v123, v65
  v_add_f32 v122, v122, v66
  v_add_f32 v123, v123, v67
  v_cvt_pk_bf16_f32 v62, v64, v65
  v_cvt_pk_bf16_f32 v63, v66, v67
  v_add_f32 v122, v122, v123
  v_mov_b32 v123, v122

  v_mfma_f32_16x16x32_bf16 v[64:67], v[112:115], v[60:63], 0
  v_mfma_f32_16x16x32_bf16 v[68:71], v[116:119], v[60:63], 0
  v_mfma_f32_16x16x32_bf16 v[64:67], v[72:75], v[56:59], v[64:67]
  v_mfma_f32_16x16x32_bf16 v[68:71], v[76:79], v[56:59], v[68:71]
  v_permlane16_swap_b32 v122, v123
  v_add_f32 v122, v122, v123
  v_mov_b32 v123, v122
  s_nop 1
  v_permlane32_swap_b32 v122, v123
  v_add_f32 v122, v122, v123
  v_rcp_f32 v122, v122

  ds_read_b128 v[112:115], v12 offset:0
  ds_read_b128 v[116:119], v12 offset:1024
  v_mul_f32 v64, v64, v122
  v_mul_f32 v65, v65, v122
  v_mul_f32 v66, v66, v122
  v_mul_f32 v67, v67, v122
  v_mul_f32 v68, v68, v122
  v_mul_f32 v69, v69, v122
  v_mul_f32 v70, v70, v122
  v_mul_f32 v71, v71, v122
  v_cvt_pk_bf16_f32 v64, v64, v65
  v_cvt_pk_bf16_f32 v65, v66, v67
  v_cvt_pk_bf16_f32 v66, v68, v69
  v_cvt_pk_bf16_f32 v67, v70, v71
  ds_write_b128 v10, v[64:67]

  ds_read_b128 v[72:75], v12 offset:2048
  ds_read_b128 v[76:79], v12 offset:3072
  ds_read_b128 v[124:127], v12 offset:4096
  ds_read_b128 v[104:107], v12 offset:5120
  s_waitcnt lgkmcnt(0)
  s_barrier
  ds_read_b128 v[56:59], v11 offset:0
  ds_read_b128 v[60:63], v11 offset:1024
  ds_read_b128 v[64:67], v11 offset:2048
  ds_read_b128 v[68:71], v11 offset:3072
  s_waitcnt lgkmcnt(0)
  v_mfma_f32_16x16x32_bf16 v[24:27], v[112:115], v[56:59], 0
  ds_read_b128 v[108:111], v12 offset:6144
  v_mfma_f32_16x16x32_bf16 v[24:27], v[116:119], v[60:63], v[24:27]
  ds_read_b128 v[112:115], v12 offset:7168
  v_mfma_f32_16x16x32_bf16 v[24:27], v[72:75], v[64:67], v[24:27]
  ds_read_b128 v[116:119], v12 offset:8192
  v_mfma_f32_16x16x32_bf16 v[24:27], v[76:79], v[68:71], v[24:27]
  ds_read_b128 v[72:75], v12 offset:9216
  v_mfma_f32_16x16x32_bf16 v[28:31], v[124:127], v[56:59], 0
  ds_read_b128 v[76:79], v12 offset:10240
  v_mfma_f32_16x16x32_bf16 v[28:31], v[104:107], v[60:63], v[28:31]
  ds_read_b128 v[124:127], v12 offset:11264
  s_waitcnt lgkmcnt(5)
  v_mfma_f32_16x16x32_bf16 v[28:31], v[108:111], v[64:67], v[28:31]
  ds_read_b128 v[104:107], v12 offset:12288
  s_waitcnt lgkmcnt(5)
  v_mfma_f32_16x16x32_bf16 v[28:31], v[112:115], v[68:71], v[28:31]
  ds_read_b128 v[108:111], v12 offset:13312
  s_waitcnt lgkmcnt(5)
  v_mfma_f32_16x16x32_bf16 v[32:35], v[116:119], v[56:59], 0
  ds_read_b128 v[112:115], v12 offset:14336
  s_waitcnt lgkmcnt(5)
  v_mfma_f32_16x16x32_bf16 v[32:35], v[72:75], v[60:63], v[32:35]
  ds_read_b128 v[116:119], v12 offset:15360
  s_waitcnt lgkmcnt(5)
  v_mfma_f32_16x16x32_bf16 v[32:35], v[76:79], v[64:67], v[32:35]
  ds_read_b128 v[72:75], v12 offset:16384
  s_waitcnt lgkmcnt(5)
  v_mfma_f32_16x16x32_bf16 v[32:35], v[124:127], v[68:71], v[32:35]
  ds_read_b128 v[76:79], v12 offset:17408
  s_waitcnt lgkmcnt(5)
  v_mfma_f32_16x16x32_bf16 v[36:39], v[104:107], v[56:59], 0
  ds_read_b128 v[124:127], v12 offset:18432
  s_waitcnt lgkmcnt(5)
  v_mfma_f32_16x16x32_bf16 v[36:39], v[108:111], v[60:63], v[36:39]
  ds_read_b128 v[104:107], v12 offset:19456
  s_waitcnt lgkmcnt(5)
  v_mfma_f32_16x16x32_bf16 v[36:39], v[112:115], v[64:67], v[36:39]
  ds_read_b128 v[108:111], v12 offset:20480
  s_waitcnt lgkmcnt(5)
  v_mfma_f32_16x16x32_bf16 v[36:39], v[116:119], v[68:71], v[36:39]
  ds_read_b128 v[112:115], v12 offset:21504
  v_mov_b32_dpp v24, v28 row_shr:8 row_mask:0xf bank_mask:0xc
  v_mov_b32_dpp v25, v29 row_shr:8 row_mask:0xf bank_mask:0xc
  v_mov_b32_dpp v26, v30 row_shr:8 row_mask:0xf bank_mask:0xc
  v_mov_b32_dpp v27, v31 row_shr:8 row_mask:0xf bank_mask:0xc
  v_and_or_b32 v24, v24, -4, v1
  v_and_or_b32 v25, v25, -4, v1
  v_and_or_b32 v26, v26, -4, v1
  v_and_or_b32 v27, v27, -4, v1
  s_mov_b32 s34, 0
  buffer_store_dwordx4 v[24:27], v14, s[4:7], s34 offen
  s_waitcnt lgkmcnt(5)
  v_mfma_f32_16x16x32_bf16 v[40:43], v[72:75], v[56:59], 0
  ds_read_b128 v[116:119], v12 offset:22528
  s_waitcnt lgkmcnt(5)
  v_mfma_f32_16x16x32_bf16 v[40:43], v[76:79], v[60:63], v[40:43]
  ds_read_b128 v[72:75], v12 offset:23552
  s_waitcnt lgkmcnt(5)
  v_mfma_f32_16x16x32_bf16 v[40:43], v[124:127], v[64:67], v[40:43]
  ds_read_b128 v[76:79], v12 offset:24576
  s_waitcnt lgkmcnt(5)
  v_mfma_f32_16x16x32_bf16 v[40:43], v[104:107], v[68:71], v[40:43]
  ds_read_b128 v[124:127], v12 offset:25600
  s_waitcnt lgkmcnt(5)
  v_mfma_f32_16x16x32_bf16 v[44:47], v[108:111], v[56:59], 0
  ds_read_b128 v[104:107], v12 offset:26624
  s_waitcnt lgkmcnt(5)
  v_mfma_f32_16x16x32_bf16 v[44:47], v[112:115], v[60:63], v[44:47]
  ds_read_b128 v[108:111], v12 offset:27648
  s_waitcnt lgkmcnt(5)
  v_mfma_f32_16x16x32_bf16 v[44:47], v[116:119], v[64:67], v[44:47]
  ds_read_b128 v[112:115], v12 offset:28672
  s_waitcnt lgkmcnt(5)
  v_mfma_f32_16x16x32_bf16 v[44:47], v[72:75], v[68:71], v[44:47]
  ds_read_b128 v[116:119], v12 offset:29696
  v_mov_b32_dpp v32, v36 row_shr:8 row_mask:0xf bank_mask:0xc
  v_mov_b32_dpp v33, v37 row_shr:8 row_mask:0xf bank_mask:0xc
  v_mov_b32_dpp v34, v38 row_shr:8 row_mask:0xf bank_mask:0xc
  v_mov_b32_dpp v35, v39 row_shr:8 row_mask:0xf bank_mask:0xc
  v_and_or_b32 v32, v32, -4, v1
  v_and_or_b32 v33, v33, -4, v1
  v_and_or_b32 v34, v34, -4, v1
  v_and_or_b32 v35, v35, -4, v1
  s_mov_b32 s34, 32768
  buffer_store_dwordx4 v[32:35], v14, s[4:7], s34 offen
  s_waitcnt lgkmcnt(5)
  v_mfma_f32_16x16x32_bf16 v[48:51], v[76:79], v[56:59], 0
  ds_read_b128 v[72:75], v12 offset:30720
  s_waitcnt lgkmcnt(5)
  v_mfma_f32_16x16x32_bf16 v[48:51], v[124:127], v[60:63], v[48:51]
  ds_read_b128 v[76:79], v12 offset:31744
  s_waitcnt lgkmcnt(5)
  v_mfma_f32_16x16x32_bf16 v[48:51], v[104:107], v[64:67], v[48:51]
  s_waitcnt lgkmcnt(4)
  v_mfma_f32_16x16x32_bf16 v[48:51], v[108:111], v[68:71], v[48:51]
  s_waitcnt lgkmcnt(3)
  v_mfma_f32_16x16x32_bf16 v[52:55], v[112:115], v[56:59], 0
  s_waitcnt lgkmcnt(2)
  v_mfma_f32_16x16x32_bf16 v[52:55], v[116:119], v[60:63], v[52:55]
  s_waitcnt lgkmcnt(1)
  v_mfma_f32_16x16x32_bf16 v[52:55], v[72:75], v[64:67], v[52:55]
  s_waitcnt lgkmcnt(0)
  v_mfma_f32_16x16x32_bf16 v[52:55], v[76:79], v[68:71], v[52:55]
  v_mov_b32_dpp v40, v44 row_shr:8 row_mask:0xf bank_mask:0xc
  v_mov_b32_dpp v41, v45 row_shr:8 row_mask:0xf bank_mask:0xc
  v_mov_b32_dpp v42, v46 row_shr:8 row_mask:0xf bank_mask:0xc
  v_mov_b32_dpp v43, v47 row_shr:8 row_mask:0xf bank_mask:0xc
  v_and_or_b32 v40, v40, -4, v1
  v_and_or_b32 v41, v41, -4, v1
  v_and_or_b32 v42, v42, -4, v1
  v_and_or_b32 v43, v43, -4, v1
  s_mov_b32 s34, 65536
  buffer_store_dwordx4 v[40:43], v14, s[4:7], s34 offen
  s_nop 7
  v_mov_b32_dpp v48, v52 row_shr:8 row_mask:0xf bank_mask:0xc
  v_mov_b32_dpp v49, v53 row_shr:8 row_mask:0xf bank_mask:0xc
  v_mov_b32_dpp v50, v54 row_shr:8 row_mask:0xf bank_mask:0xc
  v_mov_b32_dpp v51, v55 row_shr:8 row_mask:0xf bank_mask:0xc
  v_and_or_b32 v48, v48, -4, v1
  v_and_or_b32 v49, v49, -4, v1
  v_and_or_b32 v50, v50, -4, v1
  v_and_or_b32 v51, v51, -4, v1
  s_mov_b32 s34, 98304
  buffer_store_dwordx4 v[48:51], v14, s[4:7], s34 offen
  s_mov_b32 s62, 0
  s_add_u32 s34, s70, 4096
  s_add_u32 s35, s70, 8192
  s_add_u32 s36, s70, 12288
  s_sleep 6
  buffer_load_dwordx4 v[56:59], v15, s[4:7], s70 offen sc1
  buffer_load_dwordx4 v[60:63], v15, s[4:7], s34 offen sc1
  buffer_load_dwordx4 v[64:67], v15, s[4:7], s35 offen sc1
  buffer_load_dwordx4 v[68:71], v15, s[4:7], s36 offen sc1
L_recFa_pg:
  s_waitcnt vmcnt(0)
  v_or3_b32 v24, v56, v57, v58
  v_or3_b32 v25, v59, v60, v61
  v_or3_b32 v24, v24, v62, v63
  v_or3_b32 v25, v25, v64, v65
  v_or3_b32 v24, v24, v66, v67
  v_or3_b32 v25, v25, v68, v69
  v_or3_b32 v24, v24, v70, v71
  v_or_b32 v24, v24, v25
  v_and_b32 v24, s71, v24
  v_cmp_ne_u32 vcc, 0, v24
  s_cbranch_vccz L_recFa_pg0
  buffer_load_dwordx4 v[56:59], v15, s[4:7], s70 offen sc1
  buffer_load_dwordx4 v[60:63], v15, s[4:7], s34 offen sc1
  buffer_load_dwordx4 v[64:67], v15, s[4:7], s35 offen sc1
  buffer_load_dwordx4 v[68:71], v15, s[4:7], s36 offen sc1
  s_add_u32 s62, s62, 1
  s_cmp_gt_u32 s62, 0x40000
  s_cbranch_scc1 L_rec_end
  s_branch L_recFa_pg

L_recFa_pg0:
  v_pk_add_f32 v[56:57], v[56:57], v[60:61]
  v_pk_add_f32 v[58:59], v[58:59], v[62:63]
  v_pk_add_f32 v[64:65], v[64:65], v[68:69]
  v_pk_add_f32 v[66:67], v[66:67], v[70:71]
  v_pk_add_f32 v[28:29], v[56:57], v[64:65]
  v_pk_add_f32 v[30:31], v[58:59], v[66:67]

L_recFa_pgX:
  s_nop 0
  v_add_f32_dpp v28, v28, v28 row_ror:8 row_mask:0xf bank_mask:0xf
  v_add_f32_dpp v29, v29, v29 row_ror:8 row_mask:0xf bank_mask:0xf
  v_add_f32_dpp v30, v30, v30 row_ror:8 row_mask:0xf bank_mask:0xf
  v_add_f32_dpp v31, v31, v31 row_ror:8 row_mask:0xf bank_mask:0xf
  v_mov_b32 v32, v28
  v_mov_b32 v33, v29
  v_mov_b32 v34, v30
  v_mov_b32 v35, v31
  s_nop 0
  v_permlane16_swap_b32 v28, v32
  v_permlane16_swap_b32 v29, v33
  v_permlane16_swap_b32 v30, v34
  v_permlane16_swap_b32 v31, v35
  v_pk_add_f32 v[28:29], v[28:29], v[32:33]
  v_pk_add_f32 v[30:31], v[30:31], v[34:35]
  v_mov_b32 v32, v28
  v_mov_b32 v33, v29
  v_mov_b32 v34, v30
  v_mov_b32 v35, v31
  s_nop 0
  v_permlane32_swap_b32 v28, v32
  v_permlane32_swap_b32 v29, v33
  v_permlane32_swap_b32 v30, v34
  v_permlane32_swap_b32 v31, v35
  v_pk_add_f32 v[28:29], v[28:29], v[32:33]
  v_pk_add_f32 v[30:31], v[30:31], v[34:35]
  v_cvt_pk_bf16_f32 v28, v28, v29
  v_cvt_pk_bf16_f32 v29, v30, v31
  buffer_store_dwordx2 v[28:29], v16, s[4:7], s73 offen
  buffer_store_dwordx2 v[20:21], v16, s[4:7], s74 offen
  s_xor_b32 s71, s71, 3
  v_xor_b32 v1, 3, v1
  s_mov_b32 s34, s75
  s_mov_b32 s75, s74
  s_mov_b32 s74, s73
  s_mov_b32 s73, s34

  s_add_u32 s19, s19, 1
  s_cmp_lt_u32 s19, 63
  s_cbranch_scc1 L_recF_loop

  s_mov_b32 s62, 0
  s_waitcnt vmcnt(2)
  v_mov_b32 v56, 0
  v_mov_b32 v57, 0
  v_mov_b32 v58, 0
  v_mov_b32 v59, 0
  v_mov_b32 v60, 0
  v_mov_b32 v61, 0
  v_mov_b32 v62, 0
  v_mov_b32 v63, 0
  v_mov_b32 v64, 0
  v_mov_b32 v65, 0
  v_mov_b32 v66, 0
  v_mov_b32 v67, 0
  v_mov_b32 v68, 0
  v_mov_b32 v69, 0
  v_mov_b32 v70, 0
  v_mov_b32 v71, 0
  v_mov_b32 v72, 0
  v_mov_b32 v73, 0
  v_mov_b32 v74, 0
  v_mov_b32 v75, 0
  v_mov_b32 v76, 0
  v_mov_b32 v77, 0
  v_mov_b32 v78, 0
  v_mov_b32 v79, 0
  v_mov_b32 v112, v96
  v_mov_b32 v113, v97
  v_mov_b32 v114, v98
  v_mov_b32 v115, v99
  v_mov_b32 v116, v100
  v_mov_b32 v117, v101
  v_mov_b32 v118, v102
  v_mov_b32 v119, v103
  v_xor_b32 v19, 8192, v19
  buffer_load_dwordx4 v[120:123], v2, s[4:7], s74 offen sc1
  buffer_load_dwordx4 v[124:127], v2, s[4:7], s74 offen offset:1024 sc1
L_recFb_pa:
  s_waitcnt vmcnt(0)
  v_max3_u32 v24, v120, v121, v122
  v_max3_u32 v24, v24, v123, v124
  v_max3_u32 v24, v24, v125, v126
  v_max_u32 v24, v24, v127
  v_cmp_eq_u32 vcc, -1, v24
  s_cbranch_vccz L_recFb_pa0

  buffer_load_dwordx4 v[120:123], v2, s[4:7], s74 offen sc1
  buffer_load_dwordx4 v[124:127], v2, s[4:7], s74 offen offset:1024 sc1
  s_add_u32 s62, s62, 1
  s_cmp_gt_u32 s62, 0x40000
  s_cbranch_scc1 L_rec_end
  s_branch L_recFb_pa

L_recFb_pa0:
  ds_write_b128 v13, v[120:123]
  ds_write_b128 v13, v[124:127] offset:1040
L_recFb_paX:
  s_waitcnt lgkmcnt(0)
  s_barrier
  ds_read_b128 v[24:27], v17 offset:0
  ds_read_b128 v[28:31], v17 offset:128
  ds_read_b128 v[32:35], v17 offset:256
  s_and_b32 s34, s19, 3
  s_cbranch_scc1 L_pub_17
  s_cmp_eq_u32 s19, 0
  s_cbranch_scc1 L_pub_17
  s_cmp_lg_u32 s18, 0
  s_cbranch_scc1 L_pub_17
  s_lshl_b32 s34, s19, 5
  s_lshl_b32 s35, s16, 2
  s_add_u32 s34, s34, s35
  s_add_u32 s34, s34, 98631552
  v_mov_b32 v126, s34
  v_mov_b32 v127, s69
  s_mov_b64 exec, 1
  buffer_store_dword v127, v126, s[4:7], 0 offen sc1
  s_mov_b64 exec, -1

L_pub_17:
  s_waitcnt lgkmcnt(2)
  v_smfmac_f32_16x16x64_bf16 v[56:59], v[24:27], a[0:7], v18
  v_smfmac_f32_16x16x64_bf16 v[60:63], v[24:27], a[64:71], v18
  ds_read_b128 v[36:39], v17 offset:384
  v_smfmac_f32_16x16x64_bf16 v[64:67], v[24:27], a[128:135], v18
  v_smfmac_f32_16x16x64_bf16 v[68:71], v[24:27], a[192:199], v18
  v_smfmac_f32_16x16x64_bf16 v[72:75], v[24:27], v[128:135], v18
  v_smfmac_f32_16x16x64_bf16 v[76:79], v[24:27], v[192:199], v18
  s_waitcnt lgkmcnt(2)
  v_smfmac_f32_16x16x64_bf16 v[56:59], v[28:31], a[8:15], v18
  v_smfmac_f32_16x16x64_bf16 v[60:63], v[28:31], a[72:79], v18
  ds_read_b128 v[40:43], v17 offset:512
  v_smfmac_f32_16x16x64_bf16 v[64:67], v[28:31], a[136:143], v18
  v_smfmac_f32_16x16x64_bf16 v[68:71], v[28:31], a[200:207], v18
  v_smfmac_f32_16x16x64_bf16 v[72:75], v[28:31], v[136:143], v18
  v_smfmac_f32_16x16x64_bf16 v[76:79], v[28:31], v[200:207], v18
  s_waitcnt lgkmcnt(2)
  v_smfmac_f32_16x16x64_bf16 v[56:59], v[32:35], a[16:23], v18
  v_smfmac_f32_16x16x64_bf16 v[60:63], v[32:35], a[80:87], v18
  ds_read_b128 v[44:47], v17 offset:640
  v_smfmac_f32_16x16x64_bf16 v[64:67], v[32:35], a[144:151], v18
  v_smfmac_f32_16x16x64_bf16 v[68:71], v[32:35], a[208:215], v18
  v_smfmac_f32_16x16x64_bf16 v[72:75], v[32:35], v[144:151], v18
  v_smfmac_f32_16x16x64_bf16 v[76:79], v[32:35], v[208:215], v18
  s_waitcnt lgkmcnt(2)
  v_smfmac_f32_16x16x64_bf16 v[56:59], v[36:39], a[24:31], v18
  v_smfmac_f32_16x16x64_bf16 v[60:63], v[36:39], a[88:95], v18
  ds_read_b128 v[48:51], v17 offset:768
  v_smfmac_f32_16x16x64_bf16 v[64:67], v[36:39], a[152:159], v18
  v_smfmac_f32_16x16x64_bf16 v[68:71], v[36:39], a[216:223], v18
  v_smfmac_f32_16x16x64_bf16 v[72:75], v[36:39], v[152:159], v18
  v_smfmac_f32_16x16x64_bf16 v[76:79], v[36:39], v[216:223], v18
  s_waitcnt lgkmcnt(2)
  v_smfmac_f32_16x16x64_bf16 v[56:59], v[40:43], a[32:39], v18
  v_smfmac_f32_16x16x64_bf16 v[60:63], v[40:43], a[96:103], v18
  ds_read_b128 v[52:55], v17 offset:896
  v_smfmac_f32_16x16x64_bf16 v[64:67], v[40:43], a[160:167], v18
  v_smfmac_f32_16x16x64_bf16 v[68:71], v[40:43], a[224:231], v18
  v_smfmac_f32_16x16x64_bf16 v[72:75], v[40:43], v[160:167], v18
  v_smfmac_f32_16x16x64_bf16 v[76:79], v[40:43], v[224:231], v18
  s_waitcnt lgkmcnt(2)
  v_smfmac_f32_16x16x64_bf16 v[56:59], v[44:47], a[40:47], v18
  v_smfmac_f32_16x16x64_bf16 v[60:63], v[44:47], a[104:111], v18
  v_smfmac_f32_16x16x64_bf16 v[64:67], v[44:47], a[168:175], v18
  v_smfmac_f32_16x16x64_bf16 v[68:71], v[44:47], a[232:239], v18
  v_smfmac_f32_16x16x64_bf16 v[72:75], v[44:47], v[168:175], v18
  v_smfmac_f32_16x16x64_bf16 v[76:79], v[44:47], v[232:239], v18
  s_waitcnt lgkmcnt(1)
  v_smfmac_f32_16x16x64_bf16 v[56:59], v[48:51], a[48:55], v18
  v_smfmac_f32_16x16x64_bf16 v[60:63], v[48:51], a[112:119], v18
  v_smfmac_f32_16x16x64_bf16 v[64:67], v[48:51], a[176:183], v18
  v_smfmac_f32_16x16x64_bf16 v[68:71], v[48:51], a[240:247], v18
  v_smfmac_f32_16x16x64_bf16 v[72:75], v[48:51], v[176:183], v18
  v_smfmac_f32_16x16x64_bf16 v[76:79], v[48:51], v[240:247], v18
  s_waitcnt lgkmcnt(0)
  v_smfmac_f32_16x16x64_bf16 v[56:59], v[52:55], a[56:63], v18
  v_smfmac_f32_16x16x64_bf16 v[60:63], v[52:55], a[120:127], v18
  v_smfmac_f32_16x16x64_bf16 v[64:67], v[52:55], a[184:191], v18
  v_smfmac_f32_16x16x64_bf16 v[68:71], v[52:55], a[248:255], v18
  v_smfmac_f32_16x16x64_bf16 v[72:75], v[52:55], v[184:191], v18
  v_smfmac_f32_16x16x64_bf16 v[76:79], v[52:55], v[248:255], v18
  s_nop 4
  v_permlane32_swap_b32 v56, v60
  v_permlane32_swap_b32 v57, v61
  v_permlane32_swap_b32 v58, v62
  v_permlane32_swap_b32 v59, v63
  v_pk_add_f32 v[56:57], v[56:57], v[60:61]
  v_pk_add_f32 v[58:59], v[58:59], v[62:63]
  v_cvt_pk_bf16_f32 v56, v56, v57
  v_cvt_pk_bf16_f32 v57, v58, v59
  ds_write_b64 v8, v[56:57] offset:0
  v_permlane32_swap_b32 v64, v68
  v_permlane32_swap_b32 v65, v69
  v_permlane32_swap_b32 v66, v70
  v_permlane32_swap_b32 v67, v71
  v_pk_add_f32 v[64:65], v[64:65], v[68:69]
  v_pk_add_f32 v[66:67], v[66:67], v[70:71]
  v_cvt_pk_bf16_f32 v64, v64, v65
  v_cvt_pk_bf16_f32 v65, v66, v67
  ds_write_b64 v8, v[64:65] offset:2176
  v_permlane32_swap_b32 v72, v76
  v_permlane32_swap_b32 v73, v77
  v_permlane32_swap_b32 v74, v78
  v_permlane32_swap_b32 v75, v79
  v_pk_add_f32 v[72:73], v[72:73], v[76:77]
  v_pk_add_f32 v[74:75], v[74:75], v[78:79]
  v_cvt_pk_bf16_f32 v72, v72, v73
  v_cvt_pk_bf16_f32 v73, v74, v75
  buffer_store_dwordx2 v[72:73], v7, s[4:7], s53 offen sc1
  v_mov_b32 v76, 0
  v_mov_b32 v77, 0
  v_mov_b32 v78, 0
  v_mov_b32 v79, 0
  v_mov_b32 v74, 0
  v_mov_b32 v75, 0
  s_waitcnt lgkmcnt(0)
  s_barrier

  ds_read_b64_tr_b16 v[40:41], v9 offset:2176
  ds_read_b64_tr_b16 v[42:43], v9 offset:2240
  ds_read_b64_tr_b16 v[44:45], v9 offset:2688
  ds_read_b64_tr_b16 v[46:47], v9 offset:2752
  ds_read_b64_tr_b16 v[48:49], v9 offset:3200
  ds_read_b64_tr_b16 v[50:51], v9 offset:3264
  ds_read_b64_tr_b16 v[52:53], v9 offset:3712
  ds_read_b64_tr_b16 v[54:55], v9 offset:3776
  v_permlane32_swap_b32 v72, v76
  v_permlane32_swap_b32 v73, v77
  s_waitcnt lgkmcnt(0)
  s_cmp_eq_u32 s18, 0
  s_cbranch_scc1 L_km_18
  s_cmp_eq_u32 s18, 1
  s_cbranch_scc1 L_km_19
  s_cmp_eq_u32 s18, 2
  s_cbranch_scc1 L_km_20
  buffer_store_dwordx4 v[52:55], v6, s[4:7], s53 offen sc1
  s_branch L_kmd_22
L_km_20:
  buffer_store_dwordx4 v[48:51], v6, s[4:7], s53 offen sc1
  s_branch L_kmd_22
L_km_19:
  buffer_store_dwordx4 v[44:47], v6, s[4:7], s53 offen sc1
  s_branch L_kmd_22
L_km_18:
  buffer_store_dwordx4 v[40:43], v6, s[4:7], s53 offen sc1
L_kmd_22:
  s_waitcnt vmcnt(0)
  s_barrier
  s_mov_b32 s19, 64
  s_cmp_lg_u32 s18, 0
  s_cbranch_scc1 L_pub_23
  s_lshl_b32 s34, s19, 5
  s_lshl_b32 s35, s16, 2
  s_add_u32 s34, s34, s35
  s_add_u32 s34, s34, 98631552
  v_mov_b32 v126, s34
  v_mov_b32 v127, s69
  s_mov_b64 exec, 1
  buffer_store_dword v127, v126, s[4:7], 0 offen sc1
  s_mov_b64 exec, -1

L_pub_23:
  s_waitcnt vmcnt(0)
  s_branch L_rec_end
L_recF_entry0:
  s_branch L_recFa_pa0
  s_branch L_recS_entry0
L_recS_loop:
  s_mov_b32 s62, 0
  s_waitcnt vmcnt(2)
  v_mov_b32 v56, 0
  v_mov_b32 v57, 0
  v_mov_b32 v58, 0
  v_mov_b32 v59, 0
  v_mov_b32 v60, 0
  v_mov_b32 v61, 0
  v_mov_b32 v62, 0
  v_mov_b32 v63, 0
  v_mov_b32 v64, 0
  v_mov_b32 v65, 0
  v_mov_b32 v66, 0
  v_mov_b32 v67, 0
  v_mov_b32 v68, 0
  v_mov_b32 v69, 0
  v_mov_b32 v70, 0
  v_mov_b32 v71, 0
  v_mov_b32 v72, 0
  v_mov_b32 v73, 0
  v_mov_b32 v74, 0
  v_mov_b32 v75, 0
  v_mov_b32 v76, 0
  v_mov_b32 v77, 0
  v_mov_b32 v78, 0
  v_mov_b32 v79, 0
  v_mov_b32 v112, v96
  v_mov_b32 v113, v97
  v_mov_b32 v114, v98
  v_mov_b32 v115, v99
  v_mov_b32 v116, v100
  v_mov_b32 v117, v101
  v_mov_b32 v118, v102
  v_mov_b32 v119, v103
  v_xor_b32 v19, 8192, v19
  buffer_load_dwordx4 v[120:123], v2, s[4:7], s74 offen sc1
  buffer_load_dwordx4 v[124:127], v2, s[4:7], s74 offen offset:1024 sc1
L_recSa_pa:
  s_waitcnt vmcnt(0)
  v_max3_u32 v24, v120, v121, v122
  v_max3_u32 v24, v24, v123, v124
  v_max3_u32 v24, v24, v125, v126
  v_max_u32 v24, v24, v127
  v_cmp_eq_u32 vcc, -1, v24
  s_cbranch_vccz L_recSa_pa0

  buffer_load_dwordx4 v[120:123], v2, s[4:7], s74 offen sc1
  buffer_load_dwordx4 v[124:127], v2, s[4:7], s74 offen offset:1024 sc1
  s_add_u32 s62, s62, 1
  s_cmp_gt_u32 s62, 0x40000
  s_cbranch_scc1 L_rec_end
  s_branch L_recSa_pa

L_recSa_pa0:
  ds_write_b128 v13, v[120:123]
  ds_write_b128 v13, v[124:127] offset:1040
L_recSa_paX:
  s_waitcnt lgkmcnt(0)
  s_barrier
  ds_read_b128 v[24:27], v17 offset:0
  ds_read_b128 v[28:31], v17 offset:128
  ds_read_b128 v[32:35], v17 offset:256
  s_and_b32 s34, s19, 3
  s_cbranch_scc1 L_pub_24
  s_cmp_eq_u32 s19, 0
  s_cbranch_scc1 L_pub_24
  s_cmp_lg_u32 s18, 0
  s_cbranch_scc1 L_pub_24
  s_lshl_b32 s34, s19, 5
  s_lshl_b32 s35, s16, 2
  s_add_u32 s34, s34, s35
  s_add_u32 s34, s34, 98631552
  v_mov_b32 v126, s34
  v_mov_b32 v127, s69
  s_mov_b64 exec, 1
  buffer_store_dword v127, v126, s[4:7], 0 offen sc1
  s_mov_b64 exec, -1

L_pub_24:
  s_add_u32 s34, s19, 1
  s_and_b32 s34, s34, 3
  s_cbranch_scc1 L_kvs_25
  s_cmp_lt_u32 s76, s72
  s_cbranch_scc1 L_kvk_27
  v_mbcnt_lo_u32_b32 v126, -1, 0
  v_mbcnt_hi_u32_b32 v126, -1, v126
  v_lshlrev_b32 v126, 9, v126
  s_lshl_b32 s34, s16, 4
  s_add_u32 s34, s34, 98566148
  v_add_u32 v126, s34, v126
  s_mov_b32 s62, 0
  s_mov_b64 exec, 0xffff

L_kvl_26:
  buffer_load_dwordx2 v[124:125], v126, s[4:7], 0 offen sc1
  s_waitcnt vmcnt(0)
  v_cmp_eq_u32 vcc, s69, v124
  v_cmp_eq_u32 s[34:35], s69, v125
  s_nop 3
  s_and_b64 s[34:35], s[34:35], vcc
  s_ff0_i32_b64 s72, s[34:35]
  s_add_u32 s62, s62, 1
  s_cmp_gt_u32 s62, 0x80000
  s_cbranch_scc1 L_rec_end
  s_cmp_lt_u32 s76, s72
  s_cbranch_scc0 L_kvl_26
  s_mov_b64 exec, -1

L_kvk_27:
  s_add_u32 s76, s76, 1
L_kvs_25:
  s_cmp_ge_u32 s19, 62
  s_cbranch_scc1 L_nopf_28
  s_add_u32 m0, s77, 0
  s_nop 0
  buffer_load_dwordx4 v3, s[4:7], s51 offen sc1 lds
  s_add_u32 m0, s77, 4096
  s_nop 0
  buffer_load_dwordx4 v4, s[4:7], s51 offen sc1 lds
  s_xor_b32 s77, s77, 8192
  buffer_load_dwordx4 v[96:99], v5, s[4:7], s51 offen sc1
  buffer_load_dwordx4 v[100:103], v5, s[4:7], s51 offen offset:1024 sc1
  s_add_u32 s51, s51, 262144
L_nopf_28:
  s_waitcnt lgkmcnt(2)
  v_smfmac_f32_16x16x64_bf16 v[56:59], v[24:27], a[0:7], v18
  v_smfmac_f32_16x16x64_bf16 v[60:63], v[24:27], a[64:71], v18
  ds_read_b128 v[36:39], v17 offset:384
  v_smfmac_f32_16x16x64_bf16 v[64:67], v[24:27], a[128:135], v18
  v_smfmac_f32_16x16x64_bf16 v[68:71], v[24:27], a[192:199], v18
  v_smfmac_f32_16x16x64_bf16 v[72:75], v[24:27], v[128:135], v18
  v_smfmac_f32_16x16x64_bf16 v[76:79], v[24:27], v[192:199], v18
  s_waitcnt lgkmcnt(2)
  v_smfmac_f32_16x16x64_bf16 v[56:59], v[28:31], a[8:15], v18
  v_smfmac_f32_16x16x64_bf16 v[60:63], v[28:31], a[72:79], v18
  ds_read_b128 v[40:43], v17 offset:512
  v_smfmac_f32_16x16x64_bf16 v[64:67], v[28:31], a[136:143], v18
  v_smfmac_f32_16x16x64_bf16 v[68:71], v[28:31], a[200:207], v18
  v_smfmac_f32_16x16x64_bf16 v[72:75], v[28:31], v[136:143], v18
  v_smfmac_f32_16x16x64_bf16 v[76:79], v[28:31], v[200:207], v18
  s_waitcnt lgkmcnt(2)
  v_smfmac_f32_16x16x64_bf16 v[56:59], v[32:35], a[16:23], v18
  v_smfmac_f32_16x16x64_bf16 v[60:63], v[32:35], a[80:87], v18
  ds_read_b128 v[44:47], v17 offset:640
  v_smfmac_f32_16x16x64_bf16 v[64:67], v[32:35], a[144:151], v18
  v_smfmac_f32_16x16x64_bf16 v[68:71], v[32:35], a[208:215], v18
  v_smfmac_f32_16x16x64_bf16 v[72:75], v[32:35], v[144:151], v18
  v_smfmac_f32_16x16x64_bf16 v[76:79], v[32:35], v[208:215], v18
  s_waitcnt lgkmcnt(2)
  v_smfmac_f32_16x16x64_bf16 v[56:59], v[36:39], a[24:31], v18
  v_smfmac_f32_16x16x64_bf16 v[60:63], v[36:39], a[88:95], v18
  ds_read_b128 v[48:51], v17 offset:768
  v_smfmac_f32_16x16x64_bf16 v[64:67], v[36:39], a[152:159], v18
  v_smfmac_f32_16x16x64_bf16 v[68:71], v[36:39], a[216:223], v18
  v_smfmac_f32_16x16x64_bf16 v[72:75], v[36:39], v[152:159], v18
  v_smfmac_f32_16x16x64_bf16 v[76:79], v[36:39], v[216:223], v18
  s_waitcnt lgkmcnt(2)
  v_smfmac_f32_16x16x64_bf16 v[56:59], v[40:43], a[32:39], v18
  v_smfmac_f32_16x16x64_bf16 v[60:63], v[40:43], a[96:103], v18
  ds_read_b128 v[52:55], v17 offset:896
  v_smfmac_f32_16x16x64_bf16 v[64:67], v[40:43], a[160:167], v18
  v_smfmac_f32_16x16x64_bf16 v[68:71], v[40:43], a[224:231], v18
  v_smfmac_f32_16x16x64_bf16 v[72:75], v[40:43], v[160:167], v18
  v_smfmac_f32_16x16x64_bf16 v[76:79], v[40:43], v[224:231], v18
  s_waitcnt lgkmcnt(2)
  v_smfmac_f32_16x16x64_bf16 v[56:59], v[44:47], a[40:47], v18
  v_smfmac_f32_16x16x64_bf16 v[60:63], v[44:47], a[104:111], v18
  v_smfmac_f32_16x16x64_bf16 v[64:67], v[44:47], a[168:175], v18
  v_smfmac_f32_16x16x64_bf16 v[68:71], v[44:47], a[232:239], v18
  ds_read_b128 v[80:83], v19 offset:0
  ds_read_b128 v[84:87], v19 offset:4096
  v_smfmac_f32_16x16x64_bf16 v[72:75], v[44:47], v[168:175], v18
  v_smfmac_f32_16x16x64_bf16 v[76:79], v[44:47], v[232:239], v18
  s_waitcnt lgkmcnt(1)
  v_smfmac_f32_16x16x64_bf16 v[56:59], v[48:51], a[48:55], v18
  v_smfmac_f32_16x16x64_bf16 v[60:63], v[48:51], a[112:119], v18
  v_smfmac_f32_16x16x64_bf16 v[64:67], v[48:51], a[176:183], v18
  v_smfmac_f32_16x16x64_bf16 v[68:71], v[48:51], a[240:247], v18
  ds_read_b128 v[88:91], v19 offset:1024
  ds_read_b128 v[92:95], v19 offset:5120
  v_smfmac_f32_16x16x64_bf16 v[72:75], v[48:51], v[176:183], v18
  v_smfmac_f32_16x16x64_bf16 v[76:79], v[48:51], v[240:247], v18
  s_waitcnt lgkmcnt(0)
  v_smfmac_f32_16x16x64_bf16 v[56:59], v[52:55], a[56:63], v18
  v_smfmac_f32_16x16x64_bf16 v[60:63], v[52:55], a[120:127], v18
  v_smfmac_f32_16x16x64_bf16 v[64:67], v[52:55], a[184:191], v18
  v_smfmac_f32_16x16x64_bf16 v[68:71], v[52:55], a[248:255], v18
  v_smfmac_f32_16x16x64_bf16 v[72:75], v[52:55], v[184:191], v18
  v_smfmac_f32_16x16x64_bf16 v[76:79], v[52:55], v[248:255], v18
  s_nop 4
  v_permlane32_swap_b32 v56, v60
  v_permlane32_swap_b32 v57, v61
  v_permlane32_swap_b32 v58, v62
  v_permlane32_swap_b32 v59, v63
  v_pk_add_f32 v[56:57], v[56:57], v[60:61]
  v_pk_add_f32 v[58:59], v[58:59], v[62:63]
  v_cvt_pk_bf16_f32 v56, v56, v57
  v_cvt_pk_bf16_f32 v57, v58, v59
  ds_write_b64 v8, v[56:57] offset:0
  v_permlane32_swap_b32 v64, v68
  v_permlane32_swap_b32 v65, v69
  v_permlane32_swap_b32 v66, v70
  v_permlane32_swap_b32 v67, v71
  v_pk_add_f32 v[64:65], v[64:65], v[68:69]
  v_pk_add_f32 v[66:67], v[66:67], v[70:71]
  v_cvt_pk_bf16_f32 v64, v64, v65
  v_cvt_pk_bf16_f32 v65, v66, v67
  ds_write_b64 v8, v[64:65] offset:2176
  v_permlane32_swap_b32 v72, v76
  v_permlane32_swap_b32 v73, v77
  v_permlane32_swap_b32 v74, v78
  v_permlane32_swap_b32 v75, v79
  v_pk_add_f32 v[72:73], v[72:73], v[76:77]
  v_pk_add_f32 v[74:75], v[74:75], v[78:79]
  v_cvt_pk_bf16_f32 v72, v72, v73
  v_cvt_pk_bf16_f32 v73, v74, v75
  buffer_store_dwordx2 v[72:73], v7, s[4:7], s53 offen sc1
  v_mov_b32 v76, 0
  v_mov_b32 v77, 0
  v_mov_b32 v78, 0
  v_mov_b32 v79, 0
  v_mov_b32 v74, 0
  v_mov_b32 v75, 0
  s_waitcnt lgkmcnt(0)
  s_barrier

  ds_read_b64_tr_b16 v[24:25], v9 offset:0
  ds_read_b64_tr_b16 v[26:27], v9 offset:64
  ds_read_b64_tr_b16 v[40:41], v9 offset:2176
  ds_read_b64_tr_b16 v[42:43], v9 offset:2240
  ds_read_b64_tr_b16 v[28:29], v9 offset:512
  ds_read_b64_tr_b16 v[30:31], v9 offset:576
  ds_read_b64_tr_b16 v[44:45], v9 offset:2688
  ds_read_b64_tr_b16 v[46:47], v9 offset:2752
  ds_read_b64_tr_b16 v[32:33], v9 offset:1024
  ds_read_b64_tr_b16 v[34:35], v9 offset:1088
  ds_read_b64_tr_b16 v[48:49], v9 offset:3200
  ds_read_b64_tr_b16 v[50:51], v9 offset:3264
  ds_read_b64_tr_b16 v[36:37], v9 offset:1536
  ds_read_b64_tr_b16 v[38:39], v9 offset:1600
  ds_read_b64_tr_b16 v[52:53], v9 offset:3712
  ds_read_b64_tr_b16 v[54:55], v9 offset:3776
  v_permlane32_swap_b32 v72, v76
  v_permlane32_swap_b32 v73, v77
  s_waitcnt lgkmcnt(12)
  v_mfma_f32_16x16x32_bf16 v[56:59], v[40:43], v[24:27], 0
  v_mfma_f32_16x16x32_bf16 v[60:63], v[80:83], v[24:27], 0
  v_mfma_f32_16x16x32_bf16 v[64:67], v[84:87], v[24:27], 0
  ds_read_b128 v[80:83], v19 offset:2048
  ds_read_b128 v[84:87], v19 offset:6144
  s_waitcnt lgkmcnt(10)
  v_mfma_f32_16x16x32_bf16 v[56:59], v[44:47], v[28:31], v[56:59]
  v_mfma_f32_16x16x32_bf16 v[60:63], v[88:91], v[28:31], v[60:63]
  v_mfma_f32_16x16x32_bf16 v[64:67], v[92:95], v[28:31], v[64:67]
  ds_read_b128 v[88:91], v19 offset:3072
  ds_read_b128 v[92:95], v19 offset:7168
  s_waitcnt lgkmcnt(2)
  v_mfma_f32_16x16x32_bf16 v[56:59], v[48:51], v[32:35], v[56:59]
  v_mfma_f32_16x16x32_bf16 v[60:63], v[80:83], v[32:35], v[60:63]
  v_mfma_f32_16x16x32_bf16 v[64:67], v[84:87], v[32:35], v[64:67]
  s_waitcnt lgkmcnt(0)
  v_mfma_f32_16x16x32_bf16 v[56:59], v[52:55], v[36:39], v[56:59]
  v_mfma_f32_16x16x32_bf16 v[60:63], v[88:91], v[36:39], v[60:63]
  v_mfma_f32_16x16x32_bf16 v[64:67], v[92:95], v[36:39], v[64:67]
  s_cmp_eq_u32 s18, 0
  s_cbranch_scc1 L_km_29
  s_cmp_eq_u32 s18, 1
  s_cbranch_scc1 L_km_30
  s_cmp_eq_u32 s18, 2
  s_cbranch_scc1 L_km_31
  buffer_store_dwordx4 v[52:55], v6, s[4:7], s53 offen sc1
  s_branch L_kmd_33
L_km_31:
  buffer_store_dwordx4 v[48:51], v6, s[4:7], s53 offen sc1
  s_branch L_kmd_33
L_km_30:
  buffer_store_dwordx4 v[44:47], v6, s[4:7], s53 offen sc1
  s_branch L_kmd_33
L_km_29:
  buffer_store_dwordx4 v[40:43], v6, s[4:7], s53 offen sc1
L_kmd_33:
  s_add_u32 s53, s53, 65536
  s_nop 3
  v_mov_b32 v121, 0xf149f2ca
  v_cndmask_b32 v56, v121, v56, s[58:59]
  v_cndmask_b32 v57, v121, v57, s[58:59]
  v_cndmask_b32 v58, v121, v58, s[58:59]
  v_cndmask_b32 v59, v121, v59, s[58:59]
  v_max3_f32 v120, v60, v61, v62
  v_max3_f32 v121, v63, v64, v65
  v_max3_f32 v120, v120, v66, v67
  v_max3_f32 v121, v121, v56, v57
  v_max3_f32 v120, v120, v58, v59
  v_max_f32 v120, v120, v121
  v_mov_b32 v121, v120
  s_nop 1
  v_permlane16_swap_b32 v120, v121
  v_max_f32 v120, v120, v121
  v_mov_b32 v121, v120
  s_nop 1
  v_permlane32_swap_b32 v120, v121
  v_max_f32 v120, v120, v121
  v_mul_f32 v120, s68, v120

  v_fma_f32 v56, v56, s68, -v120
  v_fma_f32 v57, v57, s68, -v120
  v_fma_f32 v58, v58, s68, -v120
  v_fma_f32 v59, v59, s68, -v120
  v_fma_f32 v60, v60, s68, -v120
  v_fma_f32 v61, v61, s68, -v120
  v_fma_f32 v62, v62, s68, -v120
  v_fma_f32 v63, v63, s68, -v120
  v_fma_f32 v64, v64, s68, -v120
  v_fma_f32 v65, v65, s68, -v120
  v_fma_f32 v66, v66, s68, -v120
  v_fma_f32 v67, v67, s68, -v120
  v_exp_f32 v56, v56
  v_exp_f32 v57, v57
  v_exp_f32 v58, v58
  v_exp_f32 v59, v59
  v_exp_f32 v60, v60
  v_exp_f32 v61, v61
  v_exp_f32 v62, v62
  v_exp_f32 v63, v63
  v_exp_f32 v64, v64
  v_exp_f32 v65, v65
  v_exp_f32 v66, v66
  v_exp_f32 v67, v67
  s_nop 0
  v_add_f32 v122, v56, v57
  v_add_f32 v123, v58, v59
  v_cvt_pk_bf16_f32 v56, v56, v57
  v_cvt_pk_bf16_f32 v57, v58, v59
  v_mov_b32 v58, 0
  v_mov_b32 v59, 0
  v_add_f32 v122, v122, v60
  v_add_f32 v123, v123, v61
  v_add_f32 v122, v122, v62
  v_add_f32 v123, v123, v63
  v_cvt_pk_bf16_f32 v60, v60, v61
  v_cvt_pk_bf16_f32 v61, v62, v63
  v_add_f32 v122, v122, v64
  v_add_f32 v123, v123, v65
  v_add_f32 v122, v122, v66
  v_add_f32 v123, v123, v67
  v_cvt_pk_bf16_f32 v62, v64, v65
  v_cvt_pk_bf16_f32 v63, v66, v67
  v_add_f32 v122, v122, v123
  v_mov_b32 v123, v122

  v_mfma_f32_16x16x32_bf16 v[64:67], v[112:115], v[60:63], 0
  v_mfma_f32_16x16x32_bf16 v[68:71], v[116:119], v[60:63], 0
  v_mfma_f32_16x16x32_bf16 v[64:67], v[72:75], v[56:59], v[64:67]
  v_mfma_f32_16x16x32_bf16 v[68:71], v[76:79], v[56:59], v[68:71]
  v_permlane16_swap_b32 v122, v123
  v_add_f32 v122, v122, v123
  v_mov_b32 v123, v122
  s_nop 1
  v_permlane32_swap_b32 v122, v123
  v_add_f32 v122, v122, v123
  v_rcp_f32 v122, v122

  ds_read_b128 v[112:115], v12 offset:0
  ds_read_b128 v[116:119], v12 offset:1024
  v_mul_f32 v64, v64, v122
  v_mul_f32 v65, v65, v122
  v_mul_f32 v66, v66, v122
  v_mul_f32 v67, v67, v122
  v_mul_f32 v68, v68, v122
  v_mul_f32 v69, v69, v122
  v_mul_f32 v70, v70, v122
  v_mul_f32 v71, v71, v122
  v_cvt_pk_bf16_f32 v64, v64, v65
  v_cvt_pk_bf16_f32 v65, v66, v67
  v_cvt_pk_bf16_f32 v66, v68, v69
  v_cvt_pk_bf16_f32 v67, v70, v71
  ds_write_b128 v10, v[64:67]

  ds_read_b128 v[72:75], v12 offset:2048
  ds_read_b128 v[76:79], v12 offset:3072
  ds_read_b128 v[124:127], v12 offset:4096
  ds_read_b128 v[104:107], v12 offset:5120
  s_waitcnt lgkmcnt(0)
  s_barrier
  ds_read_b128 v[56:59], v11 offset:0
  ds_read_b128 v[60:63], v11 offset:1024
  ds_read_b128 v[64:67], v11 offset:2048
  ds_read_b128 v[68:71], v11 offset:3072
  s_waitcnt lgkmcnt(0)
  v_mfma_f32_16x16x32_bf16 v[24:27], v[112:115], v[56:59], 0
  ds_read_b128 v[108:111], v12 offset:6144
  v_mfma_f32_16x16x32_bf16 v[24:27], v[116:119], v[60:63], v[24:27]
  ds_read_b128 v[112:115], v12 offset:7168
  v_mfma_f32_16x16x32_bf16 v[24:27], v[72:75], v[64:67], v[24:27]
  ds_read_b128 v[116:119], v12 offset:8192
  v_mfma_f32_16x16x32_bf16 v[24:27], v[76:79], v[68:71], v[24:27]
  ds_read_b128 v[72:75], v12 offset:9216
  v_mfma_f32_16x16x32_bf16 v[28:31], v[124:127], v[56:59], 0
  ds_read_b128 v[76:79], v12 offset:10240
  v_mfma_f32_16x16x32_bf16 v[28:31], v[104:107], v[60:63], v[28:31]
  ds_read_b128 v[124:127], v12 offset:11264
  s_waitcnt lgkmcnt(5)
  v_mfma_f32_16x16x32_bf16 v[28:31], v[108:111], v[64:67], v[28:31]
  ds_read_b128 v[104:107], v12 offset:12288
  s_waitcnt lgkmcnt(5)
  v_mfma_f32_16x16x32_bf16 v[28:31], v[112:115], v[68:71], v[28:31]
  ds_read_b128 v[108:111], v12 offset:13312
  s_waitcnt lgkmcnt(5)
  v_mfma_f32_16x16x32_bf16 v[32:35], v[116:119], v[56:59], 0
  ds_read_b128 v[112:115], v12 offset:14336
  s_waitcnt lgkmcnt(5)
  v_mfma_f32_16x16x32_bf16 v[32:35], v[72:75], v[60:63], v[32:35]
  ds_read_b128 v[116:119], v12 offset:15360
  s_waitcnt lgkmcnt(5)
  v_mfma_f32_16x16x32_bf16 v[32:35], v[76:79], v[64:67], v[32:35]
  ds_read_b128 v[72:75], v12 offset:16384
  s_waitcnt lgkmcnt(5)
  v_mfma_f32_16x16x32_bf16 v[32:35], v[124:127], v[68:71], v[32:35]
  ds_read_b128 v[76:79], v12 offset:17408
  s_waitcnt lgkmcnt(5)
  v_mfma_f32_16x16x32_bf16 v[36:39], v[104:107], v[56:59], 0
  ds_read_b128 v[124:127], v12 offset:18432
  s_waitcnt lgkmcnt(5)
  v_mfma_f32_16x16x32_bf16 v[36:39], v[108:111], v[60:63], v[36:39]
  ds_read_b128 v[104:107], v12 offset:19456
  s_waitcnt lgkmcnt(5)
  v_mfma_f32_16x16x32_bf16 v[36:39], v[112:115], v[64:67], v[36:39]
  ds_read_b128 v[108:111], v12 offset:20480
  s_waitcnt lgkmcnt(5)
  v_mfma_f32_16x16x32_bf16 v[36:39], v[116:119], v[68:71], v[36:39]
  ds_read_b128 v[112:115], v12 offset:21504
  v_mov_b32_dpp v24, v28 row_shr:8 row_mask:0xf bank_mask:0xc
  v_mov_b32_dpp v25, v29 row_shr:8 row_mask:0xf bank_mask:0xc
  v_mov_b32_dpp v26, v30 row_shr:8 row_mask:0xf bank_mask:0xc
  v_mov_b32_dpp v27, v31 row_shr:8 row_mask:0xf bank_mask:0xc
  v_and_or_b32 v24, v24, -4, v1
  v_and_or_b32 v25, v25, -4, v1
  v_and_or_b32 v26, v26, -4, v1
  v_and_or_b32 v27, v27, -4, v1
  s_mov_b32 s34, 0
  buffer_store_dwordx4 v[24:27], v14, s[4:7], s34 offen sc1
  s_waitcnt lgkmcnt(5)
  v_mfma_f32_16x16x32_bf16 v[40:43], v[72:75], v[56:59], 0
  ds_read_b128 v[116:119], v12 offset:22528
  s_waitcnt lgkmcnt(5)
  v_mfma_f32_16x16x32_bf16 v[40:43], v[76:79], v[60:63], v[40:43]
  ds_read_b128 v[72:75], v12 offset:23552
  s_waitcnt lgkmcnt(5)
  v_mfma_f32_16x16x32_bf16 v[40:43], v[124:127], v[64:67], v[40:43]
  ds_read_b128 v[76:79], v12 offset:24576
  s_waitcnt lgkmcnt(5)
  v_mfma_f32_16x16x32_bf16 v[40:43], v[104:107], v[68:71], v[40:43]
  ds_read_b128 v[124:127], v12 offset:25600
  s_waitcnt lgkmcnt(5)
  v_mfma_f32_16x16x32_bf16 v[44:47], v[108:111], v[56:59], 0
  ds_read_b128 v[104:107], v12 offset:26624
  s_waitcnt lgkmcnt(5)
  v_mfma_f32_16x16x32_bf16 v[44:47], v[112:115], v[60:63], v[44:47]
  ds_read_b128 v[108:111], v12 offset:27648
  s_waitcnt lgkmcnt(5)
  v_mfma_f32_16x16x32_bf16 v[44:47], v[116:119], v[64:67], v[44:47]
  ds_read_b128 v[112:115], v12 offset:28672
  s_waitcnt lgkmcnt(5)
  v_mfma_f32_16x16x32_bf16 v[44:47], v[72:75], v[68:71], v[44:47]
  ds_read_b128 v[116:119], v12 offset:29696
  v_mov_b32_dpp v32, v36 row_shr:8 row_mask:0xf bank_mask:0xc
  v_mov_b32_dpp v33, v37 row_shr:8 row_mask:0xf bank_mask:0xc
  v_mov_b32_dpp v34, v38 row_shr:8 row_mask:0xf bank_mask:0xc
  v_mov_b32_dpp v35, v39 row_shr:8 row_mask:0xf bank_mask:0xc
  v_and_or_b32 v32, v32, -4, v1
  v_and_or_b32 v33, v33, -4, v1
  v_and_or_b32 v34, v34, -4, v1
  v_and_or_b32 v35, v35, -4, v1
  s_mov_b32 s34, 32768
  buffer_store_dwordx4 v[32:35], v14, s[4:7], s34 offen sc1
  s_waitcnt lgkmcnt(5)
  v_mfma_f32_16x16x32_bf16 v[48:51], v[76:79], v[56:59], 0
  ds_read_b128 v[72:75], v12 offset:30720
  s_waitcnt lgkmcnt(5)
  v_mfma_f32_16x16x32_bf16 v[48:51], v[124:127], v[60:63], v[48:51]
  ds_read_b128 v[76:79], v12 offset:31744
  s_waitcnt lgkmcnt(5)
  v_mfma_f32_16x16x32_bf16 v[48:51], v[104:107], v[64:67], v[48:51]
  s_waitcnt lgkmcnt(4)
  v_mfma_f32_16x16x32_bf16 v[48:51], v[108:111], v[68:71], v[48:51]
  s_waitcnt lgkmcnt(3)
  v_mfma_f32_16x16x32_bf16 v[52:55], v[112:115], v[56:59], 0
  s_waitcnt lgkmcnt(2)
  v_mfma_f32_16x16x32_bf16 v[52:55], v[116:119], v[60:63], v[52:55]
  s_waitcnt lgkmcnt(1)
  v_mfma_f32_16x16x32_bf16 v[52:55], v[72:75], v[64:67], v[52:55]
  s_waitcnt lgkmcnt(0)
  v_mfma_f32_16x16x32_bf16 v[52:55], v[76:79], v[68:71], v[52:55]
  v_mov_b32_dpp v40, v44 row_shr:8 row_mask:0xf bank_mask:0xc
  v_mov_b32_dpp v41, v45 row_shr:8 row_mask:0xf bank_mask:0xc
  v_mov_b32_dpp v42, v46 row_shr:8 row_mask:0xf bank_mask:0xc
  v_mov_b32_dpp v43, v47 row_shr:8 row_mask:0xf bank_mask:0xc
  v_and_or_b32 v40, v40, -4, v1
  v_and_or_b32 v41, v41, -4, v1
  v_and_or_b32 v42, v42, -4, v1
  v_and_or_b32 v43, v43, -4, v1
  s_mov_b32 s34, 65536
  buffer_store_dwordx4 v[40:43], v14, s[4:7], s34 offen sc1
  s_nop 7
  v_mov_b32_dpp v48, v52 row_shr:8 row_mask:0xf bank_mask:0xc
  v_mov_b32_dpp v49, v53 row_shr:8 row_mask:0xf bank_mask:0xc
  v_mov_b32_dpp v50, v54 row_shr:8 row_mask:0xf bank_mask:0xc
  v_mov_b32_dpp v51, v55 row_shr:8 row_mask:0xf bank_mask:0xc
  v_and_or_b32 v48, v48, -4, v1
  v_and_or_b32 v49, v49, -4, v1
  v_and_or_b32 v50, v50, -4, v1
  v_and_or_b32 v51, v51, -4, v1
  s_mov_b32 s34, 98304
  buffer_store_dwordx4 v[48:51], v14, s[4:7], s34 offen sc1
  s_mov_b32 s62, 0
  s_add_u32 s34, s70, 4096
  s_add_u32 s35, s70, 8192
  s_add_u32 s36, s70, 12288
  s_sleep 6
  buffer_load_dwordx4 v[56:59], v15, s[4:7], s70 offen sc1
  buffer_load_dwordx4 v[60:63], v15, s[4:7], s34 offen sc1
  buffer_load_dwordx4 v[64:67], v15, s[4:7], s35 offen sc1
  buffer_load_dwordx4 v[68:71], v15, s[4:7], s36 offen sc1
L_recSa_pg:
  s_waitcnt vmcnt(0)
  v_or3_b32 v24, v56, v57, v58
  v_or3_b32 v25, v59, v60, v61
  v_or3_b32 v24, v24, v62, v63
  v_or3_b32 v25, v25, v64, v65
  v_or3_b32 v24, v24, v66, v67
  v_or3_b32 v25, v25, v68, v69
  v_or3_b32 v24, v24, v70, v71
  v_or_b32 v24, v24, v25
  v_and_b32 v24, s71, v24
  v_cmp_ne_u32 vcc, 0, v24
  s_cbranch_vccz L_recSa_pg0
  buffer_load_dwordx4 v[56:59], v15, s[4:7], s70 offen sc1
  buffer_load_dwordx4 v[60:63], v15, s[4:7], s34 offen sc1
  buffer_load_dwordx4 v[64:67], v15, s[4:7], s35 offen sc1
  buffer_load_dwordx4 v[68:71], v15, s[4:7], s36 offen sc1
  s_add_u32 s62, s62, 1
  s_cmp_gt_u32 s62, 0x40000
  s_cbranch_scc1 L_rec_end
  s_branch L_recSa_pg

L_recSa_pg0:
  v_pk_add_f32 v[56:57], v[56:57], v[60:61]
  v_pk_add_f32 v[58:59], v[58:59], v[62:63]
  v_pk_add_f32 v[64:65], v[64:65], v[68:69]
  v_pk_add_f32 v[66:67], v[66:67], v[70:71]
  v_pk_add_f32 v[28:29], v[56:57], v[64:65]
  v_pk_add_f32 v[30:31], v[58:59], v[66:67]

L_recSa_pgX:
  s_nop 0
  v_add_f32_dpp v28, v28, v28 row_ror:8 row_mask:0xf bank_mask:0xf
  v_add_f32_dpp v29, v29, v29 row_ror:8 row_mask:0xf bank_mask:0xf
  v_add_f32_dpp v30, v30, v30 row_ror:8 row_mask:0xf bank_mask:0xf
  v_add_f32_dpp v31, v31, v31 row_ror:8 row_mask:0xf bank_mask:0xf
  v_mov_b32 v32, v28
  v_mov_b32 v33, v29
  v_mov_b32 v34, v30
  v_mov_b32 v35, v31
  s_nop 0
  v_permlane16_swap_b32 v28, v32
  v_permlane16_swap_b32 v29, v33
  v_permlane16_swap_b32 v30, v34
  v_permlane16_swap_b32 v31, v35
  v_pk_add_f32 v[28:29], v[28:29], v[32:33]
  v_pk_add_f32 v[30:31], v[30:31], v[34:35]
  v_mov_b32 v32, v28
  v_mov_b32 v33, v29
  v_mov_b32 v34, v30
  v_mov_b32 v35, v31
  s_nop 0
  v_permlane32_swap_b32 v28, v32
  v_permlane32_swap_b32 v29, v33
  v_permlane32_swap_b32 v30, v34
  v_permlane32_swap_b32 v31, v35
  v_pk_add_f32 v[28:29], v[28:29], v[32:33]
  v_pk_add_f32 v[30:31], v[30:31], v[34:35]
  v_cvt_pk_bf16_f32 v28, v28, v29
  v_cvt_pk_bf16_f32 v29, v30, v31
  buffer_store_dwordx2 v[28:29], v16, s[4:7], s73 offen sc1
  buffer_store_dwordx2 v[20:21], v16, s[4:7], s74 offen sc1
  s_xor_b32 s71, s71, 3
  v_xor_b32 v1, 3, v1
  s_mov_b32 s34, s75
  s_mov_b32 s75, s74
  s_mov_b32 s74, s73
  s_mov_b32 s73, s34

  s_add_u32 s19, s19, 1
  s_cmp_lt_u32 s19, 63
  s_cbranch_scc1 L_recS_loop

  s_mov_b32 s62, 0
  s_waitcnt vmcnt(2)
  v_mov_b32 v56, 0
  v_mov_b32 v57, 0
  v_mov_b32 v58, 0
  v_mov_b32 v59, 0
  v_mov_b32 v60, 0
  v_mov_b32 v61, 0
  v_mov_b32 v62, 0
  v_mov_b32 v63, 0
  v_mov_b32 v64, 0
  v_mov_b32 v65, 0
  v_mov_b32 v66, 0
  v_mov_b32 v67, 0
  v_mov_b32 v68, 0
  v_mov_b32 v69, 0
  v_mov_b32 v70, 0
  v_mov_b32 v71, 0
  v_mov_b32 v72, 0
  v_mov_b32 v73, 0
  v_mov_b32 v74, 0
  v_mov_b32 v75, 0
  v_mov_b32 v76, 0
  v_mov_b32 v77, 0
  v_mov_b32 v78, 0
  v_mov_b32 v79, 0
  v_mov_b32 v112, v96
  v_mov_b32 v113, v97
  v_mov_b32 v114, v98
  v_mov_b32 v115, v99
  v_mov_b32 v116, v100
  v_mov_b32 v117, v101
  v_mov_b32 v118, v102
  v_mov_b32 v119, v103
  v_xor_b32 v19, 8192, v19
  buffer_load_dwordx4 v[120:123], v2, s[4:7], s74 offen sc1
  buffer_load_dwordx4 v[124:127], v2, s[4:7], s74 offen offset:1024 sc1
L_recSb_pa:
  s_waitcnt vmcnt(0)
  v_max3_u32 v24, v120, v121, v122
  v_max3_u32 v24, v24, v123, v124
  v_max3_u32 v24, v24, v125, v126
  v_max_u32 v24, v24, v127
  v_cmp_eq_u32 vcc, -1, v24
  s_cbranch_vccz L_recSb_pa0

  buffer_load_dwordx4 v[120:123], v2, s[4:7], s74 offen sc1
  buffer_load_dwordx4 v[124:127], v2, s[4:7], s74 offen offset:1024 sc1
  s_add_u32 s62, s62, 1
  s_cmp_gt_u32 s62, 0x40000
  s_cbranch_scc1 L_rec_end
  s_branch L_recSb_pa

L_recSb_pa0:
  ds_write_b128 v13, v[120:123]
  ds_write_b128 v13, v[124:127] offset:1040
L_recSb_paX:
  s_waitcnt lgkmcnt(0)
  s_barrier
  ds_read_b128 v[24:27], v17 offset:0
  ds_read_b128 v[28:31], v17 offset:128
  ds_read_b128 v[32:35], v17 offset:256
  s_and_b32 s34, s19, 3
  s_cbranch_scc1 L_pub_34
  s_cmp_eq_u32 s19, 0
  s_cbranch_scc1 L_pub_34
  s_cmp_lg_u32 s18, 0
  s_cbranch_scc1 L_pub_34
  s_lshl_b32 s34, s19, 5
  s_lshl_b32 s35, s16, 2
  s_add_u32 s34, s34, s35
  s_add_u32 s34, s34, 98631552
  v_mov_b32 v126, s34
  v_mov_b32 v127, s69
  s_mov_b64 exec, 1
  buffer_store_dword v127, v126, s[4:7], 0 offen sc1
  s_mov_b64 exec, -1

L_pub_34:
  s_waitcnt lgkmcnt(2)
  v_smfmac_f32_16x16x64_bf16 v[56:59], v[24:27], a[0:7], v18
  v_smfmac_f32_16x16x64_bf16 v[60:63], v[24:27], a[64:71], v18
  ds_read_b128 v[36:39], v17 offset:384
  v_smfmac_f32_16x16x64_bf16 v[64:67], v[24:27], a[128:135], v18
  v_smfmac_f32_16x16x64_bf16 v[68:71], v[24:27], a[192:199], v18
  v_smfmac_f32_16x16x64_bf16 v[72:75], v[24:27], v[128:135], v18
  v_smfmac_f32_16x16x64_bf16 v[76:79], v[24:27], v[192:199], v18
  s_waitcnt lgkmcnt(2)
  v_smfmac_f32_16x16x64_bf16 v[56:59], v[28:31], a[8:15], v18
  v_smfmac_f32_16x16x64_bf16 v[60:63], v[28:31], a[72:79], v18
  ds_read_b128 v[40:43], v17 offset:512
  v_smfmac_f32_16x16x64_bf16 v[64:67], v[28:31], a[136:143], v18
  v_smfmac_f32_16x16x64_bf16 v[68:71], v[28:31], a[200:207], v18
  v_smfmac_f32_16x16x64_bf16 v[72:75], v[28:31], v[136:143], v18
  v_smfmac_f32_16x16x64_bf16 v[76:79], v[28:31], v[200:207], v18
  s_waitcnt lgkmcnt(2)
  v_smfmac_f32_16x16x64_bf16 v[56:59], v[32:35], a[16:23], v18
  v_smfmac_f32_16x16x64_bf16 v[60:63], v[32:35], a[80:87], v18
  ds_read_b128 v[44:47], v17 offset:640
  v_smfmac_f32_16x16x64_bf16 v[64:67], v[32:35], a[144:151], v18
  v_smfmac_f32_16x16x64_bf16 v[68:71], v[32:35], a[208:215], v18
  v_smfmac_f32_16x16x64_bf16 v[72:75], v[32:35], v[144:151], v18
  v_smfmac_f32_16x16x64_bf16 v[76:79], v[32:35], v[208:215], v18
  s_waitcnt lgkmcnt(2)
  v_smfmac_f32_16x16x64_bf16 v[56:59], v[36:39], a[24:31], v18
  v_smfmac_f32_16x16x64_bf16 v[60:63], v[36:39], a[88:95], v18
  ds_read_b128 v[48:51], v17 offset:768
  v_smfmac_f32_16x16x64_bf16 v[64:67], v[36:39], a[152:159], v18
  v_smfmac_f32_16x16x64_bf16 v[68:71], v[36:39], a[216:223], v18
  v_smfmac_f32_16x16x64_bf16 v[72:75], v[36:39], v[152:159], v18
  v_smfmac_f32_16x16x64_bf16 v[76:79], v[36:39], v[216:223], v18
  s_waitcnt lgkmcnt(2)
  v_smfmac_f32_16x16x64_bf16 v[56:59], v[40:43], a[32:39], v18
  v_smfmac_f32_16x16x64_bf16 v[60:63], v[40:43], a[96:103], v18
  ds_read_b128 v[52:55], v17 offset:896
  v_smfmac_f32_16x16x64_bf16 v[64:67], v[40:43], a[160:167], v18
  v_smfmac_f32_16x16x64_bf16 v[68:71], v[40:43], a[224:231], v18
  v_smfmac_f32_16x16x64_bf16 v[72:75], v[40:43], v[160:167], v18
  v_smfmac_f32_16x16x64_bf16 v[76:79], v[40:43], v[224:231], v18
  s_waitcnt lgkmcnt(2)
  v_smfmac_f32_16x16x64_bf16 v[56:59], v[44:47], a[40:47], v18
  v_smfmac_f32_16x16x64_bf16 v[60:63], v[44:47], a[104:111], v18
  v_smfmac_f32_16x16x64_bf16 v[64:67], v[44:47], a[168:175], v18
  v_smfmac_f32_16x16x64_bf16 v[68:71], v[44:47], a[232:239], v18
  v_smfmac_f32_16x16x64_bf16 v[72:75], v[44:47], v[168:175], v18
  v_smfmac_f32_16x16x64_bf16 v[76:79], v[44:47], v[232:239], v18
  s_waitcnt lgkmcnt(1)
  v_smfmac_f32_16x16x64_bf16 v[56:59], v[48:51], a[48:55], v18
  v_smfmac_f32_16x16x64_bf16 v[60:63], v[48:51], a[112:119], v18
  v_smfmac_f32_16x16x64_bf16 v[64:67], v[48:51], a[176:183], v18
  v_smfmac_f32_16x16x64_bf16 v[68:71], v[48:51], a[240:247], v18
  v_smfmac_f32_16x16x64_bf16 v[72:75], v[48:51], v[176:183], v18
  v_smfmac_f32_16x16x64_bf16 v[76:79], v[48:51], v[240:247], v18
  s_waitcnt lgkmcnt(0)
  v_smfmac_f32_16x16x64_bf16 v[56:59], v[52:55], a[56:63], v18
  v_smfmac_f32_16x16x64_bf16 v[60:63], v[52:55], a[120:127], v18
  v_smfmac_f32_16x16x64_bf16 v[64:67], v[52:55], a[184:191], v18
  v_smfmac_f32_16x16x64_bf16 v[68:71], v[52:55], a[248:255], v18
  v_smfmac_f32_16x16x64_bf16 v[72:75], v[52:55], v[184:191], v18
  v_smfmac_f32_16x16x64_bf16 v[76:79], v[52:55], v[248:255], v18
  s_nop 4
  v_permlane32_swap_b32 v56, v60
  v_permlane32_swap_b32 v57, v61
  v_permlane32_swap_b32 v58, v62
  v_permlane32_swap_b32 v59, v63
  v_pk_add_f32 v[56:57], v[56:57], v[60:61]
  v_pk_add_f32 v[58:59], v[58:59], v[62:63]
  v_cvt_pk_bf16_f32 v56, v56, v57
  v_cvt_pk_bf16_f32 v57, v58, v59
  ds_write_b64 v8, v[56:57] offset:0
  v_permlane32_swap_b32 v64, v68
  v_permlane32_swap_b32 v65, v69
  v_permlane32_swap_b32 v66, v70
  v_permlane32_swap_b32 v67, v71
  v_pk_add_f32 v[64:65], v[64:65], v[68:69]
  v_pk_add_f32 v[66:67], v[66:67], v[70:71]
  v_cvt_pk_bf16_f32 v64, v64, v65
  v_cvt_pk_bf16_f32 v65, v66, v67
  ds_write_b64 v8, v[64:65] offset:2176
  v_permlane32_swap_b32 v72, v76
  v_permlane32_swap_b32 v73, v77
  v_permlane32_swap_b32 v74, v78
  v_permlane32_swap_b32 v75, v79
  v_pk_add_f32 v[72:73], v[72:73], v[76:77]
  v_pk_add_f32 v[74:75], v[74:75], v[78:79]
  v_cvt_pk_bf16_f32 v72, v72, v73
  v_cvt_pk_bf16_f32 v73, v74, v75
  buffer_store_dwordx2 v[72:73], v7, s[4:7], s53 offen sc1
  v_mov_b32 v76, 0
  v_mov_b32 v77, 0
  v_mov_b32 v78, 0
  v_mov_b32 v79, 0
  v_mov_b32 v74, 0
  v_mov_b32 v75, 0
  s_waitcnt lgkmcnt(0)
  s_barrier

  ds_read_b64_tr_b16 v[40:41], v9 offset:2176
  ds_read_b64_tr_b16 v[42:43], v9 offset:2240
  ds_read_b64_tr_b16 v[44:45], v9 offset:2688
  ds_read_b64_tr_b16 v[46:47], v9 offset:2752
  ds_read_b64_tr_b16 v[48:49], v9 offset:3200
  ds_read_b64_tr_b16 v[50:51], v9 offset:3264
  ds_read_b64_tr_b16 v[52:53], v9 offset:3712
  ds_read_b64_tr_b16 v[54:55], v9 offset:3776
  v_permlane32_swap_b32 v72, v76
  v_permlane32_swap_b32 v73, v77
  s_waitcnt lgkmcnt(0)
  s_cmp_eq_u32 s18, 0
  s_cbranch_scc1 L_km_35
  s_cmp_eq_u32 s18, 1
  s_cbranch_scc1 L_km_36
  s_cmp_eq_u32 s18, 2
  s_cbranch_scc1 L_km_37
  buffer_store_dwordx4 v[52:55], v6, s[4:7], s53 offen sc1
  s_branch L_kmd_39
L_km_37:
  buffer_store_dwordx4 v[48:51], v6, s[4:7], s53 offen sc1
  s_branch L_kmd_39
L_km_36:
  buffer_store_dwordx4 v[44:47], v6, s[4:7], s53 offen sc1
  s_branch L_kmd_39
L_km_35:
  buffer_store_dwordx4 v[40:43], v6, s[4:7], s53 offen sc1
L_kmd_39:
  s_waitcnt vmcnt(0)
  s_barrier
  s_mov_b32 s19, 64
  s_cmp_lg_u32 s18, 0
  s_cbranch_scc1 L_pub_40
  s_lshl_b32 s34, s19, 5
  s_lshl_b32 s35, s16, 2
  s_add_u32 s34, s34, s35
  s_add_u32 s34, s34, 98631552
  v_mov_b32 v126, s34
  v_mov_b32 v127, s69
  s_mov_b64 exec, 1
  buffer_store_dword v127, v126, s[4:7], 0 offen sc1
  s_mov_b64 exec, -1

L_pub_40:
  s_waitcnt vmcnt(0)
  s_branch L_rec_end
L_recS_entry0:
  s_branch L_recSa_pa0
L_worker:
  s_barrier
  s_cmp_lg_u32 s18, 0
  s_cbranch_scc1 L_wk_wait
  s_mov_b32 s8, s96
  s_mov_b32 s9, s97
  s_mov_b32 s10, 256
  s_mov_b32 s11, 0x00020000
  v_mov_b32 v2, 192
  v_mov_b32 v3, 1
  s_mov_b64 exec, 1
  buffer_atomic_add v3, v2, s[8:11], 0 offen sc0 sc1
  s_waitcnt vmcnt(0)
  v_mov_b32 v2, 160912
  ds_write_b32 v2, v3
  s_waitcnt lgkmcnt(0)
  s_mov_b64 exec, -1

L_wk_wait:
  s_barrier
  v_mov_b32 v2, 160912
  ds_read_b32 v3, v2
  s_waitcnt lgkmcnt(0)
  v_readfirstlane_b32 s24, v3

  s_cmp_ge_u32 s24, 5380
  s_cbranch_scc1 L_rec_end
  s_cmp_lt_u32 s24, 64
  s_cbranch_scc1 L_task_ln1
  s_sub_u32 s24, s24, 64
  s_cmp_ge_u32 s24, 1024
  s_cbranch_scc1 L_wk_notkv
  s_lshr_b32 s26, s24, 6
  s_and_b32 s29, s24, 31
  s_lshr_b32 s28, s24, 5
  s_and_b32 s28, s28, 1
  s_add_u32 s28, s28, 1
  s_branch L_task_qkv

L_wk_notkv:
  s_cmp_ge_u32 s24, 1536
  s_cbranch_scc1 L_wk_post
  s_sub_u32 s24, s24, 1024
  s_lshr_b32 s26, s24, 5
  s_and_b32 s29, s24, 31
  s_mov_b32 s28, 0
  s_branch L_task_qkv

L_wk_post:
  s_sub_u32 s24, s24, 1536
  s_mul_hi_u32 s26, s24, 23860930
  s_mul_i32 s34, s26, 180
  s_sub_u32 s27, s24, s34
  s_cmp_lt_u32 s27, 32
  s_cbranch_scc1 L_chk_attn
  s_sub_u32 s27, s27, 32
  s_sub_u32 s26, s26, 1
  s_cmp_lt_u32 s27, 64
  s_cbranch_scc1 L_chk_op
  s_sub_u32 s27, s27, 64
  s_sub_u32 s26, s26, 1
  s_cmp_lt_u32 s27, 16
  s_cbranch_scc1 L_chk_ln
  s_sub_u32 s27, s27, 16
  s_sub_u32 s26, s26, 1
  s_cmp_lt_u32 s27, 44
  s_cbranch_scc1 L_chk_gu
  s_sub_u32 s27, s27, 44
  s_sub_u32 s26, s26, 1
  s_cmp_lt_u32 s27, 16
  s_cbranch_scc1 L_chk_dn
  s_sub_u32 s27, s27, 16
  s_sub_u32 s26, s26, 1
  s_cmp_lt_u32 s26, 16
  s_cbranch_scc1 L_task_fin
  s_branch L_worker
  L_chk_attn:
  s_cmp_lt_u32 s26, 16
  s_cbranch_scc1 L_task_attn
  s_branch L_worker
  L_chk_op:
  s_cmp_lt_u32 s26, 16
  s_cbranch_scc1 L_task_op
  s_branch L_worker
  L_chk_ln:
  s_cmp_lt_u32 s26, 16
  s_cbranch_scc1 L_task_ln
  s_branch L_worker
  L_chk_gu:
  s_cmp_lt_u32 s26, 16
  s_cbranch_scc1 L_task_gu
  s_branch L_worker
  L_chk_dn:
  s_cmp_lt_u32 s26, 16
  s_cbranch_scc1 L_task_dn
  s_branch L_worker

L_task_ln1:
  s_mov_b32 s23, s27
  s_mov_b32 s8, s78
  s_mov_b32 s9, s79
  s_mov_b32 s10, 2097152
  s_mov_b32 s11, 0x00020000
  s_lshr_b32 s26, s24, 2
  s_and_b32 s23, s24, 3
  s_lshl_b32 s34, s24, 15
  s_lshl_b32 s35, s18, 13
  s_add_u32 s34, s34, s35
  v_lshlrev_b32 v2, 4, v1
  v_add_u32 v2, s34, v2
  v_add_u32 v3, 0, v2
  v_add_u32 v4, 4096, v2
  v_add_u32 v5, 4096, v3

  buffer_load_dwordx4 v[40:43], v2, s[8:11], 0 offen offset:0
  buffer_load_dwordx4 v[44:47], v2, s[8:11], 0 offen offset:1024
  buffer_load_dwordx4 v[48:51], v2, s[8:11], 0 offen offset:2048
  buffer_load_dwordx4 v[52:55], v2, s[8:11], 0 offen offset:3072
  s_waitcnt vmcnt(3)
  v_lshlrev_b32 v8, 16, v40
  v_and_b32 v9, 0xffff0000, v40
  v_lshlrev_b32 v10, 16, v41
  v_and_b32 v11, 0xffff0000, v41
  v_lshlrev_b32 v12, 16, v42
  v_and_b32 v13, 0xffff0000, v42
  v_lshlrev_b32 v14, 16, v43
  v_and_b32 v15, 0xffff0000, v43
  v_add_f32 v16, v8, v9
  v_add_f32 v16, v16, v10
  v_add_f32 v16, v16, v11
  v_add_f32 v16, v16, v12
  v_add_f32 v16, v16, v13
  v_add_f32 v16, v16, v14
  v_add_f32 v16, v16, v15
  s_nop 1
  v_add_f32_dpp v16, v16, v16 row_ror:1 row_mask:0xf bank_mask:0xf
  s_nop 1
  v_add_f32_dpp v16, v16, v16 row_ror:2 row_mask:0xf bank_mask:0xf
  s_nop 1
  v_add_f32_dpp v16, v16, v16 row_ror:4 row_mask:0xf bank_mask:0xf
  s_nop 1
  v_add_f32_dpp v16, v16, v16 row_ror:8 row_mask:0xf bank_mask:0xf
  s_nop 1
  v_mov_b32 v18, v16
  s_nop 1
  v_permlane16_swap_b32 v16, v18
  v_add_f32 v16, v16, v18
  v_mov_b32 v18, v16
  s_nop 1
  v_permlane32_swap_b32 v16, v18
  v_add_f32 v16, v16, v18
  v_mul_f32 v16, 0x3b000000, v16
  v_sub_f32 v18, v8, v16
  v_mul_f32 v17, v18, v18
  v_sub_f32 v18, v9, v16
  v_fmac_f32 v17, v18, v18
  v_sub_f32 v18, v10, v16
  v_fmac_f32 v17, v18, v18
  v_sub_f32 v18, v11, v16
  v_fmac_f32 v17, v18, v18
  v_sub_f32 v18, v12, v16
  v_fmac_f32 v17, v18, v18
  v_sub_f32 v18, v13, v16
  v_fmac_f32 v17, v18, v18
  v_sub_f32 v18, v14, v16
  v_fmac_f32 v17, v18, v18
  v_sub_f32 v18, v15, v16
  v_fmac_f32 v17, v18, v18
  s_nop 1
  v_add_f32_dpp v17, v17, v17 row_ror:1 row_mask:0xf bank_mask:0xf
  s_nop 1
  v_add_f32_dpp v17, v17, v17 row_ror:2 row_mask:0xf bank_mask:0xf
  s_nop 1
  v_add_f32_dpp v17, v17, v17 row_ror:4 row_mask:0xf bank_mask:0xf
  s_nop 1
  v_add_f32_dpp v17, v17, v17 row_ror:8 row_mask:0xf bank_mask:0xf
  s_nop 1
  v_mov_b32 v18, v17
  s_nop 1
  v_permlane16_swap_b32 v17, v18
  v_add_f32 v17, v17, v18
  v_mov_b32 v18, v17
  s_nop 1
  v_permlane32_swap_b32 v17, v18
  v_add_f32 v17, v17, v18
  v_mul_f32 v17, 0x3b000000, v17
  v_cvt_pk_bf16_f32 v17, v17, v17
  v_lshlrev_b32 v17, 16, v17
  v_cvt_pk_bf16_f32 v16, v16, v16
  v_lshlrev_b32 v16, 16, v16
  v_add_f32 v17, 0x3727c5ac, v17
  v_cvt_pk_bf16_f32 v17, v17, v17
  v_lshlrev_b32 v17, 16, v17
  v_sqrt_f32 v17, v17
  s_nop 0
  v_cvt_pk_bf16_f32 v17, v17, v17
  v_lshlrev_b32 v17, 16, v17
  v_rcp_f32 v18, v17
  s_nop 0
  v_fma_f32 v20, -v17, v18, 2.0
  v_mul_f32 v18, v18, v20
  v_sub_f32 v8, v8, v16
  v_cvt_pk_bf16_f32 v8, v8, v8
  v_lshlrev_b32 v8, 16, v8
  v_mul_f32 v20, v8, v18
  v_fma_f32 v21, -v20, v17, v8
  v_fma_f32 v8, v21, v18, v20
  v_sub_f32 v9, v9, v16
  v_cvt_pk_bf16_f32 v9, v9, v9
  v_lshlrev_b32 v9, 16, v9
  v_mul_f32 v20, v9, v18
  v_fma_f32 v21, -v20, v17, v9
  v_fma_f32 v9, v21, v18, v20
  v_sub_f32 v10, v10, v16
  v_cvt_pk_bf16_f32 v10, v10, v10
  v_lshlrev_b32 v10, 16, v10
  v_mul_f32 v20, v10, v18
  v_fma_f32 v21, -v20, v17, v10
  v_fma_f32 v10, v21, v18, v20
  v_sub_f32 v11, v11, v16
  v_cvt_pk_bf16_f32 v11, v11, v11
  v_lshlrev_b32 v11, 16, v11
  v_mul_f32 v20, v11, v18
  v_fma_f32 v21, -v20, v17, v11
  v_fma_f32 v11, v21, v18, v20
  v_sub_f32 v12, v12, v16
  v_cvt_pk_bf16_f32 v12, v12, v12
  v_lshlrev_b32 v12, 16, v12
  v_mul_f32 v20, v12, v18
  v_fma_f32 v21, -v20, v17, v12
  v_fma_f32 v12, v21, v18, v20
  v_sub_f32 v13, v13, v16
  v_cvt_pk_bf16_f32 v13, v13, v13
  v_lshlrev_b32 v13, 16, v13
  v_mul_f32 v20, v13, v18
  v_fma_f32 v21, -v20, v17, v13
  v_fma_f32 v13, v21, v18, v20
  v_sub_f32 v14, v14, v16
  v_cvt_pk_bf16_f32 v14, v14, v14
  v_lshlrev_b32 v14, 16, v14
  v_mul_f32 v20, v14, v18
  v_fma_f32 v21, -v20, v17, v14
  v_fma_f32 v14, v21, v18, v20
  v_sub_f32 v15, v15, v16
  v_cvt_pk_bf16_f32 v15, v15, v15
  v_lshlrev_b32 v15, 16, v15
  v_mul_f32 v20, v15, v18
  v_fma_f32 v21, -v20, v17, v15
  v_fma_f32 v15, v21, v18, v20
  v_cvt_pk_bf16_f32 v40, v8, v9
  v_cvt_pk_bf16_f32 v41, v10, v11
  v_cvt_pk_bf16_f32 v42, v12, v13
  v_cvt_pk_bf16_f32 v43, v14, v15
  buffer_store_dwordx4 v[40:43], v3, s[4:7], 0 offen offset:0 sc1
  s_waitcnt vmcnt(3)
  v_lshlrev_b32 v8, 16, v44
  v_and_b32 v9, 0xffff0000, v44
  v_lshlrev_b32 v10, 16, v45
  v_and_b32 v11, 0xffff0000, v45
  v_lshlrev_b32 v12, 16, v46
  v_and_b32 v13, 0xffff0000, v46
  v_lshlrev_b32 v14, 16, v47
  v_and_b32 v15, 0xffff0000, v47
  v_add_f32 v16, v8, v9
  v_add_f32 v16, v16, v10
  v_add_f32 v16, v16, v11
  v_add_f32 v16, v16, v12
  v_add_f32 v16, v16, v13
  v_add_f32 v16, v16, v14
  v_add_f32 v16, v16, v15
  s_nop 1
  v_add_f32_dpp v16, v16, v16 row_ror:1 row_mask:0xf bank_mask:0xf
  s_nop 1
  v_add_f32_dpp v16, v16, v16 row_ror:2 row_mask:0xf bank_mask:0xf
  s_nop 1
  v_add_f32_dpp v16, v16, v16 row_ror:4 row_mask:0xf bank_mask:0xf
  s_nop 1
  v_add_f32_dpp v16, v16, v16 row_ror:8 row_mask:0xf bank_mask:0xf
  s_nop 1
  v_mov_b32 v18, v16
  s_nop 1
  v_permlane16_swap_b32 v16, v18
  v_add_f32 v16, v16, v18
  v_mov_b32 v18, v16
  s_nop 1
  v_permlane32_swap_b32 v16, v18
  v_add_f32 v16, v16, v18
  v_mul_f32 v16, 0x3b000000, v16
  v_sub_f32 v18, v8, v16
  v_mul_f32 v17, v18, v18
  v_sub_f32 v18, v9, v16
  v_fmac_f32 v17, v18, v18
  v_sub_f32 v18, v10, v16
  v_fmac_f32 v17, v18, v18
  v_sub_f32 v18, v11, v16
  v_fmac_f32 v17, v18, v18
  v_sub_f32 v18, v12, v16
  v_fmac_f32 v17, v18, v18
  v_sub_f32 v18, v13, v16
  v_fmac_f32 v17, v18, v18
  v_sub_f32 v18, v14, v16
  v_fmac_f32 v17, v18, v18
  v_sub_f32 v18, v15, v16
  v_fmac_f32 v17, v18, v18
  s_nop 1
  v_add_f32_dpp v17, v17, v17 row_ror:1 row_mask:0xf bank_mask:0xf
  s_nop 1
  v_add_f32_dpp v17, v17, v17 row_ror:2 row_mask:0xf bank_mask:0xf
  s_nop 1
  v_add_f32_dpp v17, v17, v17 row_ror:4 row_mask:0xf bank_mask:0xf
  s_nop 1
  v_add_f32_dpp v17, v17, v17 row_ror:8 row_mask:0xf bank_mask:0xf
  s_nop 1
  v_mov_b32 v18, v17
  s_nop 1
  v_permlane16_swap_b32 v17, v18
  v_add_f32 v17, v17, v18
  v_mov_b32 v18, v17
  s_nop 1
  v_permlane32_swap_b32 v17, v18
  v_add_f32 v17, v17, v18
  v_mul_f32 v17, 0x3b000000, v17
  v_cvt_pk_bf16_f32 v17, v17, v17
  v_lshlrev_b32 v17, 16, v17
  v_cvt_pk_bf16_f32 v16, v16, v16
  v_lshlrev_b32 v16, 16, v16
  v_add_f32 v17, 0x3727c5ac, v17
  v_cvt_pk_bf16_f32 v17, v17, v17
  v_lshlrev_b32 v17, 16, v17
  v_sqrt_f32 v17, v17
  s_nop 0
  v_cvt_pk_bf16_f32 v17, v17, v17
  v_lshlrev_b32 v17, 16, v17
  v_rcp_f32 v18, v17
  s_nop 0
  v_fma_f32 v20, -v17, v18, 2.0
  v_mul_f32 v18, v18, v20
  v_sub_f32 v8, v8, v16
  v_cvt_pk_bf16_f32 v8, v8, v8
  v_lshlrev_b32 v8, 16, v8
  v_mul_f32 v20, v8, v18
  v_fma_f32 v21, -v20, v17, v8
  v_fma_f32 v8, v21, v18, v20
  v_sub_f32 v9, v9, v16
  v_cvt_pk_bf16_f32 v9, v9, v9
  v_lshlrev_b32 v9, 16, v9
  v_mul_f32 v20, v9, v18
  v_fma_f32 v21, -v20, v17, v9
  v_fma_f32 v9, v21, v18, v20
  v_sub_f32 v10, v10, v16
  v_cvt_pk_bf16_f32 v10, v10, v10
  v_lshlrev_b32 v10, 16, v10
  v_mul_f32 v20, v10, v18
  v_fma_f32 v21, -v20, v17, v10
  v_fma_f32 v10, v21, v18, v20
  v_sub_f32 v11, v11, v16
  v_cvt_pk_bf16_f32 v11, v11, v11
  v_lshlrev_b32 v11, 16, v11
  v_mul_f32 v20, v11, v18
  v_fma_f32 v21, -v20, v17, v11
  v_fma_f32 v11, v21, v18, v20
  v_sub_f32 v12, v12, v16
  v_cvt_pk_bf16_f32 v12, v12, v12
  v_lshlrev_b32 v12, 16, v12
  v_mul_f32 v20, v12, v18
  v_fma_f32 v21, -v20, v17, v12
  v_fma_f32 v12, v21, v18, v20
  v_sub_f32 v13, v13, v16
  v_cvt_pk_bf16_f32 v13, v13, v13
  v_lshlrev_b32 v13, 16, v13
  v_mul_f32 v20, v13, v18
  v_fma_f32 v21, -v20, v17, v13
  v_fma_f32 v13, v21, v18, v20
  v_sub_f32 v14, v14, v16
  v_cvt_pk_bf16_f32 v14, v14, v14
  v_lshlrev_b32 v14, 16, v14
  v_mul_f32 v20, v14, v18
  v_fma_f32 v21, -v20, v17, v14
  v_fma_f32 v14, v21, v18, v20
  v_sub_f32 v15, v15, v16
  v_cvt_pk_bf16_f32 v15, v15, v15
  v_lshlrev_b32 v15, 16, v15
  v_mul_f32 v20, v15, v18
  v_fma_f32 v21, -v20, v17, v15
  v_fma_f32 v15, v21, v18, v20
  v_cvt_pk_bf16_f32 v44, v8, v9
  v_cvt_pk_bf16_f32 v45, v10, v11
  v_cvt_pk_bf16_f32 v46, v12, v13
  v_cvt_pk_bf16_f32 v47, v14, v15
  buffer_store_dwordx4 v[44:47], v3, s[4:7], 0 offen offset:1024 sc1
  s_waitcnt vmcnt(3)
  v_lshlrev_b32 v8, 16, v48
  v_and_b32 v9, 0xffff0000, v48
  v_lshlrev_b32 v10, 16, v49
  v_and_b32 v11, 0xffff0000, v49
  v_lshlrev_b32 v12, 16, v50
  v_and_b32 v13, 0xffff0000, v50
  v_lshlrev_b32 v14, 16, v51
  v_and_b32 v15, 0xffff0000, v51
  v_add_f32 v16, v8, v9
  v_add_f32 v16, v16, v10
  v_add_f32 v16, v16, v11
  v_add_f32 v16, v16, v12
  v_add_f32 v16, v16, v13
  v_add_f32 v16, v16, v14
  v_add_f32 v16, v16, v15
  s_nop 1
  v_add_f32_dpp v16, v16, v16 row_ror:1 row_mask:0xf bank_mask:0xf
  s_nop 1
  v_add_f32_dpp v16, v16, v16 row_ror:2 row_mask:0xf bank_mask:0xf
  s_nop 1
  v_add_f32_dpp v16, v16, v16 row_ror:4 row_mask:0xf bank_mask:0xf
  s_nop 1
  v_add_f32_dpp v16, v16, v16 row_ror:8 row_mask:0xf bank_mask:0xf
  s_nop 1
  v_mov_b32 v18, v16
  s_nop 1
  v_permlane16_swap_b32 v16, v18
  v_add_f32 v16, v16, v18
  v_mov_b32 v18, v16
  s_nop 1
  v_permlane32_swap_b32 v16, v18
  v_add_f32 v16, v16, v18
  v_mul_f32 v16, 0x3b000000, v16
  v_sub_f32 v18, v8, v16
  v_mul_f32 v17, v18, v18
  v_sub_f32 v18, v9, v16
  v_fmac_f32 v17, v18, v18
  v_sub_f32 v18, v10, v16
  v_fmac_f32 v17, v18, v18
  v_sub_f32 v18, v11, v16
  v_fmac_f32 v17, v18, v18
  v_sub_f32 v18, v12, v16
  v_fmac_f32 v17, v18, v18
  v_sub_f32 v18, v13, v16
  v_fmac_f32 v17, v18, v18
  v_sub_f32 v18, v14, v16
  v_fmac_f32 v17, v18, v18
  v_sub_f32 v18, v15, v16
  v_fmac_f32 v17, v18, v18
  s_nop 1
  v_add_f32_dpp v17, v17, v17 row_ror:1 row_mask:0xf bank_mask:0xf
  s_nop 1
  v_add_f32_dpp v17, v17, v17 row_ror:2 row_mask:0xf bank_mask:0xf
  s_nop 1
  v_add_f32_dpp v17, v17, v17 row_ror:4 row_mask:0xf bank_mask:0xf
  s_nop 1
  v_add_f32_dpp v17, v17, v17 row_ror:8 row_mask:0xf bank_mask:0xf
  s_nop 1
  v_mov_b32 v18, v17
  s_nop 1
  v_permlane16_swap_b32 v17, v18
  v_add_f32 v17, v17, v18
  v_mov_b32 v18, v17
  s_nop 1
  v_permlane32_swap_b32 v17, v18
  v_add_f32 v17, v17, v18
  v_mul_f32 v17, 0x3b000000, v17
  v_cvt_pk_bf16_f32 v17, v17, v17
  v_lshlrev_b32 v17, 16, v17
  v_cvt_pk_bf16_f32 v16, v16, v16
  v_lshlrev_b32 v16, 16, v16
  v_add_f32 v17, 0x3727c5ac, v17
  v_cvt_pk_bf16_f32 v17, v17, v17
  v_lshlrev_b32 v17, 16, v17
  v_sqrt_f32 v17, v17
  s_nop 0
  v_cvt_pk_bf16_f32 v17, v17, v17
  v_lshlrev_b32 v17, 16, v17
  v_rcp_f32 v18, v17
  s_nop 0
  v_fma_f32 v20, -v17, v18, 2.0
  v_mul_f32 v18, v18, v20
  v_sub_f32 v8, v8, v16
  v_cvt_pk_bf16_f32 v8, v8, v8
  v_lshlrev_b32 v8, 16, v8
  v_mul_f32 v20, v8, v18
  v_fma_f32 v21, -v20, v17, v8
  v_fma_f32 v8, v21, v18, v20
  v_sub_f32 v9, v9, v16
  v_cvt_pk_bf16_f32 v9, v9, v9
  v_lshlrev_b32 v9, 16, v9
  v_mul_f32 v20, v9, v18
  v_fma_f32 v21, -v20, v17, v9
  v_fma_f32 v9, v21, v18, v20
  v_sub_f32 v10, v10, v16
  v_cvt_pk_bf16_f32 v10, v10, v10
  v_lshlrev_b32 v10, 16, v10
  v_mul_f32 v20, v10, v18
  v_fma_f32 v21, -v20, v17, v10
  v_fma_f32 v10, v21, v18, v20
  v_sub_f32 v11, v11, v16
  v_cvt_pk_bf16_f32 v11, v11, v11
  v_lshlrev_b32 v11, 16, v11
  v_mul_f32 v20, v11, v18
  v_fma_f32 v21, -v20, v17, v11
  v_fma_f32 v11, v21, v18, v20
  v_sub_f32 v12, v12, v16
  v_cvt_pk_bf16_f32 v12, v12, v12
  v_lshlrev_b32 v12, 16, v12
  v_mul_f32 v20, v12, v18
  v_fma_f32 v21, -v20, v17, v12
  v_fma_f32 v12, v21, v18, v20
  v_sub_f32 v13, v13, v16
  v_cvt_pk_bf16_f32 v13, v13, v13
  v_lshlrev_b32 v13, 16, v13
  v_mul_f32 v20, v13, v18
  v_fma_f32 v21, -v20, v17, v13
  v_fma_f32 v13, v21, v18, v20
  v_sub_f32 v14, v14, v16
  v_cvt_pk_bf16_f32 v14, v14, v14
  v_lshlrev_b32 v14, 16, v14
  v_mul_f32 v20, v14, v18
  v_fma_f32 v21, -v20, v17, v14
  v_fma_f32 v14, v21, v18, v20
  v_sub_f32 v15, v15, v16
  v_cvt_pk_bf16_f32 v15, v15, v15
  v_lshlrev_b32 v15, 16, v15
  v_mul_f32 v20, v15, v18
  v_fma_f32 v21, -v20, v17, v15
  v_fma_f32 v15, v21, v18, v20
  v_cvt_pk_bf16_f32 v48, v8, v9
  v_cvt_pk_bf16_f32 v49, v10, v11
  v_cvt_pk_bf16_f32 v50, v12, v13
  v_cvt_pk_bf16_f32 v51, v14, v15
  buffer_store_dwordx4 v[48:51], v3, s[4:7], 0 offen offset:2048 sc1
  s_waitcnt vmcnt(3)
  v_lshlrev_b32 v8, 16, v52
  v_and_b32 v9, 0xffff0000, v52
  v_lshlrev_b32 v10, 16, v53
  v_and_b32 v11, 0xffff0000, v53
  v_lshlrev_b32 v12, 16, v54
  v_and_b32 v13, 0xffff0000, v54
  v_lshlrev_b32 v14, 16, v55
  v_and_b32 v15, 0xffff0000, v55
  v_add_f32 v16, v8, v9
  v_add_f32 v16, v16, v10
  v_add_f32 v16, v16, v11
  v_add_f32 v16, v16, v12
  v_add_f32 v16, v16, v13
  v_add_f32 v16, v16, v14
  v_add_f32 v16, v16, v15
  s_nop 1
  v_add_f32_dpp v16, v16, v16 row_ror:1 row_mask:0xf bank_mask:0xf
  s_nop 1
  v_add_f32_dpp v16, v16, v16 row_ror:2 row_mask:0xf bank_mask:0xf
  s_nop 1
  v_add_f32_dpp v16, v16, v16 row_ror:4 row_mask:0xf bank_mask:0xf
  s_nop 1
  v_add_f32_dpp v16, v16, v16 row_ror:8 row_mask:0xf bank_mask:0xf
  s_nop 1
  v_mov_b32 v18, v16
  s_nop 1
  v_permlane16_swap_b32 v16, v18
  v_add_f32 v16, v16, v18
  v_mov_b32 v18, v16
  s_nop 1
  v_permlane32_swap_b32 v16, v18
  v_add_f32 v16, v16, v18
  v_mul_f32 v16, 0x3b000000, v16
  v_sub_f32 v18, v8, v16
  v_mul_f32 v17, v18, v18
  v_sub_f32 v18, v9, v16
  v_fmac_f32 v17, v18, v18
  v_sub_f32 v18, v10, v16
  v_fmac_f32 v17, v18, v18
  v_sub_f32 v18, v11, v16
  v_fmac_f32 v17, v18, v18
  v_sub_f32 v18, v12, v16
  v_fmac_f32 v17, v18, v18
  v_sub_f32 v18, v13, v16
  v_fmac_f32 v17, v18, v18
  v_sub_f32 v18, v14, v16
  v_fmac_f32 v17, v18, v18
  v_sub_f32 v18, v15, v16
  v_fmac_f32 v17, v18, v18
  s_nop 1
  v_add_f32_dpp v17, v17, v17 row_ror:1 row_mask:0xf bank_mask:0xf
  s_nop 1
  v_add_f32_dpp v17, v17, v17 row_ror:2 row_mask:0xf bank_mask:0xf
  s_nop 1
  v_add_f32_dpp v17, v17, v17 row_ror:4 row_mask:0xf bank_mask:0xf
  s_nop 1
  v_add_f32_dpp v17, v17, v17 row_ror:8 row_mask:0xf bank_mask:0xf
  s_nop 1
  v_mov_b32 v18, v17
  s_nop 1
  v_permlane16_swap_b32 v17, v18
  v_add_f32 v17, v17, v18
  v_mov_b32 v18, v17
  s_nop 1
  v_permlane32_swap_b32 v17, v18
  v_add_f32 v17, v17, v18
  v_mul_f32 v17, 0x3b000000, v17
  v_cvt_pk_bf16_f32 v17, v17, v17
  v_lshlrev_b32 v17, 16, v17
  v_cvt_pk_bf16_f32 v16, v16, v16
  v_lshlrev_b32 v16, 16, v16
  v_add_f32 v17, 0x3727c5ac, v17
  v_cvt_pk_bf16_f32 v17, v17, v17
  v_lshlrev_b32 v17, 16, v17
  v_sqrt_f32 v17, v17
  s_nop 0
  v_cvt_pk_bf16_f32 v17, v17, v17
  v_lshlrev_b32 v17, 16, v17
  v_rcp_f32 v18, v17
  s_nop 0
  v_fma_f32 v20, -v17, v18, 2.0
  v_mul_f32 v18, v18, v20
  v_sub_f32 v8, v8, v16
  v_cvt_pk_bf16_f32 v8, v8, v8
  v_lshlrev_b32 v8, 16, v8
  v_mul_f32 v20, v8, v18
  v_fma_f32 v21, -v20, v17, v8
  v_fma_f32 v8, v21, v18, v20
  v_sub_f32 v9, v9, v16
  v_cvt_pk_bf16_f32 v9, v9, v9
  v_lshlrev_b32 v9, 16, v9
  v_mul_f32 v20, v9, v18
  v_fma_f32 v21, -v20, v17, v9
  v_fma_f32 v9, v21, v18, v20
  v_sub_f32 v10, v10, v16
  v_cvt_pk_bf16_f32 v10, v10, v10
  v_lshlrev_b32 v10, 16, v10
  v_mul_f32 v20, v10, v18
  v_fma_f32 v21, -v20, v17, v10
  v_fma_f32 v10, v21, v18, v20
  v_sub_f32 v11, v11, v16
  v_cvt_pk_bf16_f32 v11, v11, v11
  v_lshlrev_b32 v11, 16, v11
  v_mul_f32 v20, v11, v18
  v_fma_f32 v21, -v20, v17, v11
  v_fma_f32 v11, v21, v18, v20
  v_sub_f32 v12, v12, v16
  v_cvt_pk_bf16_f32 v12, v12, v12
  v_lshlrev_b32 v12, 16, v12
  v_mul_f32 v20, v12, v18
  v_fma_f32 v21, -v20, v17, v12
  v_fma_f32 v12, v21, v18, v20
  v_sub_f32 v13, v13, v16
  v_cvt_pk_bf16_f32 v13, v13, v13
  v_lshlrev_b32 v13, 16, v13
  v_mul_f32 v20, v13, v18
  v_fma_f32 v21, -v20, v17, v13
  v_fma_f32 v13, v21, v18, v20
  v_sub_f32 v14, v14, v16
  v_cvt_pk_bf16_f32 v14, v14, v14
  v_lshlrev_b32 v14, 16, v14
  v_mul_f32 v20, v14, v18
  v_fma_f32 v21, -v20, v17, v14
  v_fma_f32 v14, v21, v18, v20
  v_sub_f32 v15, v15, v16
  v_cvt_pk_bf16_f32 v15, v15, v15
  v_lshlrev_b32 v15, 16, v15
  v_mul_f32 v20, v15, v18
  v_fma_f32 v21, -v20, v17, v15
  v_fma_f32 v15, v21, v18, v20
  v_cvt_pk_bf16_f32 v52, v8, v9
  v_cvt_pk_bf16_f32 v53, v10, v11
  v_cvt_pk_bf16_f32 v54, v12, v13
  v_cvt_pk_bf16_f32 v55, v14, v15
  buffer_store_dwordx4 v[52:55], v3, s[4:7], 0 offen offset:3072 sc1
  buffer_load_dwordx4 v[40:43], v4, s[8:11], 0 offen offset:0
  buffer_load_dwordx4 v[44:47], v4, s[8:11], 0 offen offset:1024
  buffer_load_dwordx4 v[48:51], v4, s[8:11], 0 offen offset:2048
  buffer_load_dwordx4 v[52:55], v4, s[8:11], 0 offen offset:3072
  s_waitcnt vmcnt(3)
  v_lshlrev_b32 v8, 16, v40
  v_and_b32 v9, 0xffff0000, v40
  v_lshlrev_b32 v10, 16, v41
  v_and_b32 v11, 0xffff0000, v41
  v_lshlrev_b32 v12, 16, v42
  v_and_b32 v13, 0xffff0000, v42
  v_lshlrev_b32 v14, 16, v43
  v_and_b32 v15, 0xffff0000, v43
  v_add_f32 v16, v8, v9
  v_add_f32 v16, v16, v10
  v_add_f32 v16, v16, v11
  v_add_f32 v16, v16, v12
  v_add_f32 v16, v16, v13
  v_add_f32 v16, v16, v14
  v_add_f32 v16, v16, v15
  s_nop 1
  v_add_f32_dpp v16, v16, v16 row_ror:1 row_mask:0xf bank_mask:0xf
  s_nop 1
  v_add_f32_dpp v16, v16, v16 row_ror:2 row_mask:0xf bank_mask:0xf
  s_nop 1
  v_add_f32_dpp v16, v16, v16 row_ror:4 row_mask:0xf bank_mask:0xf
  s_nop 1
  v_add_f32_dpp v16, v16, v16 row_ror:8 row_mask:0xf bank_mask:0xf
  s_nop 1
  v_mov_b32 v18, v16
  s_nop 1
  v_permlane16_swap_b32 v16, v18
  v_add_f32 v16, v16, v18
  v_mov_b32 v18, v16
  s_nop 1
  v_permlane32_swap_b32 v16, v18
  v_add_f32 v16, v16, v18
  v_mul_f32 v16, 0x3b000000, v16
  v_sub_f32 v18, v8, v16
  v_mul_f32 v17, v18, v18
  v_sub_f32 v18, v9, v16
  v_fmac_f32 v17, v18, v18
  v_sub_f32 v18, v10, v16
  v_fmac_f32 v17, v18, v18
  v_sub_f32 v18, v11, v16
  v_fmac_f32 v17, v18, v18
  v_sub_f32 v18, v12, v16
  v_fmac_f32 v17, v18, v18
  v_sub_f32 v18, v13, v16
  v_fmac_f32 v17, v18, v18
  v_sub_f32 v18, v14, v16
  v_fmac_f32 v17, v18, v18
  v_sub_f32 v18, v15, v16
  v_fmac_f32 v17, v18, v18
  s_nop 1
  v_add_f32_dpp v17, v17, v17 row_ror:1 row_mask:0xf bank_mask:0xf
  s_nop 1
  v_add_f32_dpp v17, v17, v17 row_ror:2 row_mask:0xf bank_mask:0xf
  s_nop 1
  v_add_f32_dpp v17, v17, v17 row_ror:4 row_mask:0xf bank_mask:0xf
  s_nop 1
  v_add_f32_dpp v17, v17, v17 row_ror:8 row_mask:0xf bank_mask:0xf
  s_nop 1
  v_mov_b32 v18, v17
  s_nop 1
  v_permlane16_swap_b32 v17, v18
  v_add_f32 v17, v17, v18
  v_mov_b32 v18, v17
  s_nop 1
  v_permlane32_swap_b32 v17, v18
  v_add_f32 v17, v17, v18
  v_mul_f32 v17, 0x3b000000, v17
  v_cvt_pk_bf16_f32 v17, v17, v17
  v_lshlrev_b32 v17, 16, v17
  v_cvt_pk_bf16_f32 v16, v16, v16
  v_lshlrev_b32 v16, 16, v16
  v_add_f32 v17, 0x3727c5ac, v17
  v_cvt_pk_bf16_f32 v17, v17, v17
  v_lshlrev_b32 v17, 16, v17
  v_sqrt_f32 v17, v17
  s_nop 0
  v_cvt_pk_bf16_f32 v17, v17, v17
  v_lshlrev_b32 v17, 16, v17
  v_rcp_f32 v18, v17
  s_nop 0
  v_fma_f32 v20, -v17, v18, 2.0
  v_mul_f32 v18, v18, v20
  v_sub_f32 v8, v8, v16
  v_cvt_pk_bf16_f32 v8, v8, v8
  v_lshlrev_b32 v8, 16, v8
  v_mul_f32 v20, v8, v18
  v_fma_f32 v21, -v20, v17, v8
  v_fma_f32 v8, v21, v18, v20
  v_sub_f32 v9, v9, v16
  v_cvt_pk_bf16_f32 v9, v9, v9
  v_lshlrev_b32 v9, 16, v9
  v_mul_f32 v20, v9, v18
  v_fma_f32 v21, -v20, v17, v9
  v_fma_f32 v9, v21, v18, v20
  v_sub_f32 v10, v10, v16
  v_cvt_pk_bf16_f32 v10, v10, v10
  v_lshlrev_b32 v10, 16, v10
  v_mul_f32 v20, v10, v18
  v_fma_f32 v21, -v20, v17, v10
  v_fma_f32 v10, v21, v18, v20
  v_sub_f32 v11, v11, v16
  v_cvt_pk_bf16_f32 v11, v11, v11
  v_lshlrev_b32 v11, 16, v11
  v_mul_f32 v20, v11, v18
  v_fma_f32 v21, -v20, v17, v11
  v_fma_f32 v11, v21, v18, v20
  v_sub_f32 v12, v12, v16
  v_cvt_pk_bf16_f32 v12, v12, v12
  v_lshlrev_b32 v12, 16, v12
  v_mul_f32 v20, v12, v18
  v_fma_f32 v21, -v20, v17, v12
  v_fma_f32 v12, v21, v18, v20
  v_sub_f32 v13, v13, v16
  v_cvt_pk_bf16_f32 v13, v13, v13
  v_lshlrev_b32 v13, 16, v13
  v_mul_f32 v20, v13, v18
  v_fma_f32 v21, -v20, v17, v13
  v_fma_f32 v13, v21, v18, v20
  v_sub_f32 v14, v14, v16
  v_cvt_pk_bf16_f32 v14, v14, v14
  v_lshlrev_b32 v14, 16, v14
  v_mul_f32 v20, v14, v18
  v_fma_f32 v21, -v20, v17, v14
  v_fma_f32 v14, v21, v18, v20
  v_sub_f32 v15, v15, v16
  v_cvt_pk_bf16_f32 v15, v15, v15
  v_lshlrev_b32 v15, 16, v15
  v_mul_f32 v20, v15, v18
  v_fma_f32 v21, -v20, v17, v15
  v_fma_f32 v15, v21, v18, v20
  v_cvt_pk_bf16_f32 v40, v8, v9
  v_cvt_pk_bf16_f32 v41, v10, v11
  v_cvt_pk_bf16_f32 v42, v12, v13
  v_cvt_pk_bf16_f32 v43, v14, v15
  buffer_store_dwordx4 v[40:43], v5, s[4:7], 0 offen offset:0 sc1
  s_waitcnt vmcnt(3)
  v_lshlrev_b32 v8, 16, v44
  v_and_b32 v9, 0xffff0000, v44
  v_lshlrev_b32 v10, 16, v45
  v_and_b32 v11, 0xffff0000, v45
  v_lshlrev_b32 v12, 16, v46
  v_and_b32 v13, 0xffff0000, v46
  v_lshlrev_b32 v14, 16, v47
  v_and_b32 v15, 0xffff0000, v47
  v_add_f32 v16, v8, v9
  v_add_f32 v16, v16, v10
  v_add_f32 v16, v16, v11
  v_add_f32 v16, v16, v12
  v_add_f32 v16, v16, v13
  v_add_f32 v16, v16, v14
  v_add_f32 v16, v16, v15
  s_nop 1
  v_add_f32_dpp v16, v16, v16 row_ror:1 row_mask:0xf bank_mask:0xf
  s_nop 1
  v_add_f32_dpp v16, v16, v16 row_ror:2 row_mask:0xf bank_mask:0xf
  s_nop 1
  v_add_f32_dpp v16, v16, v16 row_ror:4 row_mask:0xf bank_mask:0xf
  s_nop 1
  v_add_f32_dpp v16, v16, v16 row_ror:8 row_mask:0xf bank_mask:0xf
  s_nop 1
  v_mov_b32 v18, v16
  s_nop 1
  v_permlane16_swap_b32 v16, v18
  v_add_f32 v16, v16, v18
  v_mov_b32 v18, v16
  s_nop 1
  v_permlane32_swap_b32 v16, v18
  v_add_f32 v16, v16, v18
  v_mul_f32 v16, 0x3b000000, v16
  v_sub_f32 v18, v8, v16
  v_mul_f32 v17, v18, v18
  v_sub_f32 v18, v9, v16
  v_fmac_f32 v17, v18, v18
  v_sub_f32 v18, v10, v16
  v_fmac_f32 v17, v18, v18
  v_sub_f32 v18, v11, v16
  v_fmac_f32 v17, v18, v18
  v_sub_f32 v18, v12, v16
  v_fmac_f32 v17, v18, v18
  v_sub_f32 v18, v13, v16
  v_fmac_f32 v17, v18, v18
  v_sub_f32 v18, v14, v16
  v_fmac_f32 v17, v18, v18
  v_sub_f32 v18, v15, v16
  v_fmac_f32 v17, v18, v18
  s_nop 1
  v_add_f32_dpp v17, v17, v17 row_ror:1 row_mask:0xf bank_mask:0xf
  s_nop 1
  v_add_f32_dpp v17, v17, v17 row_ror:2 row_mask:0xf bank_mask:0xf
  s_nop 1
  v_add_f32_dpp v17, v17, v17 row_ror:4 row_mask:0xf bank_mask:0xf
  s_nop 1
  v_add_f32_dpp v17, v17, v17 row_ror:8 row_mask:0xf bank_mask:0xf
  s_nop 1
  v_mov_b32 v18, v17
  s_nop 1
  v_permlane16_swap_b32 v17, v18
  v_add_f32 v17, v17, v18
  v_mov_b32 v18, v17
  s_nop 1
  v_permlane32_swap_b32 v17, v18
  v_add_f32 v17, v17, v18
  v_mul_f32 v17, 0x3b000000, v17
  v_cvt_pk_bf16_f32 v17, v17, v17
  v_lshlrev_b32 v17, 16, v17
  v_cvt_pk_bf16_f32 v16, v16, v16
  v_lshlrev_b32 v16, 16, v16
  v_add_f32 v17, 0x3727c5ac, v17
  v_cvt_pk_bf16_f32 v17, v17, v17
  v_lshlrev_b32 v17, 16, v17
  v_sqrt_f32 v17, v17
  s_nop 0
  v_cvt_pk_bf16_f32 v17, v17, v17
  v_lshlrev_b32 v17, 16, v17
  v_rcp_f32 v18, v17
  s_nop 0
  v_fma_f32 v20, -v17, v18, 2.0
  v_mul_f32 v18, v18, v20
  v_sub_f32 v8, v8, v16
  v_cvt_pk_bf16_f32 v8, v8, v8
  v_lshlrev_b32 v8, 16, v8
  v_mul_f32 v20, v8, v18
  v_fma_f32 v21, -v20, v17, v8
  v_fma_f32 v8, v21, v18, v20
  v_sub_f32 v9, v9, v16
  v_cvt_pk_bf16_f32 v9, v9, v9
  v_lshlrev_b32 v9, 16, v9
  v_mul_f32 v20, v9, v18
  v_fma_f32 v21, -v20, v17, v9
  v_fma_f32 v9, v21, v18, v20
  v_sub_f32 v10, v10, v16
  v_cvt_pk_bf16_f32 v10, v10, v10
  v_lshlrev_b32 v10, 16, v10
  v_mul_f32 v20, v10, v18
  v_fma_f32 v21, -v20, v17, v10
  v_fma_f32 v10, v21, v18, v20
  v_sub_f32 v11, v11, v16
  v_cvt_pk_bf16_f32 v11, v11, v11
  v_lshlrev_b32 v11, 16, v11
  v_mul_f32 v20, v11, v18
  v_fma_f32 v21, -v20, v17, v11
  v_fma_f32 v11, v21, v18, v20
  v_sub_f32 v12, v12, v16
  v_cvt_pk_bf16_f32 v12, v12, v12
  v_lshlrev_b32 v12, 16, v12
  v_mul_f32 v20, v12, v18
  v_fma_f32 v21, -v20, v17, v12
  v_fma_f32 v12, v21, v18, v20
  v_sub_f32 v13, v13, v16
  v_cvt_pk_bf16_f32 v13, v13, v13
  v_lshlrev_b32 v13, 16, v13
  v_mul_f32 v20, v13, v18
  v_fma_f32 v21, -v20, v17, v13
  v_fma_f32 v13, v21, v18, v20
  v_sub_f32 v14, v14, v16
  v_cvt_pk_bf16_f32 v14, v14, v14
  v_lshlrev_b32 v14, 16, v14
  v_mul_f32 v20, v14, v18
  v_fma_f32 v21, -v20, v17, v14
  v_fma_f32 v14, v21, v18, v20
  v_sub_f32 v15, v15, v16
  v_cvt_pk_bf16_f32 v15, v15, v15
  v_lshlrev_b32 v15, 16, v15
  v_mul_f32 v20, v15, v18
  v_fma_f32 v21, -v20, v17, v15
  v_fma_f32 v15, v21, v18, v20
  v_cvt_pk_bf16_f32 v44, v8, v9
  v_cvt_pk_bf16_f32 v45, v10, v11
  v_cvt_pk_bf16_f32 v46, v12, v13
  v_cvt_pk_bf16_f32 v47, v14, v15
  buffer_store_dwordx4 v[44:47], v5, s[4:7], 0 offen offset:1024 sc1
  s_waitcnt vmcnt(3)
  v_lshlrev_b32 v8, 16, v48
  v_and_b32 v9, 0xffff0000, v48
  v_lshlrev_b32 v10, 16, v49
  v_and_b32 v11, 0xffff0000, v49
  v_lshlrev_b32 v12, 16, v50
  v_and_b32 v13, 0xffff0000, v50
  v_lshlrev_b32 v14, 16, v51
  v_and_b32 v15, 0xffff0000, v51
  v_add_f32 v16, v8, v9
  v_add_f32 v16, v16, v10
  v_add_f32 v16, v16, v11
  v_add_f32 v16, v16, v12
  v_add_f32 v16, v16, v13
  v_add_f32 v16, v16, v14
  v_add_f32 v16, v16, v15
  s_nop 1
  v_add_f32_dpp v16, v16, v16 row_ror:1 row_mask:0xf bank_mask:0xf
  s_nop 1
  v_add_f32_dpp v16, v16, v16 row_ror:2 row_mask:0xf bank_mask:0xf
  s_nop 1
  v_add_f32_dpp v16, v16, v16 row_ror:4 row_mask:0xf bank_mask:0xf
  s_nop 1
  v_add_f32_dpp v16, v16, v16 row_ror:8 row_mask:0xf bank_mask:0xf
  s_nop 1
  v_mov_b32 v18, v16
  s_nop 1
  v_permlane16_swap_b32 v16, v18
  v_add_f32 v16, v16, v18
  v_mov_b32 v18, v16
  s_nop 1
  v_permlane32_swap_b32 v16, v18
  v_add_f32 v16, v16, v18
  v_mul_f32 v16, 0x3b000000, v16
  v_sub_f32 v18, v8, v16
  v_mul_f32 v17, v18, v18
  v_sub_f32 v18, v9, v16
  v_fmac_f32 v17, v18, v18
  v_sub_f32 v18, v10, v16
  v_fmac_f32 v17, v18, v18
  v_sub_f32 v18, v11, v16
  v_fmac_f32 v17, v18, v18
  v_sub_f32 v18, v12, v16
  v_fmac_f32 v17, v18, v18
  v_sub_f32 v18, v13, v16
  v_fmac_f32 v17, v18, v18
  v_sub_f32 v18, v14, v16
  v_fmac_f32 v17, v18, v18
  v_sub_f32 v18, v15, v16
  v_fmac_f32 v17, v18, v18
  s_nop 1
  v_add_f32_dpp v17, v17, v17 row_ror:1 row_mask:0xf bank_mask:0xf
  s_nop 1
  v_add_f32_dpp v17, v17, v17 row_ror:2 row_mask:0xf bank_mask:0xf
  s_nop 1
  v_add_f32_dpp v17, v17, v17 row_ror:4 row_mask:0xf bank_mask:0xf
  s_nop 1
  v_add_f32_dpp v17, v17, v17 row_ror:8 row_mask:0xf bank_mask:0xf
  s_nop 1
  v_mov_b32 v18, v17
  s_nop 1
  v_permlane16_swap_b32 v17, v18
  v_add_f32 v17, v17, v18
  v_mov_b32 v18, v17
  s_nop 1
  v_permlane32_swap_b32 v17, v18
  v_add_f32 v17, v17, v18
  v_mul_f32 v17, 0x3b000000, v17
  v_cvt_pk_bf16_f32 v17, v17, v17
  v_lshlrev_b32 v17, 16, v17
  v_cvt_pk_bf16_f32 v16, v16, v16
  v_lshlrev_b32 v16, 16, v16
  v_add_f32 v17, 0x3727c5ac, v17
  v_cvt_pk_bf16_f32 v17, v17, v17
  v_lshlrev_b32 v17, 16, v17
  v_sqrt_f32 v17, v17
  s_nop 0
  v_cvt_pk_bf16_f32 v17, v17, v17
  v_lshlrev_b32 v17, 16, v17
  v_rcp_f32 v18, v17
  s_nop 0
  v_fma_f32 v20, -v17, v18, 2.0
  v_mul_f32 v18, v18, v20
  v_sub_f32 v8, v8, v16
  v_cvt_pk_bf16_f32 v8, v8, v8
  v_lshlrev_b32 v8, 16, v8
  v_mul_f32 v20, v8, v18
  v_fma_f32 v21, -v20, v17, v8
  v_fma_f32 v8, v21, v18, v20
  v_sub_f32 v9, v9, v16
  v_cvt_pk_bf16_f32 v9, v9, v9
  v_lshlrev_b32 v9, 16, v9
  v_mul_f32 v20, v9, v18
  v_fma_f32 v21, -v20, v17, v9
  v_fma_f32 v9, v21, v18, v20
  v_sub_f32 v10, v10, v16
  v_cvt_pk_bf16_f32 v10, v10, v10
  v_lshlrev_b32 v10, 16, v10
  v_mul_f32 v20, v10, v18
  v_fma_f32 v21, -v20, v17, v10
  v_fma_f32 v10, v21, v18, v20
  v_sub_f32 v11, v11, v16
  v_cvt_pk_bf16_f32 v11, v11, v11
  v_lshlrev_b32 v11, 16, v11
  v_mul_f32 v20, v11, v18
  v_fma_f32 v21, -v20, v17, v11
  v_fma_f32 v11, v21, v18, v20
  v_sub_f32 v12, v12, v16
  v_cvt_pk_bf16_f32 v12, v12, v12
  v_lshlrev_b32 v12, 16, v12
  v_mul_f32 v20, v12, v18
  v_fma_f32 v21, -v20, v17, v12
  v_fma_f32 v12, v21, v18, v20
  v_sub_f32 v13, v13, v16
  v_cvt_pk_bf16_f32 v13, v13, v13
  v_lshlrev_b32 v13, 16, v13
  v_mul_f32 v20, v13, v18
  v_fma_f32 v21, -v20, v17, v13
  v_fma_f32 v13, v21, v18, v20
  v_sub_f32 v14, v14, v16
  v_cvt_pk_bf16_f32 v14, v14, v14
  v_lshlrev_b32 v14, 16, v14
  v_mul_f32 v20, v14, v18
  v_fma_f32 v21, -v20, v17, v14
  v_fma_f32 v14, v21, v18, v20
  v_sub_f32 v15, v15, v16
  v_cvt_pk_bf16_f32 v15, v15, v15
  v_lshlrev_b32 v15, 16, v15
  v_mul_f32 v20, v15, v18
  v_fma_f32 v21, -v20, v17, v15
  v_fma_f32 v15, v21, v18, v20
  v_cvt_pk_bf16_f32 v48, v8, v9
  v_cvt_pk_bf16_f32 v49, v10, v11
  v_cvt_pk_bf16_f32 v50, v12, v13
  v_cvt_pk_bf16_f32 v51, v14, v15
  buffer_store_dwordx4 v[48:51], v5, s[4:7], 0 offen offset:2048 sc1
  s_waitcnt vmcnt(3)
  v_lshlrev_b32 v8, 16, v52
  v_and_b32 v9, 0xffff0000, v52
  v_lshlrev_b32 v10, 16, v53
  v_and_b32 v11, 0xffff0000, v53
  v_lshlrev_b32 v12, 16, v54
  v_and_b32 v13, 0xffff0000, v54
  v_lshlrev_b32 v14, 16, v55
  v_and_b32 v15, 0xffff0000, v55
  v_add_f32 v16, v8, v9
  v_add_f32 v16, v16, v10
  v_add_f32 v16, v16, v11
  v_add_f32 v16, v16, v12
  v_add_f32 v16, v16, v13
  v_add_f32 v16, v16, v14
  v_add_f32 v16, v16, v15
  s_nop 1
  v_add_f32_dpp v16, v16, v16 row_ror:1 row_mask:0xf bank_mask:0xf
  s_nop 1
  v_add_f32_dpp v16, v16, v16 row_ror:2 row_mask:0xf bank_mask:0xf
  s_nop 1
  v_add_f32_dpp v16, v16, v16 row_ror:4 row_mask:0xf bank_mask:0xf
  s_nop 1
  v_add_f32_dpp v16, v16, v16 row_ror:8 row_mask:0xf bank_mask:0xf
  s_nop 1
  v_mov_b32 v18, v16
  s_nop 1
  v_permlane16_swap_b32 v16, v18
  v_add_f32 v16, v16, v18
  v_mov_b32 v18, v16
  s_nop 1
  v_permlane32_swap_b32 v16, v18
  v_add_f32 v16, v16, v18
  v_mul_f32 v16, 0x3b000000, v16
  v_sub_f32 v18, v8, v16
  v_mul_f32 v17, v18, v18
  v_sub_f32 v18, v9, v16
  v_fmac_f32 v17, v18, v18
  v_sub_f32 v18, v10, v16
  v_fmac_f32 v17, v18, v18
  v_sub_f32 v18, v11, v16
  v_fmac_f32 v17, v18, v18
  v_sub_f32 v18, v12, v16
  v_fmac_f32 v17, v18, v18
  v_sub_f32 v18, v13, v16
  v_fmac_f32 v17, v18, v18
  v_sub_f32 v18, v14, v16
  v_fmac_f32 v17, v18, v18
  v_sub_f32 v18, v15, v16
  v_fmac_f32 v17, v18, v18
  s_nop 1
  v_add_f32_dpp v17, v17, v17 row_ror:1 row_mask:0xf bank_mask:0xf
  s_nop 1
  v_add_f32_dpp v17, v17, v17 row_ror:2 row_mask:0xf bank_mask:0xf
  s_nop 1
  v_add_f32_dpp v17, v17, v17 row_ror:4 row_mask:0xf bank_mask:0xf
  s_nop 1
  v_add_f32_dpp v17, v17, v17 row_ror:8 row_mask:0xf bank_mask:0xf
  s_nop 1
  v_mov_b32 v18, v17
  s_nop 1
  v_permlane16_swap_b32 v17, v18
  v_add_f32 v17, v17, v18
  v_mov_b32 v18, v17
  s_nop 1
  v_permlane32_swap_b32 v17, v18
  v_add_f32 v17, v17, v18
  v_mul_f32 v17, 0x3b000000, v17
  v_cvt_pk_bf16_f32 v17, v17, v17
  v_lshlrev_b32 v17, 16, v17
  v_cvt_pk_bf16_f32 v16, v16, v16
  v_lshlrev_b32 v16, 16, v16
  v_add_f32 v17, 0x3727c5ac, v17
  v_cvt_pk_bf16_f32 v17, v17, v17
  v_lshlrev_b32 v17, 16, v17
  v_sqrt_f32 v17, v17
  s_nop 0
  v_cvt_pk_bf16_f32 v17, v17, v17
  v_lshlrev_b32 v17, 16, v17
  v_rcp_f32 v18, v17
  s_nop 0
  v_fma_f32 v20, -v17, v18, 2.0
  v_mul_f32 v18, v18, v20
  v_sub_f32 v8, v8, v16
  v_cvt_pk_bf16_f32 v8, v8, v8
  v_lshlrev_b32 v8, 16, v8
  v_mul_f32 v20, v8, v18
  v_fma_f32 v21, -v20, v17, v8
  v_fma_f32 v8, v21, v18, v20
  v_sub_f32 v9, v9, v16
  v_cvt_pk_bf16_f32 v9, v9, v9
  v_lshlrev_b32 v9, 16, v9
  v_mul_f32 v20, v9, v18
  v_fma_f32 v21, -v20, v17, v9
  v_fma_f32 v9, v21, v18, v20
  v_sub_f32 v10, v10, v16
  v_cvt_pk_bf16_f32 v10, v10, v10
  v_lshlrev_b32 v10, 16, v10
  v_mul_f32 v20, v10, v18
  v_fma_f32 v21, -v20, v17, v10
  v_fma_f32 v10, v21, v18, v20
  v_sub_f32 v11, v11, v16
  v_cvt_pk_bf16_f32 v11, v11, v11
  v_lshlrev_b32 v11, 16, v11
  v_mul_f32 v20, v11, v18
  v_fma_f32 v21, -v20, v17, v11
  v_fma_f32 v11, v21, v18, v20
  v_sub_f32 v12, v12, v16
  v_cvt_pk_bf16_f32 v12, v12, v12
  v_lshlrev_b32 v12, 16, v12
  v_mul_f32 v20, v12, v18
  v_fma_f32 v21, -v20, v17, v12
  v_fma_f32 v12, v21, v18, v20
  v_sub_f32 v13, v13, v16
  v_cvt_pk_bf16_f32 v13, v13, v13
  v_lshlrev_b32 v13, 16, v13
  v_mul_f32 v20, v13, v18
  v_fma_f32 v21, -v20, v17, v13
  v_fma_f32 v13, v21, v18, v20
  v_sub_f32 v14, v14, v16
  v_cvt_pk_bf16_f32 v14, v14, v14
  v_lshlrev_b32 v14, 16, v14
  v_mul_f32 v20, v14, v18
  v_fma_f32 v21, -v20, v17, v14
  v_fma_f32 v14, v21, v18, v20
  v_sub_f32 v15, v15, v16
  v_cvt_pk_bf16_f32 v15, v15, v15
  v_lshlrev_b32 v15, 16, v15
  v_mul_f32 v20, v15, v18
  v_fma_f32 v21, -v20, v17, v15
  v_fma_f32 v15, v21, v18, v20
  v_cvt_pk_bf16_f32 v52, v8, v9
  v_cvt_pk_bf16_f32 v53, v10, v11
  v_cvt_pk_bf16_f32 v54, v12, v13
  v_cvt_pk_bf16_f32 v55, v14, v15
  buffer_store_dwordx4 v[52:55], v5, s[4:7], 0 offen offset:3072 sc1
  s_waitcnt vmcnt(0)
  s_barrier
  s_cmp_lg_u32 s18, 0
  s_cbranch_scc1 L_sig_41
  s_lshl_b32 s60, s26, 8
  s_lshl_b32 s61, s23, 2
  s_add_u32 s60, s60, s61
  s_add_u32 s60, s60, 98717696
  v_mov_b32 v2, s60
  v_mov_b32 v3, s69
  s_mov_b64 exec, 1
  buffer_store_dword v3, v2, s[4:7], 0 offen sc1
  s_mov_b64 exec, -1

L_sig_41:
  s_branch L_worker
L_task_qkv:
  s_mov_b32 s23, s27
  s_cmp_lg_u32 s18, 0
  s_cbranch_scc1 L_wo_43
  s_lshl_b32 s60, s26, 8
  s_add_u32 s60, s60, 98717696
  v_lshlrev_b32 v2, 2, v1
  v_add_u32 v2, s60, v2
  s_mov_b32 s62, 0

  s_mov_b64 exec, 0xf
L_wt_42:
  buffer_load_dword v3, v2, s[4:7], 0 offen sc1
  s_waitcnt vmcnt(0)
  v_cmp_ne_u32 vcc, s69, v3
  s_cbranch_vccz L_wo_43
  s_sleep 1
  s_add_u32 s62, s62, 1
  s_cmp_lt_u32 s62, 0x100000
  s_cbranch_scc1 L_wt_42

L_wo_43:
  s_mov_b64 exec, -1
  s_barrier
  s_mov_b32 s38, 1024
  s_mov_b32 s39, 8192
  s_lshl_b32 s30, s26, 17
  s_add_u32 s30, s30, 0
  s_lshl_b32 s31, s29, 8
  s_add_u32 s59, s31, 128
  s_mov_b32 s12, s80
  s_mov_b32 s13, s81
  s_cmp_eq_u32 s28, 1
  s_cselect_b32 s12, s82, s12
  s_cselect_b32 s13, s83, s13
  s_cmp_eq_u32 s28, 2
  s_cselect_b32 s12, s84, s12
  s_cselect_b32 s13, s85, s13
  s_mov_b32 s14, 0x400000
  s_mov_b32 s15, 0x00020000
  s_cbranch_scc1 L_tq_v

  s_lshr_b32 s36, s18, 1
  s_and_b32 s37, s18, 1
  v_lshrrev_b32 v17, 3, v1
  v_mul_lo_u32 v2, v17, s38
  v_and_b32 v18, 7, v1
  v_lshrrev_b32 v19, 4, v1
  v_xor_b32 v18, v18, v19
  v_lshl_add_u32 v2, v18, 4, v2
  v_xor_b32 v3, 64, v2

  v_lshrrev_b32 v17, 3, v1
  v_mul_lo_u32 v4, v17, s39
  v_lshrrev_b32 v18, 4, v1
  v_and_b32 v18, 1, v18
  v_lshlrev_b32 v18, 2, v18
  v_and_b32 v19, 7, v1
  v_xor_b32 v19, v19, v18
  v_lshl_add_u32 v4, v19, 4, v4
  v_and_b32 v17, 31, v1
  v_lshrrev_b32 v18, 1, v17
  v_and_b32 v18, 7, v18
  v_lshrrev_b32 v19, 5, v1
  v_xor_b32 v18, v18, v19
  s_mul_i32 s34, s36, 8192
  v_lshlrev_b32 v17, 7, v17
  v_add_u32 v17, s34, v17

  v_xor_b32 v19, 0, v18
  v_lshl_add_u32 v5, v19, 4, v17
  v_add_u32 v9, 65536, v5
  v_xor_b32 v19, 2, v18
  v_lshl_add_u32 v6, v19, 4, v17
  v_add_u32 v10, 65536, v6
  v_xor_b32 v19, 4, v18
  v_lshl_add_u32 v7, v19, 4, v17
  v_add_u32 v11, 65536, v7
  v_xor_b32 v19, 6, v18
  v_lshl_add_u32 v8, v19, 4, v17
  v_add_u32 v12, 65536, v8
  v_lshrrev_b32 v17, 5, v1
  v_lshlrev_b32 v17, 3, v17
  v_lshrrev_b32 v18, 2, v1
  v_and_b32 v18, 3, v18
  v_add_u32 v17, v17, v18
  v_lshlrev_b32 v17, 7, v17
  v_lshrrev_b32 v18, 1, v18
  v_lshl_add_u32 v17, v18, 6, v17
  v_lshrrev_b32 v18, 4, v1
  v_and_b32 v18, 1, v18
  v_lshl_add_u32 v17, v18, 5, v17
  v_and_b32 v18, 3, v1
  v_lshl_add_u32 v17, v18, 3, v17
  s_mul_i32 s34, s37, 8192
  s_add_u32 s34, s34, 16384
  v_add_u32 v13, s34, v17
  v_xor_b32 v14, 64, v13
  v_add_u32 v15, 65536, v13
  v_add_u32 v16, 65536, v14

  s_mov_b32 s40, s30
  s_mul_i32 s34, s18, s38
  s_mul_i32 s34, s34, 32
  s_add_u32 s40, s40, s34
  s_mov_b32 s41, s31
  s_mov_b32 s42, s59
  s_mul_i32 s34, s18, s39
  s_lshl_b32 s34, s34, 4
  s_add_u32 s41, s41, s34
  s_add_u32 s42, s42, s34
  s_lshl_b32 s35, s18, 10
  s_mul_i32 s48, s38, 0
  s_mul_i32 s49, s38, 8
  s_mul_i32 s50, s38, 16
  s_mul_i32 s51, s38, 24
  s_lshl_b32 s56, s39, 3
  s_lshl_b32 s57, s39, 6
  s_mul_i32 s34, s18, 4096
  s_add_u32 s34, s34, 0
  s_add_u32 m0, s34, 0
  s_add_u32 s35, s40, s48
  buffer_load_dwordx4 v2, s[4:7], s35 offen sc1 lds
  s_add_u32 m0, s34, 1024
  s_add_u32 s35, s40, s49
  buffer_load_dwordx4 v3, s[4:7], s35 offen sc1 lds
  s_add_u32 m0, s34, 2048
  s_add_u32 s35, s40, s50
  buffer_load_dwordx4 v2, s[4:7], s35 offen sc1 lds
  s_add_u32 m0, s34, 3072
  s_add_u32 s35, s40, s51
  buffer_load_dwordx4 v3, s[4:7], s35 offen sc1 lds
  s_add_u32 s40, s40, 128
  s_lshl_b32 s34, s18, 11
  s_add_u32 s34, s34, 16384
  s_add_u32 m0, s34, 0
  s_nop 0
  buffer_load_dwordx4 v4, s[12:15], s41 offen lds
  s_add_u32 m0, s34, 1024
  s_add_u32 s35, s41, s56
  buffer_load_dwordx4 v4, s[12:15], s35 offen lds
  s_add_u32 s41, s41, s57
  s_add_u32 m0, s34, 8192
  s_nop 0
  buffer_load_dwordx4 v4, s[12:15], s42 offen lds
  s_add_u32 m0, s34, 9216
  s_add_u32 s35, s42, s56
  buffer_load_dwordx4 v4, s[12:15], s35 offen lds
  s_add_u32 s42, s42, s57
  s_mul_i32 s34, s18, 4096
  s_add_u32 s34, s34, 32768
  s_add_u32 m0, s34, 0
  s_add_u32 s35, s40, s48
  buffer_load_dwordx4 v2, s[4:7], s35 offen sc1 lds
  s_add_u32 m0, s34, 1024
  s_add_u32 s35, s40, s49
  buffer_load_dwordx4 v3, s[4:7], s35 offen sc1 lds
  s_add_u32 m0, s34, 2048
  s_add_u32 s35, s40, s50
  buffer_load_dwordx4 v2, s[4:7], s35 offen sc1 lds
  s_add_u32 m0, s34, 3072
  s_add_u32 s35, s40, s51
  buffer_load_dwordx4 v3, s[4:7], s35 offen sc1 lds
  s_add_u32 s40, s40, 128
  s_lshl_b32 s34, s18, 11
  s_add_u32 s34, s34, 49152
  s_add_u32 m0, s34, 0
  s_nop 0
  buffer_load_dwordx4 v4, s[12:15], s41 offen lds
  s_add_u32 m0, s34, 1024
  s_add_u32 s35, s41, s56
  buffer_load_dwordx4 v4, s[12:15], s35 offen lds
  s_add_u32 s41, s41, s57
  s_add_u32 m0, s34, 8192
  s_nop 0
  buffer_load_dwordx4 v4, s[12:15], s42 offen lds
  s_add_u32 m0, s34, 9216
  s_add_u32 s35, s42, s56
  buffer_load_dwordx4 v4, s[12:15], s35 offen lds
  s_add_u32 s42, s42, s57
  s_mul_i32 s34, s18, 4096
  s_add_u32 s34, s34, 65536
  s_add_u32 m0, s34, 0
  s_add_u32 s35, s40, s48
  buffer_load_dwordx4 v2, s[4:7], s35 offen sc1 lds
  s_add_u32 m0, s34, 1024
  s_add_u32 s35, s40, s49
  buffer_load_dwordx4 v3, s[4:7], s35 offen sc1 lds
  s_add_u32 m0, s34, 2048
  s_add_u32 s35, s40, s50
  buffer_load_dwordx4 v2, s[4:7], s35 offen sc1 lds
  s_add_u32 m0, s34, 3072
  s_add_u32 s35, s40, s51
  buffer_load_dwordx4 v3, s[4:7], s35 offen sc1 lds
  s_add_u32 s40, s40, 128
  s_lshl_b32 s34, s18, 11
  s_add_u32 s34, s34, 81920
  s_add_u32 m0, s34, 0
  s_nop 0
  buffer_load_dwordx4 v4, s[12:15], s41 offen lds
  s_add_u32 m0, s34, 1024
  s_add_u32 s35, s41, s56
  buffer_load_dwordx4 v4, s[12:15], s35 offen lds
  s_add_u32 s41, s41, s57
  s_add_u32 m0, s34, 8192
  s_nop 0
  buffer_load_dwordx4 v4, s[12:15], s42 offen lds
  s_add_u32 m0, s34, 9216
  s_add_u32 s35, s42, s56
  buffer_load_dwordx4 v4, s[12:15], s35 offen lds
  s_add_u32 s42, s42, s57
  s_waitcnt vmcnt(16)
  s_barrier
  s_mul_i32 s34, s18, 4096
  s_add_u32 s34, s34, 98304
  s_add_u32 m0, s34, 0
  s_add_u32 s35, s40, s48
  buffer_load_dwordx4 v2, s[4:7], s35 offen sc1 lds
  s_add_u32 m0, s34, 1024
  s_add_u32 s35, s40, s49
  buffer_load_dwordx4 v3, s[4:7], s35 offen sc1 lds
  s_add_u32 m0, s34, 2048
  s_add_u32 s35, s40, s50
  buffer_load_dwordx4 v2, s[4:7], s35 offen sc1 lds
  s_add_u32 m0, s34, 3072
  s_add_u32 s35, s40, s51
  buffer_load_dwordx4 v3, s[4:7], s35 offen sc1 lds
  s_add_u32 s40, s40, 128
  s_lshl_b32 s34, s18, 11
  s_add_u32 s34, s34, 114688
  s_add_u32 m0, s34, 0
  s_nop 0
  buffer_load_dwordx4 v4, s[12:15], s41 offen lds
  s_add_u32 m0, s34, 1024
  s_add_u32 s35, s41, s56
  buffer_load_dwordx4 v4, s[12:15], s35 offen lds
  s_add_u32 s41, s41, s57
  s_add_u32 m0, s34, 8192
  s_nop 0
  buffer_load_dwordx4 v4, s[12:15], s42 offen lds
  s_add_u32 m0, s34, 9216
  s_add_u32 s35, s42, s56
  buffer_load_dwordx4 v4, s[12:15], s35 offen lds
  s_add_u32 s42, s42, s57
  ds_read_b128 v[24:27], v5 offset:0
  ds_read_b128 v[28:31], v5 offset:4096
  ds_read_b64_tr_b16 v[40:41], v13 offset:0
  ds_read_b64_tr_b16 v[42:43], v13 offset:512
  ds_read_b64_tr_b16 v[44:45], v14 offset:0
  ds_read_b64_tr_b16 v[46:47], v14 offset:512
  ds_read_b128 v[32:35], v6 offset:0
  ds_read_b128 v[36:39], v6 offset:4096
  ds_read_b64_tr_b16 v[48:49], v13 offset:2048
  ds_read_b64_tr_b16 v[50:51], v13 offset:2560
  ds_read_b64_tr_b16 v[52:53], v14 offset:2048
  ds_read_b64_tr_b16 v[54:55], v14 offset:2560
  s_waitcnt lgkmcnt(6)
  v_mfma_f32_32x32x16_bf16 a[0:15], v[40:43], v[24:27], 0
  v_mfma_f32_32x32x16_bf16 a[16:31], v[44:47], v[24:27], 0
  v_mfma_f32_32x32x16_bf16 a[32:47], v[40:43], v[28:31], 0
  v_mfma_f32_32x32x16_bf16 a[48:63], v[44:47], v[28:31], 0
  ds_read_b128 v[24:27], v7 offset:0
  ds_read_b128 v[28:31], v7 offset:4096
  ds_read_b64_tr_b16 v[40:41], v13 offset:4096
  ds_read_b64_tr_b16 v[42:43], v13 offset:4608
  ds_read_b64_tr_b16 v[44:45], v14 offset:4096
  ds_read_b64_tr_b16 v[46:47], v14 offset:4608
  s_waitcnt lgkmcnt(6)
  v_mfma_f32_32x32x16_bf16 a[0:15], v[48:51], v[32:35], a[0:15]
  v_mfma_f32_32x32x16_bf16 a[16:31], v[52:55], v[32:35], a[16:31]
  v_mfma_f32_32x32x16_bf16 a[32:47], v[48:51], v[36:39], a[32:47]
  v_mfma_f32_32x32x16_bf16 a[48:63], v[52:55], v[36:39], a[48:63]
  ds_read_b128 v[32:35], v8 offset:0
  ds_read_b128 v[36:39], v8 offset:4096
  ds_read_b64_tr_b16 v[48:49], v13 offset:6144
  ds_read_b64_tr_b16 v[50:51], v13 offset:6656
  ds_read_b64_tr_b16 v[52:53], v14 offset:6144
  ds_read_b64_tr_b16 v[54:55], v14 offset:6656
  s_waitcnt lgkmcnt(6)
  v_mfma_f32_32x32x16_bf16 a[0:15], v[40:43], v[24:27], a[0:15]
  v_mfma_f32_32x32x16_bf16 a[16:31], v[44:47], v[24:27], a[16:31]
  v_mfma_f32_32x32x16_bf16 a[32:47], v[40:43], v[28:31], a[32:47]
  v_mfma_f32_32x32x16_bf16 a[48:63], v[44:47], v[28:31], a[48:63]
  s_waitcnt lgkmcnt(0)
  v_mfma_f32_32x32x16_bf16 a[0:15], v[48:51], v[32:35], a[0:15]
  v_mfma_f32_32x32x16_bf16 a[16:31], v[52:55], v[32:35], a[16:31]
  v_mfma_f32_32x32x16_bf16 a[32:47], v[48:51], v[36:39], a[32:47]
  v_mfma_f32_32x32x16_bf16 a[48:63], v[52:55], v[36:39], a[48:63]
  s_waitcnt vmcnt(16)
  s_barrier
  s_mul_i32 s34, s18, 4096
  s_add_u32 s34, s34, 0
  s_add_u32 m0, s34, 0
  s_add_u32 s35, s40, s48
  buffer_load_dwordx4 v2, s[4:7], s35 offen sc1 lds
  s_add_u32 m0, s34, 1024
  s_add_u32 s35, s40, s49
  buffer_load_dwordx4 v3, s[4:7], s35 offen sc1 lds
  s_add_u32 m0, s34, 2048
  s_add_u32 s35, s40, s50
  buffer_load_dwordx4 v2, s[4:7], s35 offen sc1 lds
  s_add_u32 m0, s34, 3072
  s_add_u32 s35, s40, s51
  buffer_load_dwordx4 v3, s[4:7], s35 offen sc1 lds
  s_add_u32 s40, s40, 128
  s_lshl_b32 s34, s18, 11
  s_add_u32 s34, s34, 16384
  s_add_u32 m0, s34, 0
  s_nop 0
  buffer_load_dwordx4 v4, s[12:15], s41 offen lds
  s_add_u32 m0, s34, 1024
  s_add_u32 s35, s41, s56
  buffer_load_dwordx4 v4, s[12:15], s35 offen lds
  s_add_u32 s41, s41, s57
  s_add_u32 m0, s34, 8192
  s_nop 0
  buffer_load_dwordx4 v4, s[12:15], s42 offen lds
  s_add_u32 m0, s34, 9216
  s_add_u32 s35, s42, s56
  buffer_load_dwordx4 v4, s[12:15], s35 offen lds
  s_add_u32 s42, s42, s57
  ds_read_b128 v[24:27], v5 offset:32768
  ds_read_b128 v[28:31], v5 offset:36864
  ds_read_b64_tr_b16 v[40:41], v13 offset:32768
  ds_read_b64_tr_b16 v[42:43], v13 offset:33280
  ds_read_b64_tr_b16 v[44:45], v14 offset:32768
  ds_read_b64_tr_b16 v[46:47], v14 offset:33280
  ds_read_b128 v[32:35], v6 offset:32768
  ds_read_b128 v[36:39], v6 offset:36864
  ds_read_b64_tr_b16 v[48:49], v13 offset:34816
  ds_read_b64_tr_b16 v[50:51], v13 offset:35328
  ds_read_b64_tr_b16 v[52:53], v14 offset:34816
  ds_read_b64_tr_b16 v[54:55], v14 offset:35328
  s_waitcnt lgkmcnt(6)
  v_mfma_f32_32x32x16_bf16 a[0:15], v[40:43], v[24:27], a[0:15]
  v_mfma_f32_32x32x16_bf16 a[16:31], v[44:47], v[24:27], a[16:31]
  v_mfma_f32_32x32x16_bf16 a[32:47], v[40:43], v[28:31], a[32:47]
  v_mfma_f32_32x32x16_bf16 a[48:63], v[44:47], v[28:31], a[48:63]
  ds_read_b128 v[24:27], v7 offset:32768
  ds_read_b128 v[28:31], v7 offset:36864
  ds_read_b64_tr_b16 v[40:41], v13 offset:36864
  ds_read_b64_tr_b16 v[42:43], v13 offset:37376
  ds_read_b64_tr_b16 v[44:45], v14 offset:36864
  ds_read_b64_tr_b16 v[46:47], v14 offset:37376
  s_waitcnt lgkmcnt(6)
  v_mfma_f32_32x32x16_bf16 a[0:15], v[48:51], v[32:35], a[0:15]
  v_mfma_f32_32x32x16_bf16 a[16:31], v[52:55], v[32:35], a[16:31]
  v_mfma_f32_32x32x16_bf16 a[32:47], v[48:51], v[36:39], a[32:47]
  v_mfma_f32_32x32x16_bf16 a[48:63], v[52:55], v[36:39], a[48:63]
  ds_read_b128 v[32:35], v8 offset:32768
  ds_read_b128 v[36:39], v8 offset:36864
  ds_read_b64_tr_b16 v[48:49], v13 offset:38912
  ds_read_b64_tr_b16 v[50:51], v13 offset:39424
  ds_read_b64_tr_b16 v[52:53], v14 offset:38912
  ds_read_b64_tr_b16 v[54:55], v14 offset:39424
  s_waitcnt lgkmcnt(6)
  v_mfma_f32_32x32x16_bf16 a[0:15], v[40:43], v[24:27], a[0:15]
  v_mfma_f32_32x32x16_bf16 a[16:31], v[44:47], v[24:27], a[16:31]
  v_mfma_f32_32x32x16_bf16 a[32:47], v[40:43], v[28:31], a[32:47]
  v_mfma_f32_32x32x16_bf16 a[48:63], v[44:47], v[28:31], a[48:63]
  s_waitcnt lgkmcnt(0)
  v_mfma_f32_32x32x16_bf16 a[0:15], v[48:51], v[32:35], a[0:15]
  v_mfma_f32_32x32x16_bf16 a[16:31], v[52:55], v[32:35], a[16:31]
  v_mfma_f32_32x32x16_bf16 a[32:47], v[48:51], v[36:39], a[32:47]
  v_mfma_f32_32x32x16_bf16 a[48:63], v[52:55], v[36:39], a[48:63]
  s_waitcnt vmcnt(16)
  s_barrier
  s_mul_i32 s34, s18, 4096
  s_add_u32 s34, s34, 32768
  s_add_u32 m0, s34, 0
  s_add_u32 s35, s40, s48
  buffer_load_dwordx4 v2, s[4:7], s35 offen sc1 lds
  s_add_u32 m0, s34, 1024
  s_add_u32 s35, s40, s49
  buffer_load_dwordx4 v3, s[4:7], s35 offen sc1 lds
  s_add_u32 m0, s34, 2048
  s_add_u32 s35, s40, s50
  buffer_load_dwordx4 v2, s[4:7], s35 offen sc1 lds
  s_add_u32 m0, s34, 3072
  s_add_u32 s35, s40, s51
  buffer_load_dwordx4 v3, s[4:7], s35 offen sc1 lds
  s_add_u32 s40, s40, 128
  s_lshl_b32 s34, s18, 11
  s_add_u32 s34, s34, 49152
  s_add_u32 m0, s34, 0
  s_nop 0
  buffer_load_dwordx4 v4, s[12:15], s41 offen lds
  s_add_u32 m0, s34, 1024
  s_add_u32 s35, s41, s56
  buffer_load_dwordx4 v4, s[12:15], s35 offen lds
  s_add_u32 s41, s41, s57
  s_add_u32 m0, s34, 8192
  s_nop 0
  buffer_load_dwordx4 v4, s[12:15], s42 offen lds
  s_add_u32 m0, s34, 9216
  s_add_u32 s35, s42, s56
  buffer_load_dwordx4 v4, s[12:15], s35 offen lds
  s_add_u32 s42, s42, s57
  ds_read_b128 v[24:27], v9 offset:0
  ds_read_b128 v[28:31], v9 offset:4096
  ds_read_b64_tr_b16 v[40:41], v15 offset:0
  ds_read_b64_tr_b16 v[42:43], v15 offset:512
  ds_read_b64_tr_b16 v[44:45], v16 offset:0
  ds_read_b64_tr_b16 v[46:47], v16 offset:512
  ds_read_b128 v[32:35], v10 offset:0
  ds_read_b128 v[36:39], v10 offset:4096
  ds_read_b64_tr_b16 v[48:49], v15 offset:2048
  ds_read_b64_tr_b16 v[50:51], v15 offset:2560
  ds_read_b64_tr_b16 v[52:53], v16 offset:2048
  ds_read_b64_tr_b16 v[54:55], v16 offset:2560
  s_waitcnt lgkmcnt(6)
  v_mfma_f32_32x32x16_bf16 a[0:15], v[40:43], v[24:27], a[0:15]
  v_mfma_f32_32x32x16_bf16 a[16:31], v[44:47], v[24:27], a[16:31]
  v_mfma_f32_32x32x16_bf16 a[32:47], v[40:43], v[28:31], a[32:47]
  v_mfma_f32_32x32x16_bf16 a[48:63], v[44:47], v[28:31], a[48:63]
  ds_read_b128 v[24:27], v11 offset:0
  ds_read_b128 v[28:31], v11 offset:4096
  ds_read_b64_tr_b16 v[40:41], v15 offset:4096
  ds_read_b64_tr_b16 v[42:43], v15 offset:4608
  ds_read_b64_tr_b16 v[44:45], v16 offset:4096
  ds_read_b64_tr_b16 v[46:47], v16 offset:4608
  s_waitcnt lgkmcnt(6)
  v_mfma_f32_32x32x16_bf16 a[0:15], v[48:51], v[32:35], a[0:15]
  v_mfma_f32_32x32x16_bf16 a[16:31], v[52:55], v[32:35], a[16:31]
  v_mfma_f32_32x32x16_bf16 a[32:47], v[48:51], v[36:39], a[32:47]
  v_mfma_f32_32x32x16_bf16 a[48:63], v[52:55], v[36:39], a[48:63]
  ds_read_b128 v[32:35], v12 offset:0
  ds_read_b128 v[36:39], v12 offset:4096
  ds_read_b64_tr_b16 v[48:49], v15 offset:6144
  ds_read_b64_tr_b16 v[50:51], v15 offset:6656
  ds_read_b64_tr_b16 v[52:53], v16 offset:6144
  ds_read_b64_tr_b16 v[54:55], v16 offset:6656
  s_waitcnt lgkmcnt(6)
  v_mfma_f32_32x32x16_bf16 a[0:15], v[40:43], v[24:27], a[0:15]
  v_mfma_f32_32x32x16_bf16 a[16:31], v[44:47], v[24:27], a[16:31]
  v_mfma_f32_32x32x16_bf16 a[32:47], v[40:43], v[28:31], a[32:47]
  v_mfma_f32_32x32x16_bf16 a[48:63], v[44:47], v[28:31], a[48:63]
  s_waitcnt lgkmcnt(0)
  v_mfma_f32_32x32x16_bf16 a[0:15], v[48:51], v[32:35], a[0:15]
  v_mfma_f32_32x32x16_bf16 a[16:31], v[52:55], v[32:35], a[16:31]
  v_mfma_f32_32x32x16_bf16 a[32:47], v[48:51], v[36:39], a[32:47]
  v_mfma_f32_32x32x16_bf16 a[48:63], v[52:55], v[36:39], a[48:63]
  s_waitcnt vmcnt(16)
  s_barrier
  s_mul_i32 s34, s18, 4096
  s_add_u32 s34, s34, 65536
  s_add_u32 m0, s34, 0
  s_add_u32 s35, s40, s48
  buffer_load_dwordx4 v2, s[4:7], s35 offen sc1 lds
  s_add_u32 m0, s34, 1024
  s_add_u32 s35, s40, s49
  buffer_load_dwordx4 v3, s[4:7], s35 offen sc1 lds
  s_add_u32 m0, s34, 2048
  s_add_u32 s35, s40, s50
  buffer_load_dwordx4 v2, s[4:7], s35 offen sc1 lds
  s_add_u32 m0, s34, 3072
  s_add_u32 s35, s40, s51
  buffer_load_dwordx4 v3, s[4:7], s35 offen sc1 lds
  s_add_u32 s40, s40, 128
  s_lshl_b32 s34, s18, 11
  s_add_u32 s34, s34, 81920
  s_add_u32 m0, s34, 0
  s_nop 0
  buffer_load_dwordx4 v4, s[12:15], s41 offen lds
  s_add_u32 m0, s34, 1024
  s_add_u32 s35, s41, s56
  buffer_load_dwordx4 v4, s[12:15], s35 offen lds
  s_add_u32 s41, s41, s57
  s_add_u32 m0, s34, 8192
  s_nop 0
  buffer_load_dwordx4 v4, s[12:15], s42 offen lds
  s_add_u32 m0, s34, 9216
  s_add_u32 s35, s42, s56
  buffer_load_dwordx4 v4, s[12:15], s35 offen lds
  s_add_u32 s42, s42, s57
  ds_read_b128 v[24:27], v9 offset:32768
  ds_read_b128 v[28:31], v9 offset:36864
  ds_read_b64_tr_b16 v[40:41], v15 offset:32768
  ds_read_b64_tr_b16 v[42:43], v15 offset:33280
  ds_read_b64_tr_b16 v[44:45], v16 offset:32768
  ds_read_b64_tr_b16 v[46:47], v16 offset:33280
  ds_read_b128 v[32:35], v10 offset:32768
  ds_read_b128 v[36:39], v10 offset:36864
  ds_read_b64_tr_b16 v[48:49], v15 offset:34816
  ds_read_b64_tr_b16 v[50:51], v15 offset:35328
  ds_read_b64_tr_b16 v[52:53], v16 offset:34816
  ds_read_b64_tr_b16 v[54:55], v16 offset:35328
  s_waitcnt lgkmcnt(6)
  v_mfma_f32_32x32x16_bf16 a[0:15], v[40:43], v[24:27], a[0:15]
  v_mfma_f32_32x32x16_bf16 a[16:31], v[44:47], v[24:27], a[16:31]
  v_mfma_f32_32x32x16_bf16 a[32:47], v[40:43], v[28:31], a[32:47]
  v_mfma_f32_32x32x16_bf16 a[48:63], v[44:47], v[28:31], a[48:63]
  ds_read_b128 v[24:27], v11 offset:32768
  ds_read_b128 v[28:31], v11 offset:36864
  ds_read_b64_tr_b16 v[40:41], v15 offset:36864
  ds_read_b64_tr_b16 v[42:43], v15 offset:37376
  ds_read_b64_tr_b16 v[44:45], v16 offset:36864
  ds_read_b64_tr_b16 v[46:47], v16 offset:37376
  s_waitcnt lgkmcnt(6)
  v_mfma_f32_32x32x16_bf16 a[0:15], v[48:51], v[32:35], a[0:15]
  v_mfma_f32_32x32x16_bf16 a[16:31], v[52:55], v[32:35], a[16:31]
  v_mfma_f32_32x32x16_bf16 a[32:47], v[48:51], v[36:39], a[32:47]
  v_mfma_f32_32x32x16_bf16 a[48:63], v[52:55], v[36:39], a[48:63]
  ds_read_b128 v[32:35], v12 offset:32768
  ds_read_b128 v[36:39], v12 offset:36864
  ds_read_b64_tr_b16 v[48:49], v15 offset:38912
  ds_read_b64_tr_b16 v[50:51], v15 offset:39424
  ds_read_b64_tr_b16 v[52:53], v16 offset:38912
  ds_read_b64_tr_b16 v[54:55], v16 offset:39424
  s_waitcnt lgkmcnt(6)
  v_mfma_f32_32x32x16_bf16 a[0:15], v[40:43], v[24:27], a[0:15]
  v_mfma_f32_32x32x16_bf16 a[16:31], v[44:47], v[24:27], a[16:31]
  v_mfma_f32_32x32x16_bf16 a[32:47], v[40:43], v[28:31], a[32:47]
  v_mfma_f32_32x32x16_bf16 a[48:63], v[44:47], v[28:31], a[48:63]
  s_waitcnt lgkmcnt(0)
  v_mfma_f32_32x32x16_bf16 a[0:15], v[48:51], v[32:35], a[0:15]
  v_mfma_f32_32x32x16_bf16 a[16:31], v[52:55], v[32:35], a[16:31]
  v_mfma_f32_32x32x16_bf16 a[32:47], v[48:51], v[36:39], a[32:47]
  v_mfma_f32_32x32x16_bf16 a[48:63], v[52:55], v[36:39], a[48:63]
  s_waitcnt vmcnt(16)
  s_barrier
  s_mul_i32 s34, s18, 4096
  s_add_u32 s34, s34, 98304
  s_add_u32 m0, s34, 0
  s_add_u32 s35, s40, s48
  buffer_load_dwordx4 v2, s[4:7], s35 offen sc1 lds
  s_add_u32 m0, s34, 1024
  s_add_u32 s35, s40, s49
  buffer_load_dwordx4 v3, s[4:7], s35 offen sc1 lds
  s_add_u32 m0, s34, 2048
  s_add_u32 s35, s40, s50
  buffer_load_dwordx4 v2, s[4:7], s35 offen sc1 lds
  s_add_u32 m0, s34, 3072
  s_add_u32 s35, s40, s51
  buffer_load_dwordx4 v3, s[4:7], s35 offen sc1 lds
  s_add_u32 s40, s40, 128
  s_lshl_b32 s34, s18, 11
  s_add_u32 s34, s34, 114688
  s_add_u32 m0, s34, 0
  s_nop 0
  buffer_load_dwordx4 v4, s[12:15], s41 offen lds
  s_add_u32 m0, s34, 1024
  s_add_u32 s35, s41, s56
  buffer_load_dwordx4 v4, s[12:15], s35 offen lds
  s_add_u32 s41, s41, s57
  s_add_u32 m0, s34, 8192
  s_nop 0
  buffer_load_dwordx4 v4, s[12:15], s42 offen lds
  s_add_u32 m0, s34, 9216
  s_add_u32 s35, s42, s56
  buffer_load_dwordx4 v4, s[12:15], s35 offen lds
  s_add_u32 s42, s42, s57
  ds_read_b128 v[24:27], v5 offset:0
  ds_read_b128 v[28:31], v5 offset:4096
  ds_read_b64_tr_b16 v[40:41], v13 offset:0
  ds_read_b64_tr_b16 v[42:43], v13 offset:512
  ds_read_b64_tr_b16 v[44:45], v14 offset:0
  ds_read_b64_tr_b16 v[46:47], v14 offset:512
  ds_read_b128 v[32:35], v6 offset:0
  ds_read_b128 v[36:39], v6 offset:4096
  ds_read_b64_tr_b16 v[48:49], v13 offset:2048
  ds_read_b64_tr_b16 v[50:51], v13 offset:2560
  ds_read_b64_tr_b16 v[52:53], v14 offset:2048
  ds_read_b64_tr_b16 v[54:55], v14 offset:2560
  s_waitcnt lgkmcnt(6)
  v_mfma_f32_32x32x16_bf16 a[0:15], v[40:43], v[24:27], a[0:15]
  v_mfma_f32_32x32x16_bf16 a[16:31], v[44:47], v[24:27], a[16:31]
  v_mfma_f32_32x32x16_bf16 a[32:47], v[40:43], v[28:31], a[32:47]
  v_mfma_f32_32x32x16_bf16 a[48:63], v[44:47], v[28:31], a[48:63]
  ds_read_b128 v[24:27], v7 offset:0
  ds_read_b128 v[28:31], v7 offset:4096
  ds_read_b64_tr_b16 v[40:41], v13 offset:4096
  ds_read_b64_tr_b16 v[42:43], v13 offset:4608
  ds_read_b64_tr_b16 v[44:45], v14 offset:4096
  ds_read_b64_tr_b16 v[46:47], v14 offset:4608
  s_waitcnt lgkmcnt(6)
  v_mfma_f32_32x32x16_bf16 a[0:15], v[48:51], v[32:35], a[0:15]
  v_mfma_f32_32x32x16_bf16 a[16:31], v[52:55], v[32:35], a[16:31]
  v_mfma_f32_32x32x16_bf16 a[32:47], v[48:51], v[36:39], a[32:47]
  v_mfma_f32_32x32x16_bf16 a[48:63], v[52:55], v[36:39], a[48:63]
  ds_read_b128 v[32:35], v8 offset:0
  ds_read_b128 v[36:39], v8 offset:4096
  ds_read_b64_tr_b16 v[48:49], v13 offset:6144
  ds_read_b64_tr_b16 v[50:51], v13 offset:6656
  ds_read_b64_tr_b16 v[52:53], v14 offset:6144
  ds_read_b64_tr_b16 v[54:55], v14 offset:6656
  s_waitcnt lgkmcnt(6)
  v_mfma_f32_32x32x16_bf16 a[0:15], v[40:43], v[24:27], a[0:15]
  v_mfma_f32_32x32x16_bf16 a[16:31], v[44:47], v[24:27], a[16:31]
  v_mfma_f32_32x32x16_bf16 a[32:47], v[40:43], v[28:31], a[32:47]
  v_mfma_f32_32x32x16_bf16 a[48:63], v[44:47], v[28:31], a[48:63]
  s_waitcnt lgkmcnt(0)
  v_mfma_f32_32x32x16_bf16 a[0:15], v[48:51], v[32:35], a[0:15]
  v_mfma_f32_32x32x16_bf16 a[16:31], v[52:55], v[32:35], a[16:31]
  v_mfma_f32_32x32x16_bf16 a[32:47], v[48:51], v[36:39], a[32:47]
  v_mfma_f32_32x32x16_bf16 a[48:63], v[52:55], v[36:39], a[48:63]
  s_waitcnt vmcnt(16)
  s_barrier
  ds_read_b128 v[24:27], v5 offset:32768
  ds_read_b128 v[28:31], v5 offset:36864
  ds_read_b64_tr_b16 v[40:41], v13 offset:32768
  ds_read_b64_tr_b16 v[42:43], v13 offset:33280
  ds_read_b64_tr_b16 v[44:45], v14 offset:32768
  ds_read_b64_tr_b16 v[46:47], v14 offset:33280
  ds_read_b128 v[32:35], v6 offset:32768
  ds_read_b128 v[36:39], v6 offset:36864
  ds_read_b64_tr_b16 v[48:49], v13 offset:34816
  ds_read_b64_tr_b16 v[50:51], v13 offset:35328
  ds_read_b64_tr_b16 v[52:53], v14 offset:34816
  ds_read_b64_tr_b16 v[54:55], v14 offset:35328
  s_waitcnt lgkmcnt(6)
  v_mfma_f32_32x32x16_bf16 a[0:15], v[40:43], v[24:27], a[0:15]
  v_mfma_f32_32x32x16_bf16 a[16:31], v[44:47], v[24:27], a[16:31]
  v_mfma_f32_32x32x16_bf16 a[32:47], v[40:43], v[28:31], a[32:47]
  v_mfma_f32_32x32x16_bf16 a[48:63], v[44:47], v[28:31], a[48:63]
  ds_read_b128 v[24:27], v7 offset:32768
  ds_read_b128 v[28:31], v7 offset:36864
  ds_read_b64_tr_b16 v[40:41], v13 offset:36864
  ds_read_b64_tr_b16 v[42:43], v13 offset:37376
  ds_read_b64_tr_b16 v[44:45], v14 offset:36864
  ds_read_b64_tr_b16 v[46:47], v14 offset:37376
  s_waitcnt lgkmcnt(6)
  v_mfma_f32_32x32x16_bf16 a[0:15], v[48:51], v[32:35], a[0:15]
  v_mfma_f32_32x32x16_bf16 a[16:31], v[52:55], v[32:35], a[16:31]
  v_mfma_f32_32x32x16_bf16 a[32:47], v[48:51], v[36:39], a[32:47]
  v_mfma_f32_32x32x16_bf16 a[48:63], v[52:55], v[36:39], a[48:63]
  ds_read_b128 v[32:35], v8 offset:32768
  ds_read_b128 v[36:39], v8 offset:36864
  ds_read_b64_tr_b16 v[48:49], v13 offset:38912
  ds_read_b64_tr_b16 v[50:51], v13 offset:39424
  ds_read_b64_tr_b16 v[52:53], v14 offset:38912
  ds_read_b64_tr_b16 v[54:55], v14 offset:39424
  s_waitcnt lgkmcnt(6)
  v_mfma_f32_32x32x16_bf16 a[0:15], v[40:43], v[24:27], a[0:15]
  v_mfma_f32_32x32x16_bf16 a[16:31], v[44:47], v[24:27], a[16:31]
  v_mfma_f32_32x32x16_bf16 a[32:47], v[40:43], v[28:31], a[32:47]
  v_mfma_f32_32x32x16_bf16 a[48:63], v[44:47], v[28:31], a[48:63]
  s_waitcnt lgkmcnt(0)
  v_mfma_f32_32x32x16_bf16 a[0:15], v[48:51], v[32:35], a[0:15]
  v_mfma_f32_32x32x16_bf16 a[16:31], v[52:55], v[32:35], a[16:31]
  v_mfma_f32_32x32x16_bf16 a[32:47], v[48:51], v[36:39], a[32:47]
  v_mfma_f32_32x32x16_bf16 a[48:63], v[52:55], v[36:39], a[48:63]
  s_waitcnt vmcnt(8)
  s_barrier
  ds_read_b128 v[24:27], v9 offset:0
  ds_read_b128 v[28:31], v9 offset:4096
  ds_read_b64_tr_b16 v[40:41], v15 offset:0
  ds_read_b64_tr_b16 v[42:43], v15 offset:512
  ds_read_b64_tr_b16 v[44:45], v16 offset:0
  ds_read_b64_tr_b16 v[46:47], v16 offset:512
  ds_read_b128 v[32:35], v10 offset:0
  ds_read_b128 v[36:39], v10 offset:4096
  ds_read_b64_tr_b16 v[48:49], v15 offset:2048
  ds_read_b64_tr_b16 v[50:51], v15 offset:2560
  ds_read_b64_tr_b16 v[52:53], v16 offset:2048
  ds_read_b64_tr_b16 v[54:55], v16 offset:2560
  s_waitcnt lgkmcnt(6)
  v_mfma_f32_32x32x16_bf16 a[0:15], v[40:43], v[24:27], a[0:15]
  v_mfma_f32_32x32x16_bf16 a[16:31], v[44:47], v[24:27], a[16:31]
  v_mfma_f32_32x32x16_bf16 a[32:47], v[40:43], v[28:31], a[32:47]
  v_mfma_f32_32x32x16_bf16 a[48:63], v[44:47], v[28:31], a[48:63]
  ds_read_b128 v[24:27], v11 offset:0
  ds_read_b128 v[28:31], v11 offset:4096
  ds_read_b64_tr_b16 v[40:41], v15 offset:4096
  ds_read_b64_tr_b16 v[42:43], v15 offset:4608
  ds_read_b64_tr_b16 v[44:45], v16 offset:4096
  ds_read_b64_tr_b16 v[46:47], v16 offset:4608
  s_waitcnt lgkmcnt(6)
  v_mfma_f32_32x32x16_bf16 a[0:15], v[48:51], v[32:35], a[0:15]
  v_mfma_f32_32x32x16_bf16 a[16:31], v[52:55], v[32:35], a[16:31]
  v_mfma_f32_32x32x16_bf16 a[32:47], v[48:51], v[36:39], a[32:47]
  v_mfma_f32_32x32x16_bf16 a[48:63], v[52:55], v[36:39], a[48:63]
  ds_read_b128 v[32:35], v12 offset:0
  ds_read_b128 v[36:39], v12 offset:4096
  ds_read_b64_tr_b16 v[48:49], v15 offset:6144
  ds_read_b64_tr_b16 v[50:51], v15 offset:6656
  ds_read_b64_tr_b16 v[52:53], v16 offset:6144
  ds_read_b64_tr_b16 v[54:55], v16 offset:6656
  s_waitcnt lgkmcnt(6)
  v_mfma_f32_32x32x16_bf16 a[0:15], v[40:43], v[24:27], a[0:15]
  v_mfma_f32_32x32x16_bf16 a[16:31], v[44:47], v[24:27], a[16:31]
  v_mfma_f32_32x32x16_bf16 a[32:47], v[40:43], v[28:31], a[32:47]
  v_mfma_f32_32x32x16_bf16 a[48:63], v[44:47], v[28:31], a[48:63]
  s_waitcnt lgkmcnt(0)
  v_mfma_f32_32x32x16_bf16 a[0:15], v[48:51], v[32:35], a[0:15]
  v_mfma_f32_32x32x16_bf16 a[16:31], v[52:55], v[32:35], a[16:31]
  v_mfma_f32_32x32x16_bf16 a[32:47], v[48:51], v[36:39], a[32:47]
  v_mfma_f32_32x32x16_bf16 a[48:63], v[52:55], v[36:39], a[48:63]
  s_waitcnt vmcnt(0)
  s_barrier
  ds_read_b128 v[24:27], v9 offset:32768
  ds_read_b128 v[28:31], v9 offset:36864
  ds_read_b64_tr_b16 v[40:41], v15 offset:32768
  ds_read_b64_tr_b16 v[42:43], v15 offset:33280
  ds_read_b64_tr_b16 v[44:45], v16 offset:32768
  ds_read_b64_tr_b16 v[46:47], v16 offset:33280
  ds_read_b128 v[32:35], v10 offset:32768
  ds_read_b128 v[36:39], v10 offset:36864
  ds_read_b64_tr_b16 v[48:49], v15 offset:34816
  ds_read_b64_tr_b16 v[50:51], v15 offset:35328
  ds_read_b64_tr_b16 v[52:53], v16 offset:34816
  ds_read_b64_tr_b16 v[54:55], v16 offset:35328
  s_waitcnt lgkmcnt(6)
  v_mfma_f32_32x32x16_bf16 a[0:15], v[40:43], v[24:27], a[0:15]
  v_mfma_f32_32x32x16_bf16 a[16:31], v[44:47], v[24:27], a[16:31]
  v_mfma_f32_32x32x16_bf16 a[32:47], v[40:43], v[28:31], a[32:47]
  v_mfma_f32_32x32x16_bf16 a[48:63], v[44:47], v[28:31], a[48:63]
  ds_read_b128 v[24:27], v11 offset:32768
  ds_read_b128 v[28:31], v11 offset:36864
  ds_read_b64_tr_b16 v[40:41], v15 offset:36864
  ds_read_b64_tr_b16 v[42:43], v15 offset:37376
  ds_read_b64_tr_b16 v[44:45], v16 offset:36864
  ds_read_b64_tr_b16 v[46:47], v16 offset:37376
  s_waitcnt lgkmcnt(6)
  v_mfma_f32_32x32x16_bf16 a[0:15], v[48:51], v[32:35], a[0:15]
  v_mfma_f32_32x32x16_bf16 a[16:31], v[52:55], v[32:35], a[16:31]
  v_mfma_f32_32x32x16_bf16 a[32:47], v[48:51], v[36:39], a[32:47]
  v_mfma_f32_32x32x16_bf16 a[48:63], v[52:55], v[36:39], a[48:63]
  ds_read_b128 v[32:35], v12 offset:32768
  ds_read_b128 v[36:39], v12 offset:36864
  ds_read_b64_tr_b16 v[48:49], v15 offset:38912
  ds_read_b64_tr_b16 v[50:51], v15 offset:39424
  ds_read_b64_tr_b16 v[52:53], v16 offset:38912
  ds_read_b64_tr_b16 v[54:55], v16 offset:39424
  s_waitcnt lgkmcnt(6)
  v_mfma_f32_32x32x16_bf16 a[0:15], v[40:43], v[24:27], a[0:15]
  v_mfma_f32_32x32x16_bf16 a[16:31], v[44:47], v[24:27], a[16:31]
  v_mfma_f32_32x32x16_bf16 a[32:47], v[40:43], v[28:31], a[32:47]
  v_mfma_f32_32x32x16_bf16 a[48:63], v[44:47], v[28:31], a[48:63]
  s_waitcnt lgkmcnt(0)
  v_mfma_f32_32x32x16_bf16 a[0:15], v[48:51], v[32:35], a[0:15]
  v_mfma_f32_32x32x16_bf16 a[16:31], v[52:55], v[32:35], a[16:31]
  v_mfma_f32_32x32x16_bf16 a[32:47], v[48:51], v[36:39], a[32:47]
  v_mfma_f32_32x32x16_bf16 a[48:63], v[52:55], v[36:39], a[48:63]
  s_nop 15
  s_mov_b32 s34, 4194304
  s_cmp_eq_u32 s28, 1
  s_cselect_b32 s34, 20971520, s34
  s_lshl_b32 s35, s26, 20
  s_add_u32 s34, s34, s35
  s_lshl_b32 s35, s36, 19
  s_add_u32 s34, s34, s35
  s_add_u32 s34, s34, s31
  s_lshl_b32 s35, s37, 7
  s_add_u32 s34, s34, s35
  v_and_b32 v2, 31, v1
  v_lshlrev_b32 v2, 13, v2
  v_lshrrev_b32 v3, 5, v1
  v_lshl_add_u32 v2, v3, 4, v2
  v_add_u32 v2, s34, v2
  v_add_u32 v3, 262144, v2

  v_accvgpr_read_b32 v12, a0
  v_accvgpr_read_b32 v13, a1
  v_accvgpr_read_b32 v14, a2
  v_accvgpr_read_b32 v15, a3
  v_accvgpr_read_b32 v16, a4
  v_accvgpr_read_b32 v17, a5
  v_accvgpr_read_b32 v18, a6
  v_accvgpr_read_b32 v19, a7
  v_cvt_pk_bf16_f32 v8, v12, v13
  v_cvt_pk_bf16_f32 v9, v14, v15
  v_cvt_pk_bf16_f32 v10, v16, v17
  v_cvt_pk_bf16_f32 v11, v18, v19
  s_nop 1
  v_permlane32_swap_b32 v8, v10
  v_permlane32_swap_b32 v9, v11
  buffer_store_dwordx4 v[8:11], v2, s[4:7], 0 offen offset:0 sc1
  v_accvgpr_read_b32 v24, a8
  v_accvgpr_read_b32 v25, a9
  v_accvgpr_read_b32 v26, a10
  v_accvgpr_read_b32 v27, a11
  v_accvgpr_read_b32 v28, a12
  v_accvgpr_read_b32 v29, a13
  v_accvgpr_read_b32 v30, a14
  v_accvgpr_read_b32 v31, a15
  v_cvt_pk_bf16_f32 v20, v24, v25
  v_cvt_pk_bf16_f32 v21, v26, v27
  v_cvt_pk_bf16_f32 v22, v28, v29
  v_cvt_pk_bf16_f32 v23, v30, v31
  s_nop 1
  v_permlane32_swap_b32 v20, v22
  v_permlane32_swap_b32 v21, v23
  buffer_store_dwordx4 v[20:23], v2, s[4:7], 0 offen offset:32 sc1
  v_accvgpr_read_b32 v36, a16
  v_accvgpr_read_b32 v37, a17
  v_accvgpr_read_b32 v38, a18
  v_accvgpr_read_b32 v39, a19
  v_accvgpr_read_b32 v40, a20
  v_accvgpr_read_b32 v41, a21
  v_accvgpr_read_b32 v42, a22
  v_accvgpr_read_b32 v43, a23
  v_cvt_pk_bf16_f32 v32, v36, v37
  v_cvt_pk_bf16_f32 v33, v38, v39
  v_cvt_pk_bf16_f32 v34, v40, v41
  v_cvt_pk_bf16_f32 v35, v42, v43
  s_nop 1
  v_permlane32_swap_b32 v32, v34
  v_permlane32_swap_b32 v33, v35
  buffer_store_dwordx4 v[32:35], v2, s[4:7], 0 offen offset:64 sc1
  v_accvgpr_read_b32 v48, a24
  v_accvgpr_read_b32 v49, a25
  v_accvgpr_read_b32 v50, a26
  v_accvgpr_read_b32 v51, a27
  v_accvgpr_read_b32 v52, a28
  v_accvgpr_read_b32 v53, a29
  v_accvgpr_read_b32 v54, a30
  v_accvgpr_read_b32 v55, a31
  v_cvt_pk_bf16_f32 v44, v48, v49
  v_cvt_pk_bf16_f32 v45, v50, v51
  v_cvt_pk_bf16_f32 v46, v52, v53
  v_cvt_pk_bf16_f32 v47, v54, v55
  s_nop 1
  v_permlane32_swap_b32 v44, v46
  v_permlane32_swap_b32 v45, v47
  buffer_store_dwordx4 v[44:47], v2, s[4:7], 0 offen offset:96 sc1
  v_accvgpr_read_b32 v12, a32
  v_accvgpr_read_b32 v13, a33
  v_accvgpr_read_b32 v14, a34
  v_accvgpr_read_b32 v15, a35
  v_accvgpr_read_b32 v16, a36
  v_accvgpr_read_b32 v17, a37
  v_accvgpr_read_b32 v18, a38
  v_accvgpr_read_b32 v19, a39
  v_cvt_pk_bf16_f32 v8, v12, v13
  v_cvt_pk_bf16_f32 v9, v14, v15
  v_cvt_pk_bf16_f32 v10, v16, v17
  v_cvt_pk_bf16_f32 v11, v18, v19
  s_nop 1
  v_permlane32_swap_b32 v8, v10
  v_permlane32_swap_b32 v9, v11
  buffer_store_dwordx4 v[8:11], v3, s[4:7], 0 offen offset:0 sc1
  v_accvgpr_read_b32 v24, a40
  v_accvgpr_read_b32 v25, a41
  v_accvgpr_read_b32 v26, a42
  v_accvgpr_read_b32 v27, a43
  v_accvgpr_read_b32 v28, a44
  v_accvgpr_read_b32 v29, a45
  v_accvgpr_read_b32 v30, a46
  v_accvgpr_read_b32 v31, a47
  v_cvt_pk_bf16_f32 v20, v24, v25
  v_cvt_pk_bf16_f32 v21, v26, v27
  v_cvt_pk_bf16_f32 v22, v28, v29
  v_cvt_pk_bf16_f32 v23, v30, v31
  s_nop 1
  v_permlane32_swap_b32 v20, v22
  v_permlane32_swap_b32 v21, v23
  buffer_store_dwordx4 v[20:23], v3, s[4:7], 0 offen offset:32 sc1
  v_accvgpr_read_b32 v36, a48
  v_accvgpr_read_b32 v37, a49
  v_accvgpr_read_b32 v38, a50
  v_accvgpr_read_b32 v39, a51
  v_accvgpr_read_b32 v40, a52
  v_accvgpr_read_b32 v41, a53
  v_accvgpr_read_b32 v42, a54
  v_accvgpr_read_b32 v43, a55
  v_cvt_pk_bf16_f32 v32, v36, v37
  v_cvt_pk_bf16_f32 v33, v38, v39
  v_cvt_pk_bf16_f32 v34, v40, v41
  v_cvt_pk_bf16_f32 v35, v42, v43
  s_nop 1
  v_permlane32_swap_b32 v32, v34
  v_permlane32_swap_b32 v33, v35
  buffer_store_dwordx4 v[32:35], v3, s[4:7], 0 offen offset:64 sc1
  v_accvgpr_read_b32 v48, a56
  v_accvgpr_read_b32 v49, a57
  v_accvgpr_read_b32 v50, a58
  v_accvgpr_read_b32 v51, a59
  v_accvgpr_read_b32 v52, a60
  v_accvgpr_read_b32 v53, a61
  v_accvgpr_read_b32 v54, a62
  v_accvgpr_read_b32 v55, a63
  v_cvt_pk_bf16_f32 v44, v48, v49
  v_cvt_pk_bf16_f32 v45, v50, v51
  v_cvt_pk_bf16_f32 v46, v52, v53
  v_cvt_pk_bf16_f32 v47, v54, v55
  s_nop 1
  v_permlane32_swap_b32 v44, v46
  v_permlane32_swap_b32 v45, v47
  buffer_store_dwordx4 v[44:47], v3, s[4:7], 0 offen offset:96 sc1
  s_branch L_tq_done
L_tq_v:
  s_lshr_b32 s36, s18, 1
  s_and_b32 s37, s18, 1
  v_lshrrev_b32 v17, 3, v1
  v_mul_lo_u32 v2, v17, s38
  v_and_b32 v18, 7, v1
  v_lshrrev_b32 v19, 4, v1
  v_xor_b32 v18, v18, v19
  v_lshl_add_u32 v2, v18, 4, v2
  v_xor_b32 v3, 64, v2

  v_lshrrev_b32 v17, 3, v1
  v_mul_lo_u32 v4, v17, s39
  v_lshrrev_b32 v18, 4, v1
  v_and_b32 v18, 1, v18
  v_lshlrev_b32 v18, 2, v18
  v_and_b32 v19, 7, v1
  v_xor_b32 v19, v19, v18
  v_lshl_add_u32 v4, v19, 4, v4
  v_and_b32 v17, 31, v1
  v_lshrrev_b32 v18, 1, v17
  v_and_b32 v18, 7, v18
  v_lshrrev_b32 v19, 5, v1
  v_xor_b32 v18, v18, v19
  s_mul_i32 s34, s36, 8192
  v_lshlrev_b32 v17, 7, v17
  v_add_u32 v17, s34, v17

  v_xor_b32 v19, 0, v18
  v_lshl_add_u32 v5, v19, 4, v17
  v_add_u32 v9, 65536, v5
  v_xor_b32 v19, 2, v18
  v_lshl_add_u32 v6, v19, 4, v17
  v_add_u32 v10, 65536, v6
  v_xor_b32 v19, 4, v18
  v_lshl_add_u32 v7, v19, 4, v17
  v_add_u32 v11, 65536, v7
  v_xor_b32 v19, 6, v18
  v_lshl_add_u32 v8, v19, 4, v17
  v_add_u32 v12, 65536, v8
  v_lshrrev_b32 v17, 5, v1
  v_lshlrev_b32 v17, 3, v17
  v_lshrrev_b32 v18, 2, v1
  v_and_b32 v18, 3, v18
  v_add_u32 v17, v17, v18
  v_lshlrev_b32 v17, 7, v17
  v_lshrrev_b32 v18, 1, v18
  v_lshl_add_u32 v17, v18, 6, v17
  v_lshrrev_b32 v18, 4, v1
  v_and_b32 v18, 1, v18
  v_lshl_add_u32 v17, v18, 5, v17
  v_and_b32 v18, 3, v1
  v_lshl_add_u32 v17, v18, 3, v17
  s_mul_i32 s34, s37, 8192
  s_add_u32 s34, s34, 16384
  v_add_u32 v13, s34, v17
  v_xor_b32 v14, 64, v13
  v_add_u32 v15, 65536, v13
  v_add_u32 v16, 65536, v14

  s_mov_b32 s40, s30
  s_mul_i32 s34, s18, s38
  s_mul_i32 s34, s34, 32
  s_add_u32 s40, s40, s34
  s_mov_b32 s41, s31
  s_mov_b32 s42, s59
  s_mul_i32 s34, s18, s39
  s_lshl_b32 s34, s34, 4
  s_add_u32 s41, s41, s34
  s_add_u32 s42, s42, s34
  s_lshl_b32 s35, s18, 10
  s_mul_i32 s48, s38, 0
  s_mul_i32 s49, s38, 8
  s_mul_i32 s50, s38, 16
  s_mul_i32 s51, s38, 24
  s_lshl_b32 s56, s39, 3
  s_lshl_b32 s57, s39, 6
  s_mul_i32 s34, s18, 4096
  s_add_u32 s34, s34, 0
  s_add_u32 m0, s34, 0
  s_add_u32 s35, s40, s48
  buffer_load_dwordx4 v2, s[4:7], s35 offen sc1 lds
  s_add_u32 m0, s34, 1024
  s_add_u32 s35, s40, s49
  buffer_load_dwordx4 v3, s[4:7], s35 offen sc1 lds
  s_add_u32 m0, s34, 2048
  s_add_u32 s35, s40, s50
  buffer_load_dwordx4 v2, s[4:7], s35 offen sc1 lds
  s_add_u32 m0, s34, 3072
  s_add_u32 s35, s40, s51
  buffer_load_dwordx4 v3, s[4:7], s35 offen sc1 lds
  s_add_u32 s40, s40, 128
  s_lshl_b32 s34, s18, 11
  s_add_u32 s34, s34, 16384
  s_add_u32 m0, s34, 0
  s_nop 0
  buffer_load_dwordx4 v4, s[12:15], s41 offen lds
  s_add_u32 m0, s34, 1024
  s_add_u32 s35, s41, s56
  buffer_load_dwordx4 v4, s[12:15], s35 offen lds
  s_add_u32 s41, s41, s57
  s_add_u32 m0, s34, 8192
  s_nop 0
  buffer_load_dwordx4 v4, s[12:15], s42 offen lds
  s_add_u32 m0, s34, 9216
  s_add_u32 s35, s42, s56
  buffer_load_dwordx4 v4, s[12:15], s35 offen lds
  s_add_u32 s42, s42, s57
  s_mul_i32 s34, s18, 4096
  s_add_u32 s34, s34, 32768
  s_add_u32 m0, s34, 0
  s_add_u32 s35, s40, s48
  buffer_load_dwordx4 v2, s[4:7], s35 offen sc1 lds
  s_add_u32 m0, s34, 1024
  s_add_u32 s35, s40, s49
  buffer_load_dwordx4 v3, s[4:7], s35 offen sc1 lds
  s_add_u32 m0, s34, 2048
  s_add_u32 s35, s40, s50
  buffer_load_dwordx4 v2, s[4:7], s35 offen sc1 lds
  s_add_u32 m0, s34, 3072
  s_add_u32 s35, s40, s51
  buffer_load_dwordx4 v3, s[4:7], s35 offen sc1 lds
  s_add_u32 s40, s40, 128
  s_lshl_b32 s34, s18, 11
  s_add_u32 s34, s34, 49152
  s_add_u32 m0, s34, 0
  s_nop 0
  buffer_load_dwordx4 v4, s[12:15], s41 offen lds
  s_add_u32 m0, s34, 1024
  s_add_u32 s35, s41, s56
  buffer_load_dwordx4 v4, s[12:15], s35 offen lds
  s_add_u32 s41, s41, s57
  s_add_u32 m0, s34, 8192
  s_nop 0
  buffer_load_dwordx4 v4, s[12:15], s42 offen lds
  s_add_u32 m0, s34, 9216
  s_add_u32 s35, s42, s56
  buffer_load_dwordx4 v4, s[12:15], s35 offen lds
  s_add_u32 s42, s42, s57
  s_mul_i32 s34, s18, 4096
  s_add_u32 s34, s34, 65536
  s_add_u32 m0, s34, 0
  s_add_u32 s35, s40, s48
  buffer_load_dwordx4 v2, s[4:7], s35 offen sc1 lds
  s_add_u32 m0, s34, 1024
  s_add_u32 s35, s40, s49
  buffer_load_dwordx4 v3, s[4:7], s35 offen sc1 lds
  s_add_u32 m0, s34, 2048
  s_add_u32 s35, s40, s50
  buffer_load_dwordx4 v2, s[4:7], s35 offen sc1 lds
  s_add_u32 m0, s34, 3072
  s_add_u32 s35, s40, s51
  buffer_load_dwordx4 v3, s[4:7], s35 offen sc1 lds
  s_add_u32 s40, s40, 128
  s_lshl_b32 s34, s18, 11
  s_add_u32 s34, s34, 81920
  s_add_u32 m0, s34, 0
  s_nop 0
  buffer_load_dwordx4 v4, s[12:15], s41 offen lds
  s_add_u32 m0, s34, 1024
  s_add_u32 s35, s41, s56
  buffer_load_dwordx4 v4, s[12:15], s35 offen lds
  s_add_u32 s41, s41, s57
  s_add_u32 m0, s34, 8192
  s_nop 0
  buffer_load_dwordx4 v4, s[12:15], s42 offen lds
  s_add_u32 m0, s34, 9216
  s_add_u32 s35, s42, s56
  buffer_load_dwordx4 v4, s[12:15], s35 offen lds
  s_add_u32 s42, s42, s57
  s_waitcnt vmcnt(16)
  s_barrier
  s_mul_i32 s34, s18, 4096
  s_add_u32 s34, s34, 98304
  s_add_u32 m0, s34, 0
  s_add_u32 s35, s40, s48
  buffer_load_dwordx4 v2, s[4:7], s35 offen sc1 lds
  s_add_u32 m0, s34, 1024
  s_add_u32 s35, s40, s49
  buffer_load_dwordx4 v3, s[4:7], s35 offen sc1 lds
  s_add_u32 m0, s34, 2048
  s_add_u32 s35, s40, s50
  buffer_load_dwordx4 v2, s[4:7], s35 offen sc1 lds
  s_add_u32 m0, s34, 3072
  s_add_u32 s35, s40, s51
  buffer_load_dwordx4 v3, s[4:7], s35 offen sc1 lds
  s_add_u32 s40, s40, 128
  s_lshl_b32 s34, s18, 11
  s_add_u32 s34, s34, 114688
  s_add_u32 m0, s34, 0
  s_nop 0
  buffer_load_dwordx4 v4, s[12:15], s41 offen lds
  s_add_u32 m0, s34, 1024
  s_add_u32 s35, s41, s56
  buffer_load_dwordx4 v4, s[12:15], s35 offen lds
  s_add_u32 s41, s41, s57
  s_add_u32 m0, s34, 8192
  s_nop 0
  buffer_load_dwordx4 v4, s[12:15], s42 offen lds
  s_add_u32 m0, s34, 9216
  s_add_u32 s35, s42, s56
  buffer_load_dwordx4 v4, s[12:15], s35 offen lds
  s_add_u32 s42, s42, s57
  ds_read_b128 v[24:27], v5 offset:0
  ds_read_b128 v[28:31], v5 offset:4096
  ds_read_b64_tr_b16 v[40:41], v13 offset:0
  ds_read_b64_tr_b16 v[42:43], v13 offset:512
  ds_read_b64_tr_b16 v[44:45], v14 offset:0
  ds_read_b64_tr_b16 v[46:47], v14 offset:512
  ds_read_b128 v[32:35], v6 offset:0
  ds_read_b128 v[36:39], v6 offset:4096
  ds_read_b64_tr_b16 v[48:49], v13 offset:2048
  ds_read_b64_tr_b16 v[50:51], v13 offset:2560
  ds_read_b64_tr_b16 v[52:53], v14 offset:2048
  ds_read_b64_tr_b16 v[54:55], v14 offset:2560
  s_waitcnt lgkmcnt(6)
  v_mfma_f32_32x32x16_bf16 a[0:15], v[24:27], v[40:43], 0
  v_mfma_f32_32x32x16_bf16 a[16:31], v[24:27], v[44:47], 0
  v_mfma_f32_32x32x16_bf16 a[32:47], v[28:31], v[40:43], 0
  v_mfma_f32_32x32x16_bf16 a[48:63], v[28:31], v[44:47], 0
  ds_read_b128 v[24:27], v7 offset:0
  ds_read_b128 v[28:31], v7 offset:4096
  ds_read_b64_tr_b16 v[40:41], v13 offset:4096
  ds_read_b64_tr_b16 v[42:43], v13 offset:4608
  ds_read_b64_tr_b16 v[44:45], v14 offset:4096
  ds_read_b64_tr_b16 v[46:47], v14 offset:4608
  s_waitcnt lgkmcnt(6)
  v_mfma_f32_32x32x16_bf16 a[0:15], v[32:35], v[48:51], a[0:15]
  v_mfma_f32_32x32x16_bf16 a[16:31], v[32:35], v[52:55], a[16:31]
  v_mfma_f32_32x32x16_bf16 a[32:47], v[36:39], v[48:51], a[32:47]
  v_mfma_f32_32x32x16_bf16 a[48:63], v[36:39], v[52:55], a[48:63]
  ds_read_b128 v[32:35], v8 offset:0
  ds_read_b128 v[36:39], v8 offset:4096
  ds_read_b64_tr_b16 v[48:49], v13 offset:6144
  ds_read_b64_tr_b16 v[50:51], v13 offset:6656
  ds_read_b64_tr_b16 v[52:53], v14 offset:6144
  ds_read_b64_tr_b16 v[54:55], v14 offset:6656
  s_waitcnt lgkmcnt(6)
  v_mfma_f32_32x32x16_bf16 a[0:15], v[24:27], v[40:43], a[0:15]
  v_mfma_f32_32x32x16_bf16 a[16:31], v[24:27], v[44:47], a[16:31]
  v_mfma_f32_32x32x16_bf16 a[32:47], v[28:31], v[40:43], a[32:47]
  v_mfma_f32_32x32x16_bf16 a[48:63], v[28:31], v[44:47], a[48:63]
  s_waitcnt lgkmcnt(0)
  v_mfma_f32_32x32x16_bf16 a[0:15], v[32:35], v[48:51], a[0:15]
  v_mfma_f32_32x32x16_bf16 a[16:31], v[32:35], v[52:55], a[16:31]
  v_mfma_f32_32x32x16_bf16 a[32:47], v[36:39], v[48:51], a[32:47]
  v_mfma_f32_32x32x16_bf16 a[48:63], v[36:39], v[52:55], a[48:63]
  s_waitcnt vmcnt(16)
  s_barrier
  s_mul_i32 s34, s18, 4096
  s_add_u32 s34, s34, 0
  s_add_u32 m0, s34, 0
  s_add_u32 s35, s40, s48
  buffer_load_dwordx4 v2, s[4:7], s35 offen sc1 lds
  s_add_u32 m0, s34, 1024
  s_add_u32 s35, s40, s49
  buffer_load_dwordx4 v3, s[4:7], s35 offen sc1 lds
  s_add_u32 m0, s34, 2048
  s_add_u32 s35, s40, s50
  buffer_load_dwordx4 v2, s[4:7], s35 offen sc1 lds
  s_add_u32 m0, s34, 3072
  s_add_u32 s35, s40, s51
  buffer_load_dwordx4 v3, s[4:7], s35 offen sc1 lds
  s_add_u32 s40, s40, 128
  s_lshl_b32 s34, s18, 11
  s_add_u32 s34, s34, 16384
  s_add_u32 m0, s34, 0
  s_nop 0
  buffer_load_dwordx4 v4, s[12:15], s41 offen lds
  s_add_u32 m0, s34, 1024
  s_add_u32 s35, s41, s56
  buffer_load_dwordx4 v4, s[12:15], s35 offen lds
  s_add_u32 s41, s41, s57
  s_add_u32 m0, s34, 8192
  s_nop 0
  buffer_load_dwordx4 v4, s[12:15], s42 offen lds
  s_add_u32 m0, s34, 9216
  s_add_u32 s35, s42, s56
  buffer_load_dwordx4 v4, s[12:15], s35 offen lds
  s_add_u32 s42, s42, s57
  ds_read_b128 v[24:27], v5 offset:32768
  ds_read_b128 v[28:31], v5 offset:36864
  ds_read_b64_tr_b16 v[40:41], v13 offset:32768
  ds_read_b64_tr_b16 v[42:43], v13 offset:33280
  ds_read_b64_tr_b16 v[44:45], v14 offset:32768
  ds_read_b64_tr_b16 v[46:47], v14 offset:33280
  ds_read_b128 v[32:35], v6 offset:32768
  ds_read_b128 v[36:39], v6 offset:36864
  ds_read_b64_tr_b16 v[48:49], v13 offset:34816
  ds_read_b64_tr_b16 v[50:51], v13 offset:35328
  ds_read_b64_tr_b16 v[52:53], v14 offset:34816
  ds_read_b64_tr_b16 v[54:55], v14 offset:35328
  s_waitcnt lgkmcnt(6)
  v_mfma_f32_32x32x16_bf16 a[0:15], v[24:27], v[40:43], a[0:15]
  v_mfma_f32_32x32x16_bf16 a[16:31], v[24:27], v[44:47], a[16:31]
  v_mfma_f32_32x32x16_bf16 a[32:47], v[28:31], v[40:43], a[32:47]
  v_mfma_f32_32x32x16_bf16 a[48:63], v[28:31], v[44:47], a[48:63]
  ds_read_b128 v[24:27], v7 offset:32768
  ds_read_b128 v[28:31], v7 offset:36864
  ds_read_b64_tr_b16 v[40:41], v13 offset:36864
  ds_read_b64_tr_b16 v[42:43], v13 offset:37376
  ds_read_b64_tr_b16 v[44:45], v14 offset:36864
  ds_read_b64_tr_b16 v[46:47], v14 offset:37376
  s_waitcnt lgkmcnt(6)
  v_mfma_f32_32x32x16_bf16 a[0:15], v[32:35], v[48:51], a[0:15]
  v_mfma_f32_32x32x16_bf16 a[16:31], v[32:35], v[52:55], a[16:31]
  v_mfma_f32_32x32x16_bf16 a[32:47], v[36:39], v[48:51], a[32:47]
  v_mfma_f32_32x32x16_bf16 a[48:63], v[36:39], v[52:55], a[48:63]
  ds_read_b128 v[32:35], v8 offset:32768
  ds_read_b128 v[36:39], v8 offset:36864
  ds_read_b64_tr_b16 v[48:49], v13 offset:38912
  ds_read_b64_tr_b16 v[50:51], v13 offset:39424
  ds_read_b64_tr_b16 v[52:53], v14 offset:38912
  ds_read_b64_tr_b16 v[54:55], v14 offset:39424
  s_waitcnt lgkmcnt(6)
  v_mfma_f32_32x32x16_bf16 a[0:15], v[24:27], v[40:43], a[0:15]
  v_mfma_f32_32x32x16_bf16 a[16:31], v[24:27], v[44:47], a[16:31]
  v_mfma_f32_32x32x16_bf16 a[32:47], v[28:31], v[40:43], a[32:47]
  v_mfma_f32_32x32x16_bf16 a[48:63], v[28:31], v[44:47], a[48:63]
  s_waitcnt lgkmcnt(0)
  v_mfma_f32_32x32x16_bf16 a[0:15], v[32:35], v[48:51], a[0:15]
  v_mfma_f32_32x32x16_bf16 a[16:31], v[32:35], v[52:55], a[16:31]
  v_mfma_f32_32x32x16_bf16 a[32:47], v[36:39], v[48:51], a[32:47]
  v_mfma_f32_32x32x16_bf16 a[48:63], v[36:39], v[52:55], a[48:63]
  s_waitcnt vmcnt(16)
  s_barrier
  s_mul_i32 s34, s18, 4096
  s_add_u32 s34, s34, 32768
  s_add_u32 m0, s34, 0
  s_add_u32 s35, s40, s48
  buffer_load_dwordx4 v2, s[4:7], s35 offen sc1 lds
  s_add_u32 m0, s34, 1024
  s_add_u32 s35, s40, s49
  buffer_load_dwordx4 v3, s[4:7], s35 offen sc1 lds
  s_add_u32 m0, s34, 2048
  s_add_u32 s35, s40, s50
  buffer_load_dwordx4 v2, s[4:7], s35 offen sc1 lds
  s_add_u32 m0, s34, 3072
  s_add_u32 s35, s40, s51
  buffer_load_dwordx4 v3, s[4:7], s35 offen sc1 lds
  s_add_u32 s40, s40, 128
  s_lshl_b32 s34, s18, 11
  s_add_u32 s34, s34, 49152
  s_add_u32 m0, s34, 0
  s_nop 0
  buffer_load_dwordx4 v4, s[12:15], s41 offen lds
  s_add_u32 m0, s34, 1024
  s_add_u32 s35, s41, s56
  buffer_load_dwordx4 v4, s[12:15], s35 offen lds
  s_add_u32 s41, s41, s57
  s_add_u32 m0, s34, 8192
  s_nop 0
  buffer_load_dwordx4 v4, s[12:15], s42 offen lds
  s_add_u32 m0, s34, 9216
  s_add_u32 s35, s42, s56
  buffer_load_dwordx4 v4, s[12:15], s35 offen lds
  s_add_u32 s42, s42, s57
  ds_read_b128 v[24:27], v9 offset:0
  ds_read_b128 v[28:31], v9 offset:4096
  ds_read_b64_tr_b16 v[40:41], v15 offset:0
  ds_read_b64_tr_b16 v[42:43], v15 offset:512
  ds_read_b64_tr_b16 v[44:45], v16 offset:0
  ds_read_b64_tr_b16 v[46:47], v16 offset:512
  ds_read_b128 v[32:35], v10 offset:0
  ds_read_b128 v[36:39], v10 offset:4096
  ds_read_b64_tr_b16 v[48:49], v15 offset:2048
  ds_read_b64_tr_b16 v[50:51], v15 offset:2560
  ds_read_b64_tr_b16 v[52:53], v16 offset:2048
  ds_read_b64_tr_b16 v[54:55], v16 offset:2560
  s_waitcnt lgkmcnt(6)
  v_mfma_f32_32x32x16_bf16 a[0:15], v[24:27], v[40:43], a[0:15]
  v_mfma_f32_32x32x16_bf16 a[16:31], v[24:27], v[44:47], a[16:31]
  v_mfma_f32_32x32x16_bf16 a[32:47], v[28:31], v[40:43], a[32:47]
  v_mfma_f32_32x32x16_bf16 a[48:63], v[28:31], v[44:47], a[48:63]
  ds_read_b128 v[24:27], v11 offset:0
  ds_read_b128 v[28:31], v11 offset:4096
  ds_read_b64_tr_b16 v[40:41], v15 offset:4096
  ds_read_b64_tr_b16 v[42:43], v15 offset:4608
  ds_read_b64_tr_b16 v[44:45], v16 offset:4096
  ds_read_b64_tr_b16 v[46:47], v16 offset:4608
  s_waitcnt lgkmcnt(6)
  v_mfma_f32_32x32x16_bf16 a[0:15], v[32:35], v[48:51], a[0:15]
  v_mfma_f32_32x32x16_bf16 a[16:31], v[32:35], v[52:55], a[16:31]
  v_mfma_f32_32x32x16_bf16 a[32:47], v[36:39], v[48:51], a[32:47]
  v_mfma_f32_32x32x16_bf16 a[48:63], v[36:39], v[52:55], a[48:63]
  ds_read_b128 v[32:35], v12 offset:0
  ds_read_b128 v[36:39], v12 offset:4096
  ds_read_b64_tr_b16 v[48:49], v15 offset:6144
  ds_read_b64_tr_b16 v[50:51], v15 offset:6656
  ds_read_b64_tr_b16 v[52:53], v16 offset:6144
  ds_read_b64_tr_b16 v[54:55], v16 offset:6656
  s_waitcnt lgkmcnt(6)
  v_mfma_f32_32x32x16_bf16 a[0:15], v[24:27], v[40:43], a[0:15]
  v_mfma_f32_32x32x16_bf16 a[16:31], v[24:27], v[44:47], a[16:31]
  v_mfma_f32_32x32x16_bf16 a[32:47], v[28:31], v[40:43], a[32:47]
  v_mfma_f32_32x32x16_bf16 a[48:63], v[28:31], v[44:47], a[48:63]
  s_waitcnt lgkmcnt(0)
  v_mfma_f32_32x32x16_bf16 a[0:15], v[32:35], v[48:51], a[0:15]
  v_mfma_f32_32x32x16_bf16 a[16:31], v[32:35], v[52:55], a[16:31]
  v_mfma_f32_32x32x16_bf16 a[32:47], v[36:39], v[48:51], a[32:47]
  v_mfma_f32_32x32x16_bf16 a[48:63], v[36:39], v[52:55], a[48:63]
  s_waitcnt vmcnt(16)
  s_barrier
  s_mul_i32 s34, s18, 4096
  s_add_u32 s34, s34, 65536
  s_add_u32 m0, s34, 0
  s_add_u32 s35, s40, s48
  buffer_load_dwordx4 v2, s[4:7], s35 offen sc1 lds
  s_add_u32 m0, s34, 1024
  s_add_u32 s35, s40, s49
  buffer_load_dwordx4 v3, s[4:7], s35 offen sc1 lds
  s_add_u32 m0, s34, 2048
  s_add_u32 s35, s40, s50
  buffer_load_dwordx4 v2, s[4:7], s35 offen sc1 lds
  s_add_u32 m0, s34, 3072
  s_add_u32 s35, s40, s51
  buffer_load_dwordx4 v3, s[4:7], s35 offen sc1 lds
  s_add_u32 s40, s40, 128
  s_lshl_b32 s34, s18, 11
  s_add_u32 s34, s34, 81920
  s_add_u32 m0, s34, 0
  s_nop 0
  buffer_load_dwordx4 v4, s[12:15], s41 offen lds
  s_add_u32 m0, s34, 1024
  s_add_u32 s35, s41, s56
  buffer_load_dwordx4 v4, s[12:15], s35 offen lds
  s_add_u32 s41, s41, s57
  s_add_u32 m0, s34, 8192
  s_nop 0
  buffer_load_dwordx4 v4, s[12:15], s42 offen lds
  s_add_u32 m0, s34, 9216
  s_add_u32 s35, s42, s56
  buffer_load_dwordx4 v4, s[12:15], s35 offen lds
  s_add_u32 s42, s42, s57
  ds_read_b128 v[24:27], v9 offset:32768
  ds_read_b128 v[28:31], v9 offset:36864
  ds_read_b64_tr_b16 v[40:41], v15 offset:32768
  ds_read_b64_tr_b16 v[42:43], v15 offset:33280
  ds_read_b64_tr_b16 v[44:45], v16 offset:32768
  ds_read_b64_tr_b16 v[46:47], v16 offset:33280
  ds_read_b128 v[32:35], v10 offset:32768
  ds_read_b128 v[36:39], v10 offset:36864
  ds_read_b64_tr_b16 v[48:49], v15 offset:34816
  ds_read_b64_tr_b16 v[50:51], v15 offset:35328
  ds_read_b64_tr_b16 v[52:53], v16 offset:34816
  ds_read_b64_tr_b16 v[54:55], v16 offset:35328
  s_waitcnt lgkmcnt(6)
  v_mfma_f32_32x32x16_bf16 a[0:15], v[24:27], v[40:43], a[0:15]
  v_mfma_f32_32x32x16_bf16 a[16:31], v[24:27], v[44:47], a[16:31]
  v_mfma_f32_32x32x16_bf16 a[32:47], v[28:31], v[40:43], a[32:47]
  v_mfma_f32_32x32x16_bf16 a[48:63], v[28:31], v[44:47], a[48:63]
  ds_read_b128 v[24:27], v11 offset:32768
  ds_read_b128 v[28:31], v11 offset:36864
  ds_read_b64_tr_b16 v[40:41], v15 offset:36864
  ds_read_b64_tr_b16 v[42:43], v15 offset:37376
  ds_read_b64_tr_b16 v[44:45], v16 offset:36864
  ds_read_b64_tr_b16 v[46:47], v16 offset:37376
  s_waitcnt lgkmcnt(6)
  v_mfma_f32_32x32x16_bf16 a[0:15], v[32:35], v[48:51], a[0:15]
  v_mfma_f32_32x32x16_bf16 a[16:31], v[32:35], v[52:55], a[16:31]
  v_mfma_f32_32x32x16_bf16 a[32:47], v[36:39], v[48:51], a[32:47]
  v_mfma_f32_32x32x16_bf16 a[48:63], v[36:39], v[52:55], a[48:63]
  ds_read_b128 v[32:35], v12 offset:32768
  ds_read_b128 v[36:39], v12 offset:36864
  ds_read_b64_tr_b16 v[48:49], v15 offset:38912
  ds_read_b64_tr_b16 v[50:51], v15 offset:39424
  ds_read_b64_tr_b16 v[52:53], v16 offset:38912
  ds_read_b64_tr_b16 v[54:55], v16 offset:39424
  s_waitcnt lgkmcnt(6)
  v_mfma_f32_32x32x16_bf16 a[0:15], v[24:27], v[40:43], a[0:15]
  v_mfma_f32_32x32x16_bf16 a[16:31], v[24:27], v[44:47], a[16:31]
  v_mfma_f32_32x32x16_bf16 a[32:47], v[28:31], v[40:43], a[32:47]
  v_mfma_f32_32x32x16_bf16 a[48:63], v[28:31], v[44:47], a[48:63]
  s_waitcnt lgkmcnt(0)
  v_mfma_f32_32x32x16_bf16 a[0:15], v[32:35], v[48:51], a[0:15]
  v_mfma_f32_32x32x16_bf16 a[16:31], v[32:35], v[52:55], a[16:31]
  v_mfma_f32_32x32x16_bf16 a[32:47], v[36:39], v[48:51], a[32:47]
  v_mfma_f32_32x32x16_bf16 a[48:63], v[36:39], v[52:55], a[48:63]
  s_waitcnt vmcnt(16)
  s_barrier
  s_mul_i32 s34, s18, 4096
  s_add_u32 s34, s34, 98304
  s_add_u32 m0, s34, 0
  s_add_u32 s35, s40, s48
  buffer_load_dwordx4 v2, s[4:7], s35 offen sc1 lds
  s_add_u32 m0, s34, 1024
  s_add_u32 s35, s40, s49
  buffer_load_dwordx4 v3, s[4:7], s35 offen sc1 lds
  s_add_u32 m0, s34, 2048
  s_add_u32 s35, s40, s50
  buffer_load_dwordx4 v2, s[4:7], s35 offen sc1 lds
  s_add_u32 m0, s34, 3072
  s_add_u32 s35, s40, s51
  buffer_load_dwordx4 v3, s[4:7], s35 offen sc1 lds
  s_add_u32 s40, s40, 128
  s_lshl_b32 s34, s18, 11
  s_add_u32 s34, s34, 114688
  s_add_u32 m0, s34, 0
  s_nop 0
  buffer_load_dwordx4 v4, s[12:15], s41 offen lds
  s_add_u32 m0, s34, 1024
  s_add_u32 s35, s41, s56
  buffer_load_dwordx4 v4, s[12:15], s35 offen lds
  s_add_u32 s41, s41, s57
  s_add_u32 m0, s34, 8192
  s_nop 0
  buffer_load_dwordx4 v4, s[12:15], s42 offen lds
  s_add_u32 m0, s34, 9216
  s_add_u32 s35, s42, s56
  buffer_load_dwordx4 v4, s[12:15], s35 offen lds
  s_add_u32 s42, s42, s57
  ds_read_b128 v[24:27], v5 offset:0
  ds_read_b128 v[28:31], v5 offset:4096
  ds_read_b64_tr_b16 v[40:41], v13 offset:0
  ds_read_b64_tr_b16 v[42:43], v13 offset:512
  ds_read_b64_tr_b16 v[44:45], v14 offset:0
  ds_read_b64_tr_b16 v[46:47], v14 offset:512
  ds_read_b128 v[32:35], v6 offset:0
  ds_read_b128 v[36:39], v6 offset:4096
  ds_read_b64_tr_b16 v[48:49], v13 offset:2048
  ds_read_b64_tr_b16 v[50:51], v13 offset:2560
  ds_read_b64_tr_b16 v[52:53], v14 offset:2048
  ds_read_b64_tr_b16 v[54:55], v14 offset:2560
  s_waitcnt lgkmcnt(6)
  v_mfma_f32_32x32x16_bf16 a[0:15], v[24:27], v[40:43], a[0:15]
  v_mfma_f32_32x32x16_bf16 a[16:31], v[24:27], v[44:47], a[16:31]
  v_mfma_f32_32x32x16_bf16 a[32:47], v[28:31], v[40:43], a[32:47]
  v_mfma_f32_32x32x16_bf16 a[48:63], v[28:31], v[44:47], a[48:63]
  ds_read_b128 v[24:27], v7 offset:0
  ds_read_b128 v[28:31], v7 offset:4096
  ds_read_b64_tr_b16 v[40:41], v13 offset:4096
  ds_read_b64_tr_b16 v[42:43], v13 offset:4608
  ds_read_b64_tr_b16 v[44:45], v14 offset:4096
  ds_read_b64_tr_b16 v[46:47], v14 offset:4608
  s_waitcnt lgkmcnt(6)
  v_mfma_f32_32x32x16_bf16 a[0:15], v[32:35], v[48:51], a[0:15]
  v_mfma_f32_32x32x16_bf16 a[16:31], v[32:35], v[52:55], a[16:31]
  v_mfma_f32_32x32x16_bf16 a[32:47], v[36:39], v[48:51], a[32:47]
  v_mfma_f32_32x32x16_bf16 a[48:63], v[36:39], v[52:55], a[48:63]
  ds_read_b128 v[32:35], v8 offset:0
  ds_read_b128 v[36:39], v8 offset:4096
  ds_read_b64_tr_b16 v[48:49], v13 offset:6144
  ds_read_b64_tr_b16 v[50:51], v13 offset:6656
  ds_read_b64_tr_b16 v[52:53], v14 offset:6144
  ds_read_b64_tr_b16 v[54:55], v14 offset:6656
  s_waitcnt lgkmcnt(6)
  v_mfma_f32_32x32x16_bf16 a[0:15], v[24:27], v[40:43], a[0:15]
  v_mfma_f32_32x32x16_bf16 a[16:31], v[24:27], v[44:47], a[16:31]
  v_mfma_f32_32x32x16_bf16 a[32:47], v[28:31], v[40:43], a[32:47]
  v_mfma_f32_32x32x16_bf16 a[48:63], v[28:31], v[44:47], a[48:63]
  s_waitcnt lgkmcnt(0)
  v_mfma_f32_32x32x16_bf16 a[0:15], v[32:35], v[48:51], a[0:15]
  v_mfma_f32_32x32x16_bf16 a[16:31], v[32:35], v[52:55], a[16:31]
  v_mfma_f32_32x32x16_bf16 a[32:47], v[36:39], v[48:51], a[32:47]
  v_mfma_f32_32x32x16_bf16 a[48:63], v[36:39], v[52:55], a[48:63]
  s_waitcnt vmcnt(16)
  s_barrier
  ds_read_b128 v[24:27], v5 offset:32768
  ds_read_b128 v[28:31], v5 offset:36864
  ds_read_b64_tr_b16 v[40:41], v13 offset:32768
  ds_read_b64_tr_b16 v[42:43], v13 offset:33280
  ds_read_b64_tr_b16 v[44:45], v14 offset:32768
  ds_read_b64_tr_b16 v[46:47], v14 offset:33280
  ds_read_b128 v[32:35], v6 offset:32768
  ds_read_b128 v[36:39], v6 offset:36864
  ds_read_b64_tr_b16 v[48:49], v13 offset:34816
  ds_read_b64_tr_b16 v[50:51], v13 offset:35328
  ds_read_b64_tr_b16 v[52:53], v14 offset:34816
  ds_read_b64_tr_b16 v[54:55], v14 offset:35328
  s_waitcnt lgkmcnt(6)
  v_mfma_f32_32x32x16_bf16 a[0:15], v[24:27], v[40:43], a[0:15]
  v_mfma_f32_32x32x16_bf16 a[16:31], v[24:27], v[44:47], a[16:31]
  v_mfma_f32_32x32x16_bf16 a[32:47], v[28:31], v[40:43], a[32:47]
  v_mfma_f32_32x32x16_bf16 a[48:63], v[28:31], v[44:47], a[48:63]
  ds_read_b128 v[24:27], v7 offset:32768
  ds_read_b128 v[28:31], v7 offset:36864
  ds_read_b64_tr_b16 v[40:41], v13 offset:36864
  ds_read_b64_tr_b16 v[42:43], v13 offset:37376
  ds_read_b64_tr_b16 v[44:45], v14 offset:36864
  ds_read_b64_tr_b16 v[46:47], v14 offset:37376
  s_waitcnt lgkmcnt(6)
  v_mfma_f32_32x32x16_bf16 a[0:15], v[32:35], v[48:51], a[0:15]
  v_mfma_f32_32x32x16_bf16 a[16:31], v[32:35], v[52:55], a[16:31]
  v_mfma_f32_32x32x16_bf16 a[32:47], v[36:39], v[48:51], a[32:47]
  v_mfma_f32_32x32x16_bf16 a[48:63], v[36:39], v[52:55], a[48:63]
  ds_read_b128 v[32:35], v8 offset:32768
  ds_read_b128 v[36:39], v8 offset:36864
  ds_read_b64_tr_b16 v[48:49], v13 offset:38912
  ds_read_b64_tr_b16 v[50:51], v13 offset:39424
  ds_read_b64_tr_b16 v[52:53], v14 offset:38912
  ds_read_b64_tr_b16 v[54:55], v14 offset:39424
  s_waitcnt lgkmcnt(6)
  v_mfma_f32_32x32x16_bf16 a[0:15], v[24:27], v[40:43], a[0:15]
  v_mfma_f32_32x32x16_bf16 a[16:31], v[24:27], v[44:47], a[16:31]
  v_mfma_f32_32x32x16_bf16 a[32:47], v[28:31], v[40:43], a[32:47]
  v_mfma_f32_32x32x16_bf16 a[48:63], v[28:31], v[44:47], a[48:63]
  s_waitcnt lgkmcnt(0)
  v_mfma_f32_32x32x16_bf16 a[0:15], v[32:35], v[48:51], a[0:15]
  v_mfma_f32_32x32x16_bf16 a[16:31], v[32:35], v[52:55], a[16:31]
  v_mfma_f32_32x32x16_bf16 a[32:47], v[36:39], v[48:51], a[32:47]
  v_mfma_f32_32x32x16_bf16 a[48:63], v[36:39], v[52:55], a[48:63]
  s_waitcnt vmcnt(8)
  s_barrier
  ds_read_b128 v[24:27], v9 offset:0
  ds_read_b128 v[28:31], v9 offset:4096
  ds_read_b64_tr_b16 v[40:41], v15 offset:0
  ds_read_b64_tr_b16 v[42:43], v15 offset:512
  ds_read_b64_tr_b16 v[44:45], v16 offset:0
  ds_read_b64_tr_b16 v[46:47], v16 offset:512
  ds_read_b128 v[32:35], v10 offset:0
  ds_read_b128 v[36:39], v10 offset:4096
  ds_read_b64_tr_b16 v[48:49], v15 offset:2048
  ds_read_b64_tr_b16 v[50:51], v15 offset:2560
  ds_read_b64_tr_b16 v[52:53], v16 offset:2048
  ds_read_b64_tr_b16 v[54:55], v16 offset:2560
  s_waitcnt lgkmcnt(6)
  v_mfma_f32_32x32x16_bf16 a[0:15], v[24:27], v[40:43], a[0:15]
  v_mfma_f32_32x32x16_bf16 a[16:31], v[24:27], v[44:47], a[16:31]
  v_mfma_f32_32x32x16_bf16 a[32:47], v[28:31], v[40:43], a[32:47]
  v_mfma_f32_32x32x16_bf16 a[48:63], v[28:31], v[44:47], a[48:63]
  ds_read_b128 v[24:27], v11 offset:0
  ds_read_b128 v[28:31], v11 offset:4096
  ds_read_b64_tr_b16 v[40:41], v15 offset:4096
  ds_read_b64_tr_b16 v[42:43], v15 offset:4608
  ds_read_b64_tr_b16 v[44:45], v16 offset:4096
  ds_read_b64_tr_b16 v[46:47], v16 offset:4608
  s_waitcnt lgkmcnt(6)
  v_mfma_f32_32x32x16_bf16 a[0:15], v[32:35], v[48:51], a[0:15]
  v_mfma_f32_32x32x16_bf16 a[16:31], v[32:35], v[52:55], a[16:31]
  v_mfma_f32_32x32x16_bf16 a[32:47], v[36:39], v[48:51], a[32:47]
  v_mfma_f32_32x32x16_bf16 a[48:63], v[36:39], v[52:55], a[48:63]
  ds_read_b128 v[32:35], v12 offset:0
  ds_read_b128 v[36:39], v12 offset:4096
  ds_read_b64_tr_b16 v[48:49], v15 offset:6144
  ds_read_b64_tr_b16 v[50:51], v15 offset:6656
  ds_read_b64_tr_b16 v[52:53], v16 offset:6144
  ds_read_b64_tr_b16 v[54:55], v16 offset:6656
  s_waitcnt lgkmcnt(6)
  v_mfma_f32_32x32x16_bf16 a[0:15], v[24:27], v[40:43], a[0:15]
  v_mfma_f32_32x32x16_bf16 a[16:31], v[24:27], v[44:47], a[16:31]
  v_mfma_f32_32x32x16_bf16 a[32:47], v[28:31], v[40:43], a[32:47]
  v_mfma_f32_32x32x16_bf16 a[48:63], v[28:31], v[44:47], a[48:63]
  s_waitcnt lgkmcnt(0)
  v_mfma_f32_32x32x16_bf16 a[0:15], v[32:35], v[48:51], a[0:15]
  v_mfma_f32_32x32x16_bf16 a[16:31], v[32:35], v[52:55], a[16:31]
  v_mfma_f32_32x32x16_bf16 a[32:47], v[36:39], v[48:51], a[32:47]
  v_mfma_f32_32x32x16_bf16 a[48:63], v[36:39], v[52:55], a[48:63]
  s_waitcnt vmcnt(0)
  s_barrier
  ds_read_b128 v[24:27], v9 offset:32768
  ds_read_b128 v[28:31], v9 offset:36864
  ds_read_b64_tr_b16 v[40:41], v15 offset:32768
  ds_read_b64_tr_b16 v[42:43], v15 offset:33280
  ds_read_b64_tr_b16 v[44:45], v16 offset:32768
  ds_read_b64_tr_b16 v[46:47], v16 offset:33280
  ds_read_b128 v[32:35], v10 offset:32768
  ds_read_b128 v[36:39], v10 offset:36864
  ds_read_b64_tr_b16 v[48:49], v15 offset:34816
  ds_read_b64_tr_b16 v[50:51], v15 offset:35328
  ds_read_b64_tr_b16 v[52:53], v16 offset:34816
  ds_read_b64_tr_b16 v[54:55], v16 offset:35328
  s_waitcnt lgkmcnt(6)
  v_mfma_f32_32x32x16_bf16 a[0:15], v[24:27], v[40:43], a[0:15]
  v_mfma_f32_32x32x16_bf16 a[16:31], v[24:27], v[44:47], a[16:31]
  v_mfma_f32_32x32x16_bf16 a[32:47], v[28:31], v[40:43], a[32:47]
  v_mfma_f32_32x32x16_bf16 a[48:63], v[28:31], v[44:47], a[48:63]
  ds_read_b128 v[24:27], v11 offset:32768
  ds_read_b128 v[28:31], v11 offset:36864
  ds_read_b64_tr_b16 v[40:41], v15 offset:36864
  ds_read_b64_tr_b16 v[42:43], v15 offset:37376
  ds_read_b64_tr_b16 v[44:45], v16 offset:36864
  ds_read_b64_tr_b16 v[46:47], v16 offset:37376
  s_waitcnt lgkmcnt(6)
  v_mfma_f32_32x32x16_bf16 a[0:15], v[32:35], v[48:51], a[0:15]
  v_mfma_f32_32x32x16_bf16 a[16:31], v[32:35], v[52:55], a[16:31]
  v_mfma_f32_32x32x16_bf16 a[32:47], v[36:39], v[48:51], a[32:47]
  v_mfma_f32_32x32x16_bf16 a[48:63], v[36:39], v[52:55], a[48:63]
  ds_read_b128 v[32:35], v12 offset:32768
  ds_read_b128 v[36:39], v12 offset:36864
  ds_read_b64_tr_b16 v[48:49], v15 offset:38912
  ds_read_b64_tr_b16 v[50:51], v15 offset:39424
  ds_read_b64_tr_b16 v[52:53], v16 offset:38912
  ds_read_b64_tr_b16 v[54:55], v16 offset:39424
  s_waitcnt lgkmcnt(6)
  v_mfma_f32_32x32x16_bf16 a[0:15], v[24:27], v[40:43], a[0:15]
  v_mfma_f32_32x32x16_bf16 a[16:31], v[24:27], v[44:47], a[16:31]
  v_mfma_f32_32x32x16_bf16 a[32:47], v[28:31], v[40:43], a[32:47]
  v_mfma_f32_32x32x16_bf16 a[48:63], v[28:31], v[44:47], a[48:63]
  s_waitcnt lgkmcnt(0)
  v_mfma_f32_32x32x16_bf16 a[0:15], v[32:35], v[48:51], a[0:15]
  v_mfma_f32_32x32x16_bf16 a[16:31], v[32:35], v[52:55], a[16:31]
  v_mfma_f32_32x32x16_bf16 a[32:47], v[36:39], v[48:51], a[32:47]
  v_mfma_f32_32x32x16_bf16 a[48:63], v[36:39], v[52:55], a[48:63]
  s_nop 15
  s_lshl_b32 s34, s26, 2
  s_lshl_b32 s35, s36, 1
  s_add_u32 s34, s34, s35
  s_lshl_b32 s34, s34, 18
  s_lshl_b32 s35, s29, 13
  s_add_u32 s34, s34, s35
  s_lshl_b32 s35, s37, 12
  s_add_u32 s34, s34, s35
  s_add_u32 s34, s34, 37748736
  v_and_b32 v2, 31, v1
  v_lshlrev_b32 v2, 6, v2
  v_lshrrev_b32 v3, 5, v1
  v_lshl_add_u32 v2, v3, 4, v2
  v_add_u32 v2, s34, v2
  v_add_u32 v3, 262144, v2

  v_accvgpr_read_b32 v12, a0
  v_accvgpr_read_b32 v13, a1
  v_accvgpr_read_b32 v14, a2
  v_accvgpr_read_b32 v15, a3
  v_accvgpr_read_b32 v16, a4
  v_accvgpr_read_b32 v17, a5
  v_accvgpr_read_b32 v18, a6
  v_accvgpr_read_b32 v19, a7
  v_cvt_pk_bf16_f32 v8, v12, v13
  v_cvt_pk_bf16_f32 v9, v14, v15
  v_cvt_pk_bf16_f32 v10, v16, v17
  v_cvt_pk_bf16_f32 v11, v18, v19
  s_nop 1
  v_permlane32_swap_b32 v8, v10
  v_permlane32_swap_b32 v9, v11
  buffer_store_dwordx4 v[8:11], v2, s[4:7], 0 offen offset:0 sc1
  v_accvgpr_read_b32 v24, a8
  v_accvgpr_read_b32 v25, a9
  v_accvgpr_read_b32 v26, a10
  v_accvgpr_read_b32 v27, a11
  v_accvgpr_read_b32 v28, a12
  v_accvgpr_read_b32 v29, a13
  v_accvgpr_read_b32 v30, a14
  v_accvgpr_read_b32 v31, a15
  v_cvt_pk_bf16_f32 v20, v24, v25
  v_cvt_pk_bf16_f32 v21, v26, v27
  v_cvt_pk_bf16_f32 v22, v28, v29
  v_cvt_pk_bf16_f32 v23, v30, v31
  s_nop 1
  v_permlane32_swap_b32 v20, v22
  v_permlane32_swap_b32 v21, v23
  buffer_store_dwordx4 v[20:23], v2, s[4:7], 0 offen offset:32 sc1
  v_accvgpr_read_b32 v36, a16
  v_accvgpr_read_b32 v37, a17
  v_accvgpr_read_b32 v38, a18
  v_accvgpr_read_b32 v39, a19
  v_accvgpr_read_b32 v40, a20
  v_accvgpr_read_b32 v41, a21
  v_accvgpr_read_b32 v42, a22
  v_accvgpr_read_b32 v43, a23
  v_cvt_pk_bf16_f32 v32, v36, v37
  v_cvt_pk_bf16_f32 v33, v38, v39
  v_cvt_pk_bf16_f32 v34, v40, v41
  v_cvt_pk_bf16_f32 v35, v42, v43
  s_nop 1
  v_permlane32_swap_b32 v32, v34
  v_permlane32_swap_b32 v33, v35
  buffer_store_dwordx4 v[32:35], v2, s[4:7], 0 offen offset:2048 sc1
  v_accvgpr_read_b32 v48, a24
  v_accvgpr_read_b32 v49, a25
  v_accvgpr_read_b32 v50, a26
  v_accvgpr_read_b32 v51, a27
  v_accvgpr_read_b32 v52, a28
  v_accvgpr_read_b32 v53, a29
  v_accvgpr_read_b32 v54, a30
  v_accvgpr_read_b32 v55, a31
  v_cvt_pk_bf16_f32 v44, v48, v49
  v_cvt_pk_bf16_f32 v45, v50, v51
  v_cvt_pk_bf16_f32 v46, v52, v53
  v_cvt_pk_bf16_f32 v47, v54, v55
  s_nop 1
  v_permlane32_swap_b32 v44, v46
  v_permlane32_swap_b32 v45, v47
  buffer_store_dwordx4 v[44:47], v2, s[4:7], 0 offen offset:2080 sc1
  v_accvgpr_read_b32 v12, a32
  v_accvgpr_read_b32 v13, a33
  v_accvgpr_read_b32 v14, a34
  v_accvgpr_read_b32 v15, a35
  v_accvgpr_read_b32 v16, a36
  v_accvgpr_read_b32 v17, a37
  v_accvgpr_read_b32 v18, a38
  v_accvgpr_read_b32 v19, a39
  v_cvt_pk_bf16_f32 v8, v12, v13
  v_cvt_pk_bf16_f32 v9, v14, v15
  v_cvt_pk_bf16_f32 v10, v16, v17
  v_cvt_pk_bf16_f32 v11, v18, v19
  s_nop 1
  v_permlane32_swap_b32 v8, v10
  v_permlane32_swap_b32 v9, v11
  buffer_store_dwordx4 v[8:11], v3, s[4:7], 0 offen offset:0 sc1
  v_accvgpr_read_b32 v24, a40
  v_accvgpr_read_b32 v25, a41
  v_accvgpr_read_b32 v26, a42
  v_accvgpr_read_b32 v27, a43
  v_accvgpr_read_b32 v28, a44
  v_accvgpr_read_b32 v29, a45
  v_accvgpr_read_b32 v30, a46
  v_accvgpr_read_b32 v31, a47
  v_cvt_pk_bf16_f32 v20, v24, v25
  v_cvt_pk_bf16_f32 v21, v26, v27
  v_cvt_pk_bf16_f32 v22, v28, v29
  v_cvt_pk_bf16_f32 v23, v30, v31
  s_nop 1
  v_permlane32_swap_b32 v20, v22
  v_permlane32_swap_b32 v21, v23
  buffer_store_dwordx4 v[20:23], v3, s[4:7], 0 offen offset:32 sc1
  v_accvgpr_read_b32 v36, a48
  v_accvgpr_read_b32 v37, a49
  v_accvgpr_read_b32 v38, a50
  v_accvgpr_read_b32 v39, a51
  v_accvgpr_read_b32 v40, a52
  v_accvgpr_read_b32 v41, a53
  v_accvgpr_read_b32 v42, a54
  v_accvgpr_read_b32 v43, a55
  v_cvt_pk_bf16_f32 v32, v36, v37
  v_cvt_pk_bf16_f32 v33, v38, v39
  v_cvt_pk_bf16_f32 v34, v40, v41
  v_cvt_pk_bf16_f32 v35, v42, v43
  s_nop 1
  v_permlane32_swap_b32 v32, v34
  v_permlane32_swap_b32 v33, v35
  buffer_store_dwordx4 v[32:35], v3, s[4:7], 0 offen offset:2048 sc1
  v_accvgpr_read_b32 v48, a56
  v_accvgpr_read_b32 v49, a57
  v_accvgpr_read_b32 v50, a58
  v_accvgpr_read_b32 v51, a59
  v_accvgpr_read_b32 v52, a60
  v_accvgpr_read_b32 v53, a61
  v_accvgpr_read_b32 v54, a62
  v_accvgpr_read_b32 v55, a63
  v_cvt_pk_bf16_f32 v44, v48, v49
  v_cvt_pk_bf16_f32 v45, v50, v51
  v_cvt_pk_bf16_f32 v46, v52, v53
  v_cvt_pk_bf16_f32 v47, v54, v55
  s_nop 1
  v_permlane32_swap_b32 v44, v46
  v_permlane32_swap_b32 v45, v47
  buffer_store_dwordx4 v[44:47], v3, s[4:7], 0 offen offset:2080 sc1
L_tq_done:
  s_waitcnt vmcnt(0)
  s_barrier
  s_cmp_lg_u32 s18, 0
  s_cbranch_scc1 L_sig_44
  s_lshl_b32 s34, s26, 5
  s_add_u32 s34, s34, s29
  s_lshl_b32 s34, s34, 4
  s_lshl_b32 s35, s28, 2
  s_add_u32 s34, s34, s35
  s_add_u32 s34, s34, 98566144
  v_mov_b32 v2, s34
  v_mov_b32 v3, s69
  s_mov_b64 exec, 1
  buffer_store_dword v3, v2, s[4:7], 0 offen sc1
  s_mov_b64 exec, -1

L_sig_44:
  s_branch L_worker
L_task_attn:
  s_mov_b32 s23, s27
  s_lshl_b32 s34, s26, 5
  s_add_u32 s34, s34, s27
  s_lshl_b32 s60, s34, 4
  s_add_u32 s60, s60, 98566144
  s_lshl_b32 s61, s34, 2
  s_add_u32 s61, s61, 98631680

  s_cmp_lg_u32 s18, 0
  s_cbranch_scc1 L_wo_46
  v_lshlrev_b32 v2, 2, v1
  v_add_u32 v2, s60, v2
  s_mov_b32 s62, 0
  s_mov_b64 exec, 0x7

L_wt_45:
  buffer_load_dword v3, v2, s[4:7], 0 offen sc1
  s_waitcnt vmcnt(0)
  v_cmp_ne_u32 vcc, s69, v3
  s_cbranch_vccz L_wo_46
  s_sleep 1
  s_add_u32 s62, s62, 1
  s_cmp_lt_u32 s62, 0x100000
  s_cbranch_scc1 L_wt_45

L_wo_46:
  s_mov_b64 exec, -1
  s_barrier
  s_lshl_b32 s20, s26, 2
  s_add_u32 s20, s20, s18
  s_mov_b32 s21, s27

  v_lshrrev_b32 v2, 4, v1
  v_and_b32 v3, 15, v1
  s_lshl_b32 s34, s20, 18
  s_lshl_b32 s35, s21, 8
  s_add_u32 s34, s34, s35
  v_lshlrev_b32 v4, 13, v3
  v_lshl_add_u32 v4, v2, 4, v4
  s_add_u32 s35, s34, 4194304
  v_add_u32 v5, s35, v4
  v_add_u32 v6, 131072, v5
  v_lshrrev_b32 v7, 2, v3
  v_lshlrev_b32 v7, 3, v7
  v_and_b32 v8, 3, v3
  v_add_u32 v7, v7, v8
  v_lshlrev_b32 v7, 13, v7
  v_lshl_add_u32 v7, v2, 4, v7
  s_add_u32 s35, s34, 20971520
  v_add_u32 v7, s35, v7
  v_add_u32 v8, 32768, v7
  s_lshl_b32 s35, s20, 5
  s_add_u32 s35, s35, s21
  s_lshl_b32 s36, s35, 11
  s_add_u32 s36, s36, 71303168
  v_lshlrev_b32 v9, 8, v3
  v_lshl_add_u32 v9, v2, 4, v9
  v_add_u32 v9, s36, v9
  v_mov_b32 v12, 2147483632
  v_cmp_gt_u32 vcc, 8, v3
  s_nop 1
  v_cndmask_b32 v9, v12, v9, vcc
  s_lshl_b32 s36, s35, 13
  s_add_u32 s36, s36, 37748736
  v_lshlrev_b32 v10, 6, v3
  v_lshl_add_u32 v10, v2, 4, v10
  v_add_u32 v10, s36, v10
  v_add_u32 v13, 4096, v10
  s_lshl_b32 s36, s35, 11
  s_add_u32 s36, s36, 75497472
  v_lshlrev_b32 v11, 4, v3
  v_lshl_add_u32 v11, v2, 3, v11
  v_add_u32 v11, s36, v11
  v_cmp_gt_u32 vcc, 2, v2
  s_nop 1
  v_cndmask_b32 v11, v12, v11, vcc
  s_mov_b64 s[58:59], vcc

  buffer_load_dwordx4 v[16:19], v5, s[4:7], 0 offen offset:0 sc1
  buffer_load_dwordx4 v[20:23], v5, s[4:7], 0 offen offset:64 sc1
  buffer_load_dwordx4 v[24:27], v5, s[4:7], 0 offen offset:128 sc1
  buffer_load_dwordx4 v[28:31], v5, s[4:7], 0 offen offset:192 sc1
  buffer_load_dwordx4 v[32:35], v6, s[4:7], 0 offen offset:0 sc1
  buffer_load_dwordx4 v[36:39], v6, s[4:7], 0 offen offset:64 sc1
  buffer_load_dwordx4 v[40:43], v6, s[4:7], 0 offen offset:128 sc1
  buffer_load_dwordx4 v[44:47], v6, s[4:7], 0 offen offset:192 sc1
  buffer_load_dwordx4 v[48:51], v7, s[4:7], 0 offen offset:0 sc1
  buffer_load_dwordx4 v[52:55], v7, s[4:7], 0 offen offset:64 sc1
  buffer_load_dwordx4 v[56:59], v7, s[4:7], 0 offen offset:128 sc1
  buffer_load_dwordx4 v[60:63], v7, s[4:7], 0 offen offset:192 sc1
  buffer_load_dwordx4 v[64:67], v8, s[4:7], 0 offen offset:0 sc1
  buffer_load_dwordx4 v[68:71], v8, s[4:7], 0 offen offset:64 sc1
  buffer_load_dwordx4 v[72:75], v8, s[4:7], 0 offen offset:128 sc1
  buffer_load_dwordx4 v[76:79], v8, s[4:7], 0 offen offset:192 sc1
  buffer_load_dwordx4 v[96:99], v10, s[4:7], 0 offen offset:0 sc1
  buffer_load_dwordx4 v[100:103], v10, s[4:7], 0 offen offset:1024 sc1
  buffer_load_dwordx4 v[104:107], v10, s[4:7], 0 offen offset:2048 sc1
  buffer_load_dwordx4 v[108:111], v10, s[4:7], 0 offen offset:3072 sc1
  buffer_load_dwordx4 v[112:115], v13, s[4:7], 0 offen offset:0 sc1
  buffer_load_dwordx4 v[116:119], v13, s[4:7], 0 offen offset:1024 sc1
  buffer_load_dwordx4 v[120:123], v13, s[4:7], 0 offen offset:2048 sc1
  buffer_load_dwordx4 v[124:127], v13, s[4:7], 0 offen offset:3072 sc1
  s_cmp_lg_u32 s18, 0
  s_cbranch_scc1 L_wo_48
  v_lshlrev_b32 v14, 2, v1
  v_add_u32 v14, s61, v14
  s_mov_b32 s62, 0
  s_mov_b64 exec, 0x1

L_wt_47:
  buffer_load_dword v15, v14, s[4:7], 0 offen sc1
  s_waitcnt vmcnt(0)
  v_cmp_ne_u32 vcc, s69, v15
  s_cbranch_vccz L_wo_48
  s_sleep 1
  s_add_u32 s62, s62, 1
  s_cmp_lt_u32 s62, 0x100000
  s_cbranch_scc1 L_wt_47

L_wo_48:
  s_mov_b64 exec, -1
  s_barrier
  buffer_load_dwordx4 v[80:83], v9, s[4:7], 0 offen offset:0 sc1
  buffer_load_dwordx4 v[84:87], v9, s[4:7], 0 offen offset:64 sc1
  buffer_load_dwordx4 v[88:91], v9, s[4:7], 0 offen offset:128 sc1
  buffer_load_dwordx4 v[92:95], v9, s[4:7], 0 offen offset:192 sc1
  buffer_load_dwordx2 v[128:129], v11, s[4:7], 0 offen offset:0 sc1
  v_mov_b32 v130, 0
  v_mov_b32 v131, 0
  buffer_load_dwordx2 v[132:133], v11, s[4:7], 0 offen offset:256 sc1
  v_mov_b32 v134, 0
  v_mov_b32 v135, 0
  buffer_load_dwordx2 v[136:137], v11, s[4:7], 0 offen offset:512 sc1
  v_mov_b32 v138, 0
  v_mov_b32 v139, 0
  buffer_load_dwordx2 v[140:141], v11, s[4:7], 0 offen offset:768 sc1
  v_mov_b32 v142, 0
  v_mov_b32 v143, 0
  buffer_load_dwordx2 v[144:145], v11, s[4:7], 0 offen offset:1024 sc1
  v_mov_b32 v146, 0
  v_mov_b32 v147, 0
  buffer_load_dwordx2 v[148:149], v11, s[4:7], 0 offen offset:1280 sc1
  v_mov_b32 v150, 0
  v_mov_b32 v151, 0
  buffer_load_dwordx2 v[152:153], v11, s[4:7], 0 offen offset:1536 sc1
  v_mov_b32 v154, 0
  v_mov_b32 v155, 0
  buffer_load_dwordx2 v[156:157], v11, s[4:7], 0 offen offset:1792 sc1
  v_mov_b32 v158, 0
  v_mov_b32 v159, 0
  s_waitcnt vmcnt(8)
  v_mfma_f32_16x16x32_bf16 v[160:163], v[80:83], v[16:19], 0
  v_mfma_f32_16x16x32_bf16 v[164:167], v[48:51], v[16:19], 0
  v_mfma_f32_16x16x32_bf16 v[168:171], v[64:67], v[16:19], 0
  v_mfma_f32_16x16x32_bf16 v[160:163], v[84:87], v[20:23], v[160:163]
  v_mfma_f32_16x16x32_bf16 v[164:167], v[52:55], v[20:23], v[164:167]
  v_mfma_f32_16x16x32_bf16 v[168:171], v[68:71], v[20:23], v[168:171]
  v_mfma_f32_16x16x32_bf16 v[160:163], v[88:91], v[24:27], v[160:163]
  v_mfma_f32_16x16x32_bf16 v[164:167], v[56:59], v[24:27], v[164:167]
  v_mfma_f32_16x16x32_bf16 v[168:171], v[72:75], v[24:27], v[168:171]
  v_mfma_f32_16x16x32_bf16 v[160:163], v[92:95], v[28:31], v[160:163]
  v_mfma_f32_16x16x32_bf16 v[164:167], v[60:63], v[28:31], v[164:167]
  v_mfma_f32_16x16x32_bf16 v[168:171], v[76:79], v[28:31], v[168:171]
  v_mfma_f32_16x16x32_bf16 v[172:175], v[80:83], v[32:35], 0
  v_mfma_f32_16x16x32_bf16 v[176:179], v[48:51], v[32:35], 0
  v_mfma_f32_16x16x32_bf16 v[180:183], v[64:67], v[32:35], 0
  v_mfma_f32_16x16x32_bf16 v[172:175], v[84:87], v[36:39], v[172:175]
  v_mfma_f32_16x16x32_bf16 v[176:179], v[52:55], v[36:39], v[176:179]
  v_mfma_f32_16x16x32_bf16 v[180:183], v[68:71], v[36:39], v[180:183]
  v_mfma_f32_16x16x32_bf16 v[172:175], v[88:91], v[40:43], v[172:175]
  v_mfma_f32_16x16x32_bf16 v[176:179], v[56:59], v[40:43], v[176:179]
  v_mfma_f32_16x16x32_bf16 v[180:183], v[72:75], v[40:43], v[180:183]
  v_mfma_f32_16x16x32_bf16 v[172:175], v[92:95], v[44:47], v[172:175]
  v_mfma_f32_16x16x32_bf16 v[176:179], v[60:63], v[44:47], v[176:179]
  v_mfma_f32_16x16x32_bf16 v[180:183], v[76:79], v[44:47], v[180:183]
  s_mov_b32 s68, 0x3e0293ee
  v_mov_b32 v14, 0xf149f2ca
  v_lshlrev_b32 v15, 3, v2
  s_nop 5
  v_and_b32 v4, 15, v1
  v_cndmask_b32 v160, v14, v160, s[58:59]
  v_cndmask_b32 v161, v14, v161, s[58:59]
  v_cndmask_b32 v162, v14, v162, s[58:59]
  v_cndmask_b32 v163, v14, v163, s[58:59]
  v_add_u32 v5, 0, v15
  v_cmp_le_i32 vcc, v5, v4
  s_nop 0
  v_cndmask_b32 v164, v14, v164, vcc
  v_add_u32 v5, 1, v15
  v_cmp_le_i32 vcc, v5, v4
  s_nop 0
  v_cndmask_b32 v165, v14, v165, vcc
  v_add_u32 v5, 2, v15
  v_cmp_le_i32 vcc, v5, v4
  s_nop 0
  v_cndmask_b32 v166, v14, v166, vcc
  v_add_u32 v5, 3, v15
  v_cmp_le_i32 vcc, v5, v4
  s_nop 0
  v_cndmask_b32 v167, v14, v167, vcc
  v_add_u32 v5, 4, v15
  v_cmp_le_i32 vcc, v5, v4
  s_nop 0
  v_cndmask_b32 v168, v14, v168, vcc
  v_add_u32 v5, 5, v15
  v_cmp_le_i32 vcc, v5, v4
  s_nop 0
  v_cndmask_b32 v169, v14, v169, vcc
  v_add_u32 v5, 6, v15
  v_cmp_le_i32 vcc, v5, v4
  s_nop 0
  v_cndmask_b32 v170, v14, v170, vcc
  v_add_u32 v5, 7, v15
  v_cmp_le_i32 vcc, v5, v4
  s_nop 0
  v_cndmask_b32 v171, v14, v171, vcc
  v_max3_f32 v2, v160, v161, v162
  v_max3_f32 v2, v2, v163, v164
  v_max3_f32 v2, v2, v165, v166
  v_max3_f32 v2, v2, v167, v168
  v_max3_f32 v2, v2, v169, v170
  v_max_f32 v2, v2, v171
  v_mov_b32 v3, v2
  s_nop 1
  v_permlane16_swap_b32 v2, v3
  v_max_f32 v2, v2, v3
  v_mov_b32 v3, v2
  s_nop 1
  v_permlane32_swap_b32 v2, v3
  v_max_f32 v2, v2, v3

  v_mul_f32 v2, s68, v2
  v_fma_f32 v160, v160, s68, -v2
  v_fma_f32 v161, v161, s68, -v2
  v_fma_f32 v162, v162, s68, -v2
  v_fma_f32 v163, v163, s68, -v2
  v_fma_f32 v164, v164, s68, -v2
  v_fma_f32 v165, v165, s68, -v2
  v_fma_f32 v166, v166, s68, -v2
  v_fma_f32 v167, v167, s68, -v2
  v_fma_f32 v168, v168, s68, -v2
  v_fma_f32 v169, v169, s68, -v2
  v_fma_f32 v170, v170, s68, -v2
  v_fma_f32 v171, v171, s68, -v2
  v_exp_f32 v160, v160
  v_exp_f32 v161, v161
  v_exp_f32 v162, v162
  v_exp_f32 v163, v163
  v_exp_f32 v164, v164
  v_exp_f32 v165, v165
  v_exp_f32 v166, v166
  v_exp_f32 v167, v167
  v_exp_f32 v168, v168
  v_exp_f32 v169, v169
  v_exp_f32 v170, v170
  v_exp_f32 v171, v171
  s_nop 0
  v_add_f32 v2, v160, v161
  v_add_f32 v2, v2, v162
  v_add_f32 v2, v2, v163
  v_add_f32 v2, v2, v164
  v_add_f32 v2, v2, v165
  v_add_f32 v2, v2, v166
  v_add_f32 v2, v2, v167
  v_add_f32 v2, v2, v168
  v_add_f32 v2, v2, v169
  v_add_f32 v2, v2, v170
  v_add_f32 v2, v2, v171
  v_mov_b32 v3, v2
  s_nop 1
  v_permlane16_swap_b32 v2, v3
  v_add_f32 v2, v2, v3
  v_mov_b32 v3, v2
  s_nop 1
  v_permlane32_swap_b32 v2, v3
  v_add_f32 v2, v2, v3

  v_rcp_f32 v2, v2
  s_nop 0
  v_mul_f32 v160, v160, v2
  v_mul_f32 v161, v161, v2
  v_mul_f32 v162, v162, v2
  v_mul_f32 v163, v163, v2
  v_mul_f32 v164, v164, v2
  v_mul_f32 v165, v165, v2
  v_mul_f32 v166, v166, v2
  v_mul_f32 v167, v167, v2
  v_mul_f32 v168, v168, v2
  v_mul_f32 v169, v169, v2
  v_mul_f32 v170, v170, v2
  v_mul_f32 v171, v171, v2
  v_cvt_pk_bf16_f32 v160, v160, v161
  v_cvt_pk_bf16_f32 v161, v162, v163
  v_mov_b32 v162, 0
  v_mov_b32 v163, 0
  v_cvt_pk_bf16_f32 v164, v164, v165
  v_cvt_pk_bf16_f32 v165, v166, v167
  v_cvt_pk_bf16_f32 v166, v168, v169
  v_cvt_pk_bf16_f32 v167, v170, v171

  v_cndmask_b32 v172, v14, v172, s[58:59]
  v_cndmask_b32 v173, v14, v173, s[58:59]
  v_cndmask_b32 v174, v14, v174, s[58:59]
  v_cndmask_b32 v175, v14, v175, s[58:59]
  v_add_u32 v5, -16, v15
  v_cmp_le_i32 vcc, v5, v4
  s_nop 0
  v_cndmask_b32 v176, v14, v176, vcc
  v_add_u32 v5, -15, v15
  v_cmp_le_i32 vcc, v5, v4
  s_nop 0
  v_cndmask_b32 v177, v14, v177, vcc
  v_add_u32 v5, -14, v15
  v_cmp_le_i32 vcc, v5, v4
  s_nop 0
  v_cndmask_b32 v178, v14, v178, vcc
  v_add_u32 v5, -13, v15
  v_cmp_le_i32 vcc, v5, v4
  s_nop 0
  v_cndmask_b32 v179, v14, v179, vcc
  v_add_u32 v5, -12, v15
  v_cmp_le_i32 vcc, v5, v4
  s_nop 0
  v_cndmask_b32 v180, v14, v180, vcc
  v_add_u32 v5, -11, v15
  v_cmp_le_i32 vcc, v5, v4
  s_nop 0
  v_cndmask_b32 v181, v14, v181, vcc
  v_add_u32 v5, -10, v15
  v_cmp_le_i32 vcc, v5, v4
  s_nop 0
  v_cndmask_b32 v182, v14, v182, vcc
  v_add_u32 v5, -9, v15
  v_cmp_le_i32 vcc, v5, v4
  s_nop 0
  v_cndmask_b32 v183, v14, v183, vcc
  v_max3_f32 v2, v172, v173, v174
  v_max3_f32 v2, v2, v175, v176
  v_max3_f32 v2, v2, v177, v178
  v_max3_f32 v2, v2, v179, v180
  v_max3_f32 v2, v2, v181, v182
  v_max_f32 v2, v2, v183
  v_mov_b32 v3, v2
  s_nop 1
  v_permlane16_swap_b32 v2, v3
  v_max_f32 v2, v2, v3
  v_mov_b32 v3, v2
  s_nop 1
  v_permlane32_swap_b32 v2, v3
  v_max_f32 v2, v2, v3

  v_mul_f32 v2, s68, v2
  v_fma_f32 v172, v172, s68, -v2
  v_fma_f32 v173, v173, s68, -v2
  v_fma_f32 v174, v174, s68, -v2
  v_fma_f32 v175, v175, s68, -v2
  v_fma_f32 v176, v176, s68, -v2
  v_fma_f32 v177, v177, s68, -v2
  v_fma_f32 v178, v178, s68, -v2
  v_fma_f32 v179, v179, s68, -v2
  v_fma_f32 v180, v180, s68, -v2
  v_fma_f32 v181, v181, s68, -v2
  v_fma_f32 v182, v182, s68, -v2
  v_fma_f32 v183, v183, s68, -v2
  v_exp_f32 v172, v172
  v_exp_f32 v173, v173
  v_exp_f32 v174, v174
  v_exp_f32 v175, v175
  v_exp_f32 v176, v176
  v_exp_f32 v177, v177
  v_exp_f32 v178, v178
  v_exp_f32 v179, v179
  v_exp_f32 v180, v180
  v_exp_f32 v181, v181
  v_exp_f32 v182, v182
  v_exp_f32 v183, v183
  s_nop 0
  v_add_f32 v2, v172, v173
  v_add_f32 v2, v2, v174
  v_add_f32 v2, v2, v175
  v_add_f32 v2, v2, v176
  v_add_f32 v2, v2, v177
  v_add_f32 v2, v2, v178
  v_add_f32 v2, v2, v179
  v_add_f32 v2, v2, v180
  v_add_f32 v2, v2, v181
  v_add_f32 v2, v2, v182
  v_add_f32 v2, v2, v183
  v_mov_b32 v3, v2
  s_nop 1
  v_permlane16_swap_b32 v2, v3
  v_add_f32 v2, v2, v3
  v_mov_b32 v3, v2
  s_nop 1
  v_permlane32_swap_b32 v2, v3
  v_add_f32 v2, v2, v3

  v_rcp_f32 v2, v2
  s_nop 0
  v_mul_f32 v172, v172, v2
  v_mul_f32 v173, v173, v2
  v_mul_f32 v174, v174, v2
  v_mul_f32 v175, v175, v2
  v_mul_f32 v176, v176, v2
  v_mul_f32 v177, v177, v2
  v_mul_f32 v178, v178, v2
  v_mul_f32 v179, v179, v2
  v_mul_f32 v180, v180, v2
  v_mul_f32 v181, v181, v2
  v_mul_f32 v182, v182, v2
  v_mul_f32 v183, v183, v2
  v_cvt_pk_bf16_f32 v172, v172, v173
  v_cvt_pk_bf16_f32 v173, v174, v175
  v_mov_b32 v174, 0
  v_mov_b32 v175, 0
  v_cvt_pk_bf16_f32 v176, v176, v177
  v_cvt_pk_bf16_f32 v177, v178, v179
  v_cvt_pk_bf16_f32 v178, v180, v181
  v_cvt_pk_bf16_f32 v179, v182, v183

  v_lshlrev_b32 v5, 13, v4
  v_add_u32 v5, v5, v15
  s_add_u32 s35, s34, 54525952
  v_add_u32 v5, s35, v5
  v_add_u32 v6, 131072, v5
  s_waitcnt vmcnt(0)

  v_mfma_f32_16x16x32_bf16 v[16:19], v[96:99], v[164:167], 0
  v_mfma_f32_16x16x32_bf16 v[20:23], v[100:103], v[164:167], 0
  v_mfma_f32_16x16x32_bf16 v[24:27], v[104:107], v[164:167], 0
  v_mfma_f32_16x16x32_bf16 v[28:31], v[108:111], v[164:167], 0
  v_mfma_f32_16x16x32_bf16 v[32:35], v[112:115], v[164:167], 0
  v_mfma_f32_16x16x32_bf16 v[36:39], v[116:119], v[164:167], 0
  v_mfma_f32_16x16x32_bf16 v[40:43], v[120:123], v[164:167], 0
  v_mfma_f32_16x16x32_bf16 v[44:47], v[124:127], v[164:167], 0
  v_mfma_f32_16x16x32_bf16 v[16:19], v[128:131], v[160:163], v[16:19]
  v_mfma_f32_16x16x32_bf16 v[20:23], v[132:135], v[160:163], v[20:23]
  v_mfma_f32_16x16x32_bf16 v[24:27], v[136:139], v[160:163], v[24:27]
  v_mfma_f32_16x16x32_bf16 v[28:31], v[140:143], v[160:163], v[28:31]
  v_mfma_f32_16x16x32_bf16 v[32:35], v[144:147], v[160:163], v[32:35]
  v_mfma_f32_16x16x32_bf16 v[36:39], v[148:151], v[160:163], v[36:39]
  v_mfma_f32_16x16x32_bf16 v[40:43], v[152:155], v[160:163], v[40:43]
  v_mfma_f32_16x16x32_bf16 v[44:47], v[156:159], v[160:163], v[44:47]
  v_mfma_f32_16x16x32_bf16 v[48:51], v[96:99], v[176:179], 0
  v_mfma_f32_16x16x32_bf16 v[52:55], v[100:103], v[176:179], 0
  v_mfma_f32_16x16x32_bf16 v[56:59], v[104:107], v[176:179], 0
  v_mfma_f32_16x16x32_bf16 v[60:63], v[108:111], v[176:179], 0
  v_mfma_f32_16x16x32_bf16 v[64:67], v[112:115], v[176:179], 0
  v_mfma_f32_16x16x32_bf16 v[68:71], v[116:119], v[176:179], 0
  v_mfma_f32_16x16x32_bf16 v[72:75], v[120:123], v[176:179], 0
  v_mfma_f32_16x16x32_bf16 v[76:79], v[124:127], v[176:179], 0
  v_mfma_f32_16x16x32_bf16 v[48:51], v[128:131], v[172:175], v[48:51]
  v_mfma_f32_16x16x32_bf16 v[52:55], v[132:135], v[172:175], v[52:55]
  v_mfma_f32_16x16x32_bf16 v[56:59], v[136:139], v[172:175], v[56:59]
  v_mfma_f32_16x16x32_bf16 v[60:63], v[140:143], v[172:175], v[60:63]
  v_mfma_f32_16x16x32_bf16 v[64:67], v[144:147], v[172:175], v[64:67]
  v_mfma_f32_16x16x32_bf16 v[68:71], v[148:151], v[172:175], v[68:71]
  v_mfma_f32_16x16x32_bf16 v[72:75], v[152:155], v[172:175], v[72:75]
  v_mfma_f32_16x16x32_bf16 v[76:79], v[156:159], v[172:175], v[76:79]
  s_nop 7
  s_mul_i32 s36, s18, 8704
  v_mul_u32_u24 v7, 272, v4
  v_add_u32 v7, v7, v15
  v_add_u32 v7, s36, v7
  v_lshrrev_b32 v8, 4, v1
  v_and_b32 v9, 15, v1
  v_mul_u32_u24 v10, 272, v8
  v_lshl_add_u32 v10, v9, 4, v10
  v_add_u32 v10, s36, v10
  v_lshlrev_b32 v11, 13, v8
  v_lshl_add_u32 v11, v9, 4, v11
  v_add_u32 v11, s35, v11

  v_cvt_pk_bf16_f32 v16, v16, v17
  v_cvt_pk_bf16_f32 v17, v18, v19
  ds_write_b64 v7, v[16:17] offset:0
  v_cvt_pk_bf16_f32 v20, v20, v21
  v_cvt_pk_bf16_f32 v21, v22, v23
  ds_write_b64 v7, v[20:21] offset:32
  v_cvt_pk_bf16_f32 v24, v24, v25
  v_cvt_pk_bf16_f32 v25, v26, v27
  ds_write_b64 v7, v[24:25] offset:64
  v_cvt_pk_bf16_f32 v28, v28, v29
  v_cvt_pk_bf16_f32 v29, v30, v31
  ds_write_b64 v7, v[28:29] offset:96
  v_cvt_pk_bf16_f32 v32, v32, v33
  v_cvt_pk_bf16_f32 v33, v34, v35
  ds_write_b64 v7, v[32:33] offset:128
  v_cvt_pk_bf16_f32 v36, v36, v37
  v_cvt_pk_bf16_f32 v37, v38, v39
  ds_write_b64 v7, v[36:37] offset:160
  v_cvt_pk_bf16_f32 v40, v40, v41
  v_cvt_pk_bf16_f32 v41, v42, v43
  ds_write_b64 v7, v[40:41] offset:192
  v_cvt_pk_bf16_f32 v44, v44, v45
  v_cvt_pk_bf16_f32 v45, v46, v47
  ds_write_b64 v7, v[44:45] offset:224
  v_cvt_pk_bf16_f32 v48, v48, v49
  v_cvt_pk_bf16_f32 v49, v50, v51
  ds_write_b64 v7, v[48:49] offset:4352
  v_cvt_pk_bf16_f32 v52, v52, v53
  v_cvt_pk_bf16_f32 v53, v54, v55
  ds_write_b64 v7, v[52:53] offset:4384
  v_cvt_pk_bf16_f32 v56, v56, v57
  v_cvt_pk_bf16_f32 v57, v58, v59
  ds_write_b64 v7, v[56:57] offset:4416
  v_cvt_pk_bf16_f32 v60, v60, v61
  v_cvt_pk_bf16_f32 v61, v62, v63
  ds_write_b64 v7, v[60:61] offset:4448
  v_cvt_pk_bf16_f32 v64, v64, v65
  v_cvt_pk_bf16_f32 v65, v66, v67
  ds_write_b64 v7, v[64:65] offset:4480
  v_cvt_pk_bf16_f32 v68, v68, v69
  v_cvt_pk_bf16_f32 v69, v70, v71
  ds_write_b64 v7, v[68:69] offset:4512
  v_cvt_pk_bf16_f32 v72, v72, v73
  v_cvt_pk_bf16_f32 v73, v74, v75
  ds_write_b64 v7, v[72:73] offset:4544
  v_cvt_pk_bf16_f32 v76, v76, v77
  v_cvt_pk_bf16_f32 v77, v78, v79
  ds_write_b64 v7, v[76:77] offset:4576
  s_waitcnt lgkmcnt(0)
  ds_read_b128 v[96:99], v10 offset:0
  ds_read_b128 v[100:103], v10 offset:1088
  ds_read_b128 v[104:107], v10 offset:2176
  ds_read_b128 v[108:111], v10 offset:3264
  ds_read_b128 v[112:115], v10 offset:4352
  ds_read_b128 v[116:119], v10 offset:5440
  ds_read_b128 v[120:123], v10 offset:6528
  ds_read_b128 v[124:127], v10 offset:7616
  s_waitcnt lgkmcnt(7)
  s_mov_b32 s36, 0
  buffer_store_dwordx4 v[96:99], v11, s[4:7], s36 offen sc1
  s_waitcnt lgkmcnt(6)
  s_mov_b32 s36, 32768
  buffer_store_dwordx4 v[100:103], v11, s[4:7], s36 offen sc1
  s_waitcnt lgkmcnt(5)
  s_mov_b32 s36, 65536
  buffer_store_dwordx4 v[104:107], v11, s[4:7], s36 offen sc1
  s_waitcnt lgkmcnt(4)
  s_mov_b32 s36, 98304
  buffer_store_dwordx4 v[108:111], v11, s[4:7], s36 offen sc1
  s_waitcnt lgkmcnt(3)
  s_mov_b32 s36, 131072
  buffer_store_dwordx4 v[112:115], v11, s[4:7], s36 offen sc1
  s_waitcnt lgkmcnt(2)
  s_mov_b32 s36, 163840
  buffer_store_dwordx4 v[116:119], v11, s[4:7], s36 offen sc1
  s_waitcnt lgkmcnt(1)
  s_mov_b32 s36, 196608
  buffer_store_dwordx4 v[120:123], v11, s[4:7], s36 offen sc1
  s_waitcnt lgkmcnt(0)
  s_mov_b32 s36, 229376
  buffer_store_dwordx4 v[124:127], v11, s[4:7], s36 offen sc1
  v_and_b32 v1, 63, v0
  s_waitcnt vmcnt(0)
  s_barrier
  s_cmp_lg_u32 s18, 0
  s_cbranch_scc1 L_sig_49
  s_lshl_b32 s60, s26, 8
  s_lshl_b32 s61, s23, 2
  s_add_u32 s60, s60, s61
  s_add_u32 s60, s60, 98697216
  v_mov_b32 v2, s60
  v_mov_b32 v3, s69
  s_mov_b64 exec, 1
  buffer_store_dword v3, v2, s[4:7], 0 offen sc1
  s_mov_b64 exec, -1

L_sig_49:
  s_branch L_worker
L_task_op:
  s_mov_b32 s23, s27
  s_cmp_lg_u32 s18, 0
  s_cbranch_scc1 L_wo_51
  s_lshl_b32 s60, s26, 8
  s_add_u32 s60, s60, 98697216
  v_lshlrev_b32 v2, 2, v1
  v_add_u32 v2, s60, v2
  s_mov_b32 s62, 0

  s_mov_b64 exec, 0xffffffff
L_wt_50:
  buffer_load_dword v3, v2, s[4:7], 0 offen sc1
  s_waitcnt vmcnt(0)
  v_cmp_ne_u32 vcc, s69, v3
  s_cbranch_vccz L_wo_51
  s_sleep 1
  s_add_u32 s62, s62, 1
  s_cmp_lt_u32 s62, 0x100000
  s_cbranch_scc1 L_wt_50

L_wo_51:
  s_mov_b64 exec, -1
  s_barrier
  s_lshr_b32 s25, s27, 3
  s_and_b32 s27, s27, 7
  s_mov_b32 s38, 8192
  s_mov_b32 s39, 1024
  s_lshl_b32 s30, s26, 20
  s_lshl_b32 s34, s25, 10
  s_add_u32 s30, s30, s34
  s_add_u32 s30, s30, 54525952
  s_lshl_b32 s31, s27, 7
  s_lshl_b32 s34, s25, 19
  s_add_u32 s31, s31, s34

  s_mov_b32 s12, s86
  s_mov_b32 s13, s87
  s_mov_b32 s14, 4194304
  s_mov_b32 s15, 0x00020000
  s_lshr_b32 s36, s18, 1
  s_and_b32 s37, s18, 1
  v_lshrrev_b32 v17, 3, v1
  v_mul_lo_u32 v2, v17, s38
  v_and_b32 v18, 7, v1
  v_lshrrev_b32 v19, 4, v1
  v_xor_b32 v18, v18, v19
  v_lshl_add_u32 v2, v18, 4, v2
  v_xor_b32 v3, 64, v2

  v_lshrrev_b32 v17, 3, v1
  v_mul_lo_u32 v4, v17, s39
  v_lshrrev_b32 v18, 4, v1
  v_and_b32 v18, 1, v18
  v_lshlrev_b32 v18, 2, v18
  v_and_b32 v19, 7, v1
  v_xor_b32 v19, v19, v18
  v_lshl_add_u32 v4, v19, 4, v4
  v_and_b32 v17, 31, v1
  v_lshrrev_b32 v18, 1, v17
  v_and_b32 v18, 7, v18
  v_lshrrev_b32 v19, 5, v1
  v_xor_b32 v18, v18, v19
  s_mul_i32 s34, s36, 8192
  v_lshlrev_b32 v17, 7, v17
  v_add_u32 v17, s34, v17

  v_xor_b32 v19, 0, v18
  v_lshl_add_u32 v5, v19, 4, v17
  v_add_u32 v9, 73728, v5
  v_xor_b32 v19, 2, v18
  v_lshl_add_u32 v6, v19, 4, v17
  v_add_u32 v10, 73728, v6
  v_xor_b32 v19, 4, v18
  v_lshl_add_u32 v7, v19, 4, v17
  v_add_u32 v11, 73728, v7
  v_xor_b32 v19, 6, v18
  v_lshl_add_u32 v8, v19, 4, v17
  v_add_u32 v12, 73728, v8
  v_lshrrev_b32 v17, 5, v1
  v_lshlrev_b32 v17, 3, v17
  v_lshrrev_b32 v18, 2, v1
  v_and_b32 v18, 3, v18
  v_add_u32 v17, v17, v18
  v_lshlrev_b32 v17, 7, v17
  v_lshrrev_b32 v18, 1, v18
  v_lshl_add_u32 v17, v18, 6, v17
  v_lshrrev_b32 v18, 4, v1
  v_and_b32 v18, 1, v18
  v_lshl_add_u32 v17, v18, 5, v17
  v_and_b32 v18, 3, v1
  v_lshl_add_u32 v17, v18, 3, v17
  s_lshl_b32 s34, s37, 6
  v_xor_b32 v17, s34, v17
  s_mov_b32 s34, 16384
  v_add_u32 v13, s34, v17
  v_xor_b32 v14, 64, v13
  v_add_u32 v15, 73728, v13
  v_add_u32 v16, 73728, v14

  s_mov_b32 s40, s30
  s_mul_i32 s34, s18, s38
  s_mul_i32 s34, s34, 32
  s_add_u32 s40, s40, s34
  s_mov_b32 s41, s31
  s_mul_i32 s34, s18, s39
  s_lshl_b32 s34, s34, 4
  s_add_u32 s41, s41, s34
  s_lshl_b32 s35, s18, 10
  s_mul_i32 s48, s38, 0
  s_mul_i32 s49, s38, 8
  s_mul_i32 s50, s38, 16
  s_mul_i32 s51, s38, 24
  s_lshl_b32 s56, s39, 3
  s_lshl_b32 s57, s39, 6
  s_mul_i32 s34, s18, 4096
  s_add_u32 s34, s34, 0
  s_add_u32 m0, s34, 0
  s_add_u32 s35, s40, s48
  buffer_load_dwordx4 v2, s[4:7], s35 offen sc1 lds
  s_add_u32 m0, s34, 1024
  s_add_u32 s35, s40, s49
  buffer_load_dwordx4 v3, s[4:7], s35 offen sc1 lds
  s_add_u32 m0, s34, 2048
  s_add_u32 s35, s40, s50
  buffer_load_dwordx4 v2, s[4:7], s35 offen sc1 lds
  s_add_u32 m0, s34, 3072
  s_add_u32 s35, s40, s51
  buffer_load_dwordx4 v3, s[4:7], s35 offen sc1 lds
  s_add_u32 s40, s40, 128
  s_lshl_b32 s34, s18, 11
  s_add_u32 s34, s34, 16384
  s_add_u32 m0, s34, 0
  s_nop 0
  buffer_load_dwordx4 v4, s[12:15], s41 offen lds
  s_add_u32 m0, s34, 1024
  s_add_u32 s35, s41, s56
  buffer_load_dwordx4 v4, s[12:15], s35 offen lds
  s_add_u32 s41, s41, s57
  s_mul_i32 s34, s18, 4096
  s_add_u32 s34, s34, 24576
  s_add_u32 m0, s34, 0
  s_add_u32 s35, s40, s48
  buffer_load_dwordx4 v2, s[4:7], s35 offen sc1 lds
  s_add_u32 m0, s34, 1024
  s_add_u32 s35, s40, s49
  buffer_load_dwordx4 v3, s[4:7], s35 offen sc1 lds
  s_add_u32 m0, s34, 2048
  s_add_u32 s35, s40, s50
  buffer_load_dwordx4 v2, s[4:7], s35 offen sc1 lds
  s_add_u32 m0, s34, 3072
  s_add_u32 s35, s40, s51
  buffer_load_dwordx4 v3, s[4:7], s35 offen sc1 lds
  s_add_u32 s40, s40, 128
  s_lshl_b32 s34, s18, 11
  s_add_u32 s34, s34, 40960
  s_add_u32 m0, s34, 0
  s_nop 0
  buffer_load_dwordx4 v4, s[12:15], s41 offen lds
  s_add_u32 m0, s34, 1024
  s_add_u32 s35, s41, s56
  buffer_load_dwordx4 v4, s[12:15], s35 offen lds
  s_add_u32 s41, s41, s57
  s_mul_i32 s34, s18, 4096
  s_add_u32 s34, s34, 49152
  s_add_u32 m0, s34, 0
  s_add_u32 s35, s40, s48
  buffer_load_dwordx4 v2, s[4:7], s35 offen sc1 lds
  s_add_u32 m0, s34, 1024
  s_add_u32 s35, s40, s49
  buffer_load_dwordx4 v3, s[4:7], s35 offen sc1 lds
  s_add_u32 m0, s34, 2048
  s_add_u32 s35, s40, s50
  buffer_load_dwordx4 v2, s[4:7], s35 offen sc1 lds
  s_add_u32 m0, s34, 3072
  s_add_u32 s35, s40, s51
  buffer_load_dwordx4 v3, s[4:7], s35 offen sc1 lds
  s_add_u32 s40, s40, 128
  s_lshl_b32 s34, s18, 11
  s_add_u32 s34, s34, 65536
  s_add_u32 m0, s34, 0
  s_nop 0
  buffer_load_dwordx4 v4, s[12:15], s41 offen lds
  s_add_u32 m0, s34, 1024
  s_add_u32 s35, s41, s56
  buffer_load_dwordx4 v4, s[12:15], s35 offen lds
  s_add_u32 s41, s41, s57
  s_mul_i32 s34, s18, 4096
  s_add_u32 s34, s34, 73728
  s_add_u32 m0, s34, 0
  s_add_u32 s35, s40, s48
  buffer_load_dwordx4 v2, s[4:7], s35 offen sc1 lds
  s_add_u32 m0, s34, 1024
  s_add_u32 s35, s40, s49
  buffer_load_dwordx4 v3, s[4:7], s35 offen sc1 lds
  s_add_u32 m0, s34, 2048
  s_add_u32 s35, s40, s50
  buffer_load_dwordx4 v2, s[4:7], s35 offen sc1 lds
  s_add_u32 m0, s34, 3072
  s_add_u32 s35, s40, s51
  buffer_load_dwordx4 v3, s[4:7], s35 offen sc1 lds
  s_add_u32 s40, s40, 128
  s_lshl_b32 s34, s18, 11
  s_add_u32 s34, s34, 90112
  s_add_u32 m0, s34, 0
  s_nop 0
  buffer_load_dwordx4 v4, s[12:15], s41 offen lds
  s_add_u32 m0, s34, 1024
  s_add_u32 s35, s41, s56
  buffer_load_dwordx4 v4, s[12:15], s35 offen lds
  s_add_u32 s41, s41, s57
  s_mul_i32 s34, s18, 4096
  s_add_u32 s34, s34, 98304
  s_add_u32 m0, s34, 0
  s_add_u32 s35, s40, s48
  buffer_load_dwordx4 v2, s[4:7], s35 offen sc1 lds
  s_add_u32 m0, s34, 1024
  s_add_u32 s35, s40, s49
  buffer_load_dwordx4 v3, s[4:7], s35 offen sc1 lds
  s_add_u32 m0, s34, 2048
  s_add_u32 s35, s40, s50
  buffer_load_dwordx4 v2, s[4:7], s35 offen sc1 lds
  s_add_u32 m0, s34, 3072
  s_add_u32 s35, s40, s51
  buffer_load_dwordx4 v3, s[4:7], s35 offen sc1 lds
  s_add_u32 s40, s40, 128
  s_lshl_b32 s34, s18, 11
  s_add_u32 s34, s34, 114688
  s_add_u32 m0, s34, 0
  s_nop 0
  buffer_load_dwordx4 v4, s[12:15], s41 offen lds
  s_add_u32 m0, s34, 1024
  s_add_u32 s35, s41, s56
  buffer_load_dwordx4 v4, s[12:15], s35 offen lds
  s_add_u32 s41, s41, s57
  s_waitcnt vmcnt(24)
  s_barrier
  s_mul_i32 s34, s18, 4096
  s_add_u32 s34, s34, 122880
  s_add_u32 m0, s34, 0
  s_add_u32 s35, s40, s48
  buffer_load_dwordx4 v2, s[4:7], s35 offen sc1 lds
  s_add_u32 m0, s34, 1024
  s_add_u32 s35, s40, s49
  buffer_load_dwordx4 v3, s[4:7], s35 offen sc1 lds
  s_add_u32 m0, s34, 2048
  s_add_u32 s35, s40, s50
  buffer_load_dwordx4 v2, s[4:7], s35 offen sc1 lds
  s_add_u32 m0, s34, 3072
  s_add_u32 s35, s40, s51
  buffer_load_dwordx4 v3, s[4:7], s35 offen sc1 lds
  s_add_u32 s40, s40, 128
  s_lshl_b32 s34, s18, 11
  s_add_u32 s34, s34, 139264
  s_add_u32 m0, s34, 0
  s_nop 0
  buffer_load_dwordx4 v4, s[12:15], s41 offen lds
  s_add_u32 m0, s34, 1024
  s_add_u32 s35, s41, s56
  buffer_load_dwordx4 v4, s[12:15], s35 offen lds
  s_add_u32 s41, s41, s57
  ds_read_b128 v[24:27], v5 offset:0
  ds_read_b128 v[28:31], v5 offset:4096
  ds_read_b64_tr_b16 v[40:41], v13 offset:0
  ds_read_b64_tr_b16 v[42:43], v13 offset:512
  ds_read_b128 v[32:35], v6 offset:0
  ds_read_b128 v[36:39], v6 offset:4096
  ds_read_b64_tr_b16 v[44:45], v13 offset:2048
  ds_read_b64_tr_b16 v[46:47], v13 offset:2560
  s_waitcnt lgkmcnt(4)
  v_mfma_f32_32x32x16_bf16 a[0:15], v[40:43], v[24:27], 0
  v_mfma_f32_32x32x16_bf16 a[16:31], v[40:43], v[28:31], 0
  ds_read_b128 v[24:27], v7 offset:0
  ds_read_b128 v[28:31], v7 offset:4096
  ds_read_b64_tr_b16 v[40:41], v13 offset:4096
  ds_read_b64_tr_b16 v[42:43], v13 offset:4608
  s_waitcnt lgkmcnt(4)
  v_mfma_f32_32x32x16_bf16 a[0:15], v[44:47], v[32:35], a[0:15]
  v_mfma_f32_32x32x16_bf16 a[16:31], v[44:47], v[36:39], a[16:31]
  ds_read_b128 v[32:35], v8 offset:0
  ds_read_b128 v[36:39], v8 offset:4096
  ds_read_b64_tr_b16 v[44:45], v13 offset:6144
  ds_read_b64_tr_b16 v[46:47], v13 offset:6656
  s_waitcnt lgkmcnt(4)
  v_mfma_f32_32x32x16_bf16 a[0:15], v[40:43], v[24:27], a[0:15]
  v_mfma_f32_32x32x16_bf16 a[16:31], v[40:43], v[28:31], a[16:31]
  s_waitcnt lgkmcnt(0)
  v_mfma_f32_32x32x16_bf16 a[0:15], v[44:47], v[32:35], a[0:15]
  v_mfma_f32_32x32x16_bf16 a[16:31], v[44:47], v[36:39], a[16:31]
  s_waitcnt vmcnt(24)
  s_barrier
  s_mul_i32 s34, s18, 4096
  s_add_u32 s34, s34, 0
  s_add_u32 m0, s34, 0
  s_add_u32 s35, s40, s48
  buffer_load_dwordx4 v2, s[4:7], s35 offen sc1 lds
  s_add_u32 m0, s34, 1024
  s_add_u32 s35, s40, s49
  buffer_load_dwordx4 v3, s[4:7], s35 offen sc1 lds
  s_add_u32 m0, s34, 2048
  s_add_u32 s35, s40, s50
  buffer_load_dwordx4 v2, s[4:7], s35 offen sc1 lds
  s_add_u32 m0, s34, 3072
  s_add_u32 s35, s40, s51
  buffer_load_dwordx4 v3, s[4:7], s35 offen sc1 lds
  s_add_u32 s40, s40, 128
  s_lshl_b32 s34, s18, 11
  s_add_u32 s34, s34, 16384
  s_add_u32 m0, s34, 0
  s_nop 0
  buffer_load_dwordx4 v4, s[12:15], s41 offen lds
  s_add_u32 m0, s34, 1024
  s_add_u32 s35, s41, s56
  buffer_load_dwordx4 v4, s[12:15], s35 offen lds
  s_add_u32 s41, s41, s57
  ds_read_b128 v[24:27], v5 offset:24576
  ds_read_b128 v[28:31], v5 offset:28672
  ds_read_b64_tr_b16 v[40:41], v13 offset:24576
  ds_read_b64_tr_b16 v[42:43], v13 offset:25088
  ds_read_b128 v[32:35], v6 offset:24576
  ds_read_b128 v[36:39], v6 offset:28672
  ds_read_b64_tr_b16 v[44:45], v13 offset:26624
  ds_read_b64_tr_b16 v[46:47], v13 offset:27136
  s_waitcnt lgkmcnt(4)
  v_mfma_f32_32x32x16_bf16 a[0:15], v[40:43], v[24:27], a[0:15]
  v_mfma_f32_32x32x16_bf16 a[16:31], v[40:43], v[28:31], a[16:31]
  ds_read_b128 v[24:27], v7 offset:24576
  ds_read_b128 v[28:31], v7 offset:28672
  ds_read_b64_tr_b16 v[40:41], v13 offset:28672
  ds_read_b64_tr_b16 v[42:43], v13 offset:29184
  s_waitcnt lgkmcnt(4)
  v_mfma_f32_32x32x16_bf16 a[0:15], v[44:47], v[32:35], a[0:15]
  v_mfma_f32_32x32x16_bf16 a[16:31], v[44:47], v[36:39], a[16:31]
  ds_read_b128 v[32:35], v8 offset:24576
  ds_read_b128 v[36:39], v8 offset:28672
  ds_read_b64_tr_b16 v[44:45], v13 offset:30720
  ds_read_b64_tr_b16 v[46:47], v13 offset:31232
  s_waitcnt lgkmcnt(4)
  v_mfma_f32_32x32x16_bf16 a[0:15], v[40:43], v[24:27], a[0:15]
  v_mfma_f32_32x32x16_bf16 a[16:31], v[40:43], v[28:31], a[16:31]
  s_waitcnt lgkmcnt(0)
  v_mfma_f32_32x32x16_bf16 a[0:15], v[44:47], v[32:35], a[0:15]
  v_mfma_f32_32x32x16_bf16 a[16:31], v[44:47], v[36:39], a[16:31]
  s_waitcnt vmcnt(24)
  s_barrier
  s_mul_i32 s34, s18, 4096
  s_add_u32 s34, s34, 24576
  s_add_u32 m0, s34, 0
  s_add_u32 s35, s40, s48
  buffer_load_dwordx4 v2, s[4:7], s35 offen sc1 lds
  s_add_u32 m0, s34, 1024
  s_add_u32 s35, s40, s49
  buffer_load_dwordx4 v3, s[4:7], s35 offen sc1 lds
  s_add_u32 m0, s34, 2048
  s_add_u32 s35, s40, s50
  buffer_load_dwordx4 v2, s[4:7], s35 offen sc1 lds
  s_add_u32 m0, s34, 3072
  s_add_u32 s35, s40, s51
  buffer_load_dwordx4 v3, s[4:7], s35 offen sc1 lds
  s_add_u32 s40, s40, 128
  s_lshl_b32 s34, s18, 11
  s_add_u32 s34, s34, 40960
  s_add_u32 m0, s34, 0
  s_nop 0
  buffer_load_dwordx4 v4, s[12:15], s41 offen lds
  s_add_u32 m0, s34, 1024
  s_add_u32 s35, s41, s56
  buffer_load_dwordx4 v4, s[12:15], s35 offen lds
  s_add_u32 s41, s41, s57
  ds_read_b128 v[24:27], v5 offset:49152
  ds_read_b128 v[28:31], v5 offset:53248
  ds_read_b64_tr_b16 v[40:41], v13 offset:49152
  ds_read_b64_tr_b16 v[42:43], v13 offset:49664
  ds_read_b128 v[32:35], v6 offset:49152
  ds_read_b128 v[36:39], v6 offset:53248
  ds_read_b64_tr_b16 v[44:45], v13 offset:51200
  ds_read_b64_tr_b16 v[46:47], v13 offset:51712
  s_waitcnt lgkmcnt(4)
  v_mfma_f32_32x32x16_bf16 a[0:15], v[40:43], v[24:27], a[0:15]
  v_mfma_f32_32x32x16_bf16 a[16:31], v[40:43], v[28:31], a[16:31]
  ds_read_b128 v[24:27], v7 offset:49152
  ds_read_b128 v[28:31], v7 offset:53248
  ds_read_b64_tr_b16 v[40:41], v13 offset:53248
  ds_read_b64_tr_b16 v[42:43], v13 offset:53760
  s_waitcnt lgkmcnt(4)
  v_mfma_f32_32x32x16_bf16 a[0:15], v[44:47], v[32:35], a[0:15]
  v_mfma_f32_32x32x16_bf16 a[16:31], v[44:47], v[36:39], a[16:31]
  ds_read_b128 v[32:35], v8 offset:49152
  ds_read_b128 v[36:39], v8 offset:53248
  ds_read_b64_tr_b16 v[44:45], v13 offset:55296
  ds_read_b64_tr_b16 v[46:47], v13 offset:55808
  s_waitcnt lgkmcnt(4)
  v_mfma_f32_32x32x16_bf16 a[0:15], v[40:43], v[24:27], a[0:15]
  v_mfma_f32_32x32x16_bf16 a[16:31], v[40:43], v[28:31], a[16:31]
  s_waitcnt lgkmcnt(0)
  v_mfma_f32_32x32x16_bf16 a[0:15], v[44:47], v[32:35], a[0:15]
  v_mfma_f32_32x32x16_bf16 a[16:31], v[44:47], v[36:39], a[16:31]
  s_waitcnt vmcnt(24)
  s_barrier
  ds_read_b128 v[24:27], v9 offset:0
  ds_read_b128 v[28:31], v9 offset:4096
  ds_read_b64_tr_b16 v[40:41], v15 offset:0
  ds_read_b64_tr_b16 v[42:43], v15 offset:512
  ds_read_b128 v[32:35], v10 offset:0
  ds_read_b128 v[36:39], v10 offset:4096
  ds_read_b64_tr_b16 v[44:45], v15 offset:2048
  ds_read_b64_tr_b16 v[46:47], v15 offset:2560
  s_waitcnt lgkmcnt(4)
  v_mfma_f32_32x32x16_bf16 a[0:15], v[40:43], v[24:27], a[0:15]
  v_mfma_f32_32x32x16_bf16 a[16:31], v[40:43], v[28:31], a[16:31]
  ds_read_b128 v[24:27], v11 offset:0
  ds_read_b128 v[28:31], v11 offset:4096
  ds_read_b64_tr_b16 v[40:41], v15 offset:4096
  ds_read_b64_tr_b16 v[42:43], v15 offset:4608
  s_waitcnt lgkmcnt(4)
  v_mfma_f32_32x32x16_bf16 a[0:15], v[44:47], v[32:35], a[0:15]
  v_mfma_f32_32x32x16_bf16 a[16:31], v[44:47], v[36:39], a[16:31]
  ds_read_b128 v[32:35], v12 offset:0
  ds_read_b128 v[36:39], v12 offset:4096
  ds_read_b64_tr_b16 v[44:45], v15 offset:6144
  ds_read_b64_tr_b16 v[46:47], v15 offset:6656
  s_waitcnt lgkmcnt(4)
  v_mfma_f32_32x32x16_bf16 a[0:15], v[40:43], v[24:27], a[0:15]
  v_mfma_f32_32x32x16_bf16 a[16:31], v[40:43], v[28:31], a[16:31]
  s_waitcnt lgkmcnt(0)
  v_mfma_f32_32x32x16_bf16 a[0:15], v[44:47], v[32:35], a[0:15]
  v_mfma_f32_32x32x16_bf16 a[16:31], v[44:47], v[36:39], a[16:31]
  s_waitcnt vmcnt(18)
  s_barrier
  ds_read_b128 v[24:27], v9 offset:24576
  ds_read_b128 v[28:31], v9 offset:28672
  ds_read_b64_tr_b16 v[40:41], v15 offset:24576
  ds_read_b64_tr_b16 v[42:43], v15 offset:25088
  ds_read_b128 v[32:35], v10 offset:24576
  ds_read_b128 v[36:39], v10 offset:28672
  ds_read_b64_tr_b16 v[44:45], v15 offset:26624
  ds_read_b64_tr_b16 v[46:47], v15 offset:27136
  s_waitcnt lgkmcnt(4)
  v_mfma_f32_32x32x16_bf16 a[0:15], v[40:43], v[24:27], a[0:15]
  v_mfma_f32_32x32x16_bf16 a[16:31], v[40:43], v[28:31], a[16:31]
  ds_read_b128 v[24:27], v11 offset:24576
  ds_read_b128 v[28:31], v11 offset:28672
  ds_read_b64_tr_b16 v[40:41], v15 offset:28672
  ds_read_b64_tr_b16 v[42:43], v15 offset:29184
  s_waitcnt lgkmcnt(4)
  v_mfma_f32_32x32x16_bf16 a[0:15], v[44:47], v[32:35], a[0:15]
  v_mfma_f32_32x32x16_bf16 a[16:31], v[44:47], v[36:39], a[16:31]
  ds_read_b128 v[32:35], v12 offset:24576
  ds_read_b128 v[36:39], v12 offset:28672
  ds_read_b64_tr_b16 v[44:45], v15 offset:30720
  ds_read_b64_tr_b16 v[46:47], v15 offset:31232
  s_waitcnt lgkmcnt(4)
  v_mfma_f32_32x32x16_bf16 a[0:15], v[40:43], v[24:27], a[0:15]
  v_mfma_f32_32x32x16_bf16 a[16:31], v[40:43], v[28:31], a[16:31]
  s_waitcnt lgkmcnt(0)
  v_mfma_f32_32x32x16_bf16 a[0:15], v[44:47], v[32:35], a[0:15]
  v_mfma_f32_32x32x16_bf16 a[16:31], v[44:47], v[36:39], a[16:31]
  s_waitcnt vmcnt(12)
  s_barrier
  ds_read_b128 v[24:27], v9 offset:49152
  ds_read_b128 v[28:31], v9 offset:53248
  ds_read_b64_tr_b16 v[40:41], v15 offset:49152
  ds_read_b64_tr_b16 v[42:43], v15 offset:49664
  ds_read_b128 v[32:35], v10 offset:49152
  ds_read_b128 v[36:39], v10 offset:53248
  ds_read_b64_tr_b16 v[44:45], v15 offset:51200
  ds_read_b64_tr_b16 v[46:47], v15 offset:51712
  s_waitcnt lgkmcnt(4)
  v_mfma_f32_32x32x16_bf16 a[0:15], v[40:43], v[24:27], a[0:15]
  v_mfma_f32_32x32x16_bf16 a[16:31], v[40:43], v[28:31], a[16:31]
  ds_read_b128 v[24:27], v11 offset:49152
  ds_read_b128 v[28:31], v11 offset:53248
  ds_read_b64_tr_b16 v[40:41], v15 offset:53248
  ds_read_b64_tr_b16 v[42:43], v15 offset:53760
  s_waitcnt lgkmcnt(4)
  v_mfma_f32_32x32x16_bf16 a[0:15], v[44:47], v[32:35], a[0:15]
  v_mfma_f32_32x32x16_bf16 a[16:31], v[44:47], v[36:39], a[16:31]
  ds_read_b128 v[32:35], v12 offset:49152
  ds_read_b128 v[36:39], v12 offset:53248
  ds_read_b64_tr_b16 v[44:45], v15 offset:55296
  ds_read_b64_tr_b16 v[46:47], v15 offset:55808
  s_waitcnt lgkmcnt(4)
  v_mfma_f32_32x32x16_bf16 a[0:15], v[40:43], v[24:27], a[0:15]
  v_mfma_f32_32x32x16_bf16 a[16:31], v[40:43], v[28:31], a[16:31]
  s_waitcnt lgkmcnt(0)
  v_mfma_f32_32x32x16_bf16 a[0:15], v[44:47], v[32:35], a[0:15]
  v_mfma_f32_32x32x16_bf16 a[16:31], v[44:47], v[36:39], a[16:31]
  s_waitcnt vmcnt(6)
  s_barrier
  ds_read_b128 v[24:27], v5 offset:0
  ds_read_b128 v[28:31], v5 offset:4096
  ds_read_b64_tr_b16 v[40:41], v13 offset:0
  ds_read_b64_tr_b16 v[42:43], v13 offset:512
  ds_read_b128 v[32:35], v6 offset:0
  ds_read_b128 v[36:39], v6 offset:4096
  ds_read_b64_tr_b16 v[44:45], v13 offset:2048
  ds_read_b64_tr_b16 v[46:47], v13 offset:2560
  s_waitcnt lgkmcnt(4)
  v_mfma_f32_32x32x16_bf16 a[0:15], v[40:43], v[24:27], a[0:15]
  v_mfma_f32_32x32x16_bf16 a[16:31], v[40:43], v[28:31], a[16:31]
  ds_read_b128 v[24:27], v7 offset:0
  ds_read_b128 v[28:31], v7 offset:4096
  ds_read_b64_tr_b16 v[40:41], v13 offset:4096
  ds_read_b64_tr_b16 v[42:43], v13 offset:4608
  s_waitcnt lgkmcnt(4)
  v_mfma_f32_32x32x16_bf16 a[0:15], v[44:47], v[32:35], a[0:15]
  v_mfma_f32_32x32x16_bf16 a[16:31], v[44:47], v[36:39], a[16:31]
  ds_read_b128 v[32:35], v8 offset:0
  ds_read_b128 v[36:39], v8 offset:4096
  ds_read_b64_tr_b16 v[44:45], v13 offset:6144
  ds_read_b64_tr_b16 v[46:47], v13 offset:6656
  s_waitcnt lgkmcnt(4)
  v_mfma_f32_32x32x16_bf16 a[0:15], v[40:43], v[24:27], a[0:15]
  v_mfma_f32_32x32x16_bf16 a[16:31], v[40:43], v[28:31], a[16:31]
  s_waitcnt lgkmcnt(0)
  v_mfma_f32_32x32x16_bf16 a[0:15], v[44:47], v[32:35], a[0:15]
  v_mfma_f32_32x32x16_bf16 a[16:31], v[44:47], v[36:39], a[16:31]
  s_waitcnt vmcnt(0)
  s_barrier
  ds_read_b128 v[24:27], v5 offset:24576
  ds_read_b128 v[28:31], v5 offset:28672
  ds_read_b64_tr_b16 v[40:41], v13 offset:24576
  ds_read_b64_tr_b16 v[42:43], v13 offset:25088
  ds_read_b128 v[32:35], v6 offset:24576
  ds_read_b128 v[36:39], v6 offset:28672
  ds_read_b64_tr_b16 v[44:45], v13 offset:26624
  ds_read_b64_tr_b16 v[46:47], v13 offset:27136
  s_waitcnt lgkmcnt(4)
  v_mfma_f32_32x32x16_bf16 a[0:15], v[40:43], v[24:27], a[0:15]
  v_mfma_f32_32x32x16_bf16 a[16:31], v[40:43], v[28:31], a[16:31]
  ds_read_b128 v[24:27], v7 offset:24576
  ds_read_b128 v[28:31], v7 offset:28672
  ds_read_b64_tr_b16 v[40:41], v13 offset:28672
  ds_read_b64_tr_b16 v[42:43], v13 offset:29184
  s_waitcnt lgkmcnt(4)
  v_mfma_f32_32x32x16_bf16 a[0:15], v[44:47], v[32:35], a[0:15]
  v_mfma_f32_32x32x16_bf16 a[16:31], v[44:47], v[36:39], a[16:31]
  ds_read_b128 v[32:35], v8 offset:24576
  ds_read_b128 v[36:39], v8 offset:28672
  ds_read_b64_tr_b16 v[44:45], v13 offset:30720
  ds_read_b64_tr_b16 v[46:47], v13 offset:31232
  s_waitcnt lgkmcnt(4)
  v_mfma_f32_32x32x16_bf16 a[0:15], v[40:43], v[24:27], a[0:15]
  v_mfma_f32_32x32x16_bf16 a[16:31], v[40:43], v[28:31], a[16:31]
  s_waitcnt lgkmcnt(0)
  v_mfma_f32_32x32x16_bf16 a[0:15], v[44:47], v[32:35], a[0:15]
  v_mfma_f32_32x32x16_bf16 a[16:31], v[44:47], v[36:39], a[16:31]
  s_nop 15
  s_barrier
  s_mul_i32 s34, s26, 2097152
  s_lshl_b32 s35, s25, 18
  s_add_u32 s34, s34, s35
  s_lshl_b32 s35, s36, 17
  s_add_u32 s34, s34, s35
  s_lshl_b32 s35, s27, 8
  s_add_u32 s34, s34, s35
  s_lshl_b32 s35, s37, 7
  s_add_u32 s34, s34, s35
  s_add_u32 s34, s34, 134217728
  s_mul_i32 s35, s18, 9216
  v_and_b32 v2, 31, v1
  v_mul_u32_u24 v2, 144, v2
  v_lshrrev_b32 v3, 5, v1
  v_lshl_add_u32 v2, v3, 4, v2
  v_add_u32 v2, s35, v2
  v_lshrrev_b32 v3, 3, v1
  v_and_b32 v4, 7, v1
  v_mul_u32_u24 v5, 144, v3
  v_lshl_add_u32 v5, v4, 4, v5
  v_add_u32 v5, s35, v5
  v_lshlrev_b32 v6, 11, v3
  v_lshl_add_u32 v6, v4, 4, v6
  v_add_u32 v6, s34, v6

  ds_write_b128 v2, a[0:3] offset:0
  ds_write_b128 v2, a[4:7] offset:32
  ds_write_b128 v2, a[8:11] offset:64
  ds_write_b128 v2, a[12:15] offset:96
  ds_write_b128 v2, a[16:19] offset:4608
  ds_write_b128 v2, a[20:23] offset:4640
  ds_write_b128 v2, a[24:27] offset:4672
  ds_write_b128 v2, a[28:31] offset:4704
  s_waitcnt lgkmcnt(0)
  ds_read_b128 v[8:11], v5 offset:0
  ds_read_b128 v[12:15], v5 offset:1152
  ds_read_b128 v[16:19], v5 offset:2304
  ds_read_b128 v[20:23], v5 offset:3456
  ds_read_b128 v[24:27], v5 offset:4608
  ds_read_b128 v[28:31], v5 offset:5760
  ds_read_b128 v[32:35], v5 offset:6912
  ds_read_b128 v[36:39], v5 offset:8064
  s_waitcnt lgkmcnt(7)
  s_mov_b32 s35, 0
  buffer_store_dwordx4 v[8:11], v6, s[4:7], s35 offen sc1
  s_waitcnt lgkmcnt(6)
  s_mov_b32 s35, 16384
  buffer_store_dwordx4 v[12:15], v6, s[4:7], s35 offen sc1
  s_waitcnt lgkmcnt(5)
  s_mov_b32 s35, 32768
  buffer_store_dwordx4 v[16:19], v6, s[4:7], s35 offen sc1
  s_waitcnt lgkmcnt(4)
  s_mov_b32 s35, 49152
  buffer_store_dwordx4 v[20:23], v6, s[4:7], s35 offen sc1
  s_waitcnt lgkmcnt(3)
  s_mov_b32 s35, 65536
  buffer_store_dwordx4 v[24:27], v6, s[4:7], s35 offen sc1
  s_waitcnt lgkmcnt(2)
  s_mov_b32 s35, 81920
  buffer_store_dwordx4 v[28:31], v6, s[4:7], s35 offen sc1
  s_waitcnt lgkmcnt(1)
  s_mov_b32 s35, 98304
  buffer_store_dwordx4 v[32:35], v6, s[4:7], s35 offen sc1
  s_waitcnt lgkmcnt(0)
  s_mov_b32 s35, 114688
  buffer_store_dwordx4 v[36:39], v6, s[4:7], s35 offen sc1
  s_waitcnt vmcnt(0)
  s_barrier
  s_cmp_lg_u32 s18, 0
  s_cbranch_scc1 L_sig_52
  s_lshl_b32 s60, s26, 8
  s_lshl_b32 s61, s23, 2
  s_add_u32 s60, s60, s61
  s_add_u32 s60, s60, 98701312
  v_mov_b32 v2, s60
  v_mov_b32 v3, s69
  s_mov_b64 exec, 1
  buffer_store_dword v3, v2, s[4:7], 0 offen sc1
  s_mov_b64 exec, -1

L_sig_52:
  s_branch L_worker
L_task_ln:
  s_mov_b32 s23, s27
  s_cmp_lg_u32 s18, 0
  s_cbranch_scc1 L_wo_54
  s_lshl_b32 s60, s26, 8
  s_add_u32 s60, s60, 98701312
  v_lshlrev_b32 v2, 2, v1
  v_add_u32 v2, s60, v2
  s_mov_b32 s62, 0

L_wt_53:
  buffer_load_dword v3, v2, s[4:7], 0 offen sc1
  s_waitcnt vmcnt(0)
  v_cmp_ne_u32 vcc, s69, v3
  s_cbranch_vccz L_wo_54
  s_sleep 1
  s_add_u32 s62, s62, 1
  s_cmp_lt_u32 s62, 0x100000
  s_cbranch_scc1 L_wt_53

L_wo_54:
  s_mov_b64 exec, -1
  s_barrier
  s_mov_b32 s8, s78
  s_mov_b32 s9, s79
  s_mov_b32 s10, 2097152
  s_mov_b32 s11, 0x00020000
  s_lshl_b32 s34, s27, 3
  s_lshl_b32 s35, s18, 1
  s_add_u32 s34, s34, s35
  s_lshl_b32 s35, s26, 7
  s_add_u32 s35, s35, s34
  s_lshl_b32 s35, s35, 10
  v_lshlrev_b32 v2, 4, v1
  v_add_u32 v2, s35, v2
  v_add_u32 v3, 79691776, v2
  v_add_u32 v4, 81788928, v2
  s_lshl_b32 s35, s26, 21
  s_lshl_b32 s34, s34, 11
  s_add_u32 s34, s34, s35
  s_add_u32 s34, s34, 134217728
  v_lshlrev_b32 v5, 5, v1
  v_add_u32 v5, s34, v5

  s_mov_b32 s34, 0
  buffer_load_dwordx4 v[40:43], v5, s[4:7], s34 offen offset:0 sc1
  buffer_load_dwordx4 v[44:47], v5, s[4:7], s34 offen offset:16 sc1
  s_mov_b32 s34, 262144
  buffer_load_dwordx4 v[48:51], v5, s[4:7], s34 offen offset:0 sc1
  buffer_load_dwordx4 v[52:55], v5, s[4:7], s34 offen offset:16 sc1
  s_mov_b32 s34, 524288
  buffer_load_dwordx4 v[56:59], v5, s[4:7], s34 offen offset:0 sc1
  buffer_load_dwordx4 v[60:63], v5, s[4:7], s34 offen offset:16 sc1
  s_mov_b32 s34, 786432
  buffer_load_dwordx4 v[64:67], v5, s[4:7], s34 offen offset:0 sc1
  buffer_load_dwordx4 v[68:71], v5, s[4:7], s34 offen offset:16 sc1
  s_mov_b32 s34, 1048576
  buffer_load_dwordx4 v[72:75], v5, s[4:7], s34 offen offset:0 sc1
  buffer_load_dwordx4 v[76:79], v5, s[4:7], s34 offen offset:16 sc1
  s_mov_b32 s34, 1310720
  buffer_load_dwordx4 v[80:83], v5, s[4:7], s34 offen offset:0 sc1
  buffer_load_dwordx4 v[84:87], v5, s[4:7], s34 offen offset:16 sc1
  s_mov_b32 s34, 1572864
  buffer_load_dwordx4 v[88:91], v5, s[4:7], s34 offen offset:0 sc1
  buffer_load_dwordx4 v[92:95], v5, s[4:7], s34 offen offset:16 sc1
  s_mov_b32 s34, 1835008
  buffer_load_dwordx4 v[96:99], v5, s[4:7], s34 offen offset:0 sc1
  buffer_load_dwordx4 v[100:103], v5, s[4:7], s34 offen offset:16 sc1
  buffer_load_dwordx4 v[104:107], v2, s[8:11], 0 offen offset:0
  s_mov_b32 s34, 0
  buffer_load_dwordx4 v[108:111], v5, s[4:7], s34 offen offset:2048 sc1
  buffer_load_dwordx4 v[112:115], v5, s[4:7], s34 offen offset:2064 sc1
  s_mov_b32 s34, 262144
  buffer_load_dwordx4 v[116:119], v5, s[4:7], s34 offen offset:2048 sc1
  buffer_load_dwordx4 v[120:123], v5, s[4:7], s34 offen offset:2064 sc1
  s_mov_b32 s34, 524288
  buffer_load_dwordx4 v[124:127], v5, s[4:7], s34 offen offset:2048 sc1
  buffer_load_dwordx4 v[128:131], v5, s[4:7], s34 offen offset:2064 sc1
  s_mov_b32 s34, 786432
  buffer_load_dwordx4 v[132:135], v5, s[4:7], s34 offen offset:2048 sc1
  buffer_load_dwordx4 v[136:139], v5, s[4:7], s34 offen offset:2064 sc1
  s_mov_b32 s34, 1048576
  buffer_load_dwordx4 v[140:143], v5, s[4:7], s34 offen offset:2048 sc1
  buffer_load_dwordx4 v[144:147], v5, s[4:7], s34 offen offset:2064 sc1
  s_mov_b32 s34, 1310720
  buffer_load_dwordx4 v[148:151], v5, s[4:7], s34 offen offset:2048 sc1
  buffer_load_dwordx4 v[152:155], v5, s[4:7], s34 offen offset:2064 sc1
  s_mov_b32 s34, 1572864
  buffer_load_dwordx4 v[156:159], v5, s[4:7], s34 offen offset:2048 sc1
  buffer_load_dwordx4 v[160:163], v5, s[4:7], s34 offen offset:2064 sc1
  s_mov_b32 s34, 1835008
  buffer_load_dwordx4 v[164:167], v5, s[4:7], s34 offen offset:2048 sc1
  buffer_load_dwordx4 v[168:171], v5, s[4:7], s34 offen offset:2064 sc1
  buffer_load_dwordx4 v[172:175], v2, s[8:11], 0 offen offset:1024
  s_waitcnt vmcnt(17)
  v_pk_add_f32 v[40:41], v[40:41], v[48:49]
  v_pk_add_f32 v[42:43], v[42:43], v[50:51]
  v_pk_add_f32 v[44:45], v[44:45], v[52:53]
  v_pk_add_f32 v[46:47], v[46:47], v[54:55]
  v_pk_add_f32 v[40:41], v[40:41], v[56:57]
  v_pk_add_f32 v[42:43], v[42:43], v[58:59]
  v_pk_add_f32 v[44:45], v[44:45], v[60:61]
  v_pk_add_f32 v[46:47], v[46:47], v[62:63]
  v_pk_add_f32 v[40:41], v[40:41], v[64:65]
  v_pk_add_f32 v[42:43], v[42:43], v[66:67]
  v_pk_add_f32 v[44:45], v[44:45], v[68:69]
  v_pk_add_f32 v[46:47], v[46:47], v[70:71]
  v_pk_add_f32 v[40:41], v[40:41], v[72:73]
  v_pk_add_f32 v[42:43], v[42:43], v[74:75]
  v_pk_add_f32 v[44:45], v[44:45], v[76:77]
  v_pk_add_f32 v[46:47], v[46:47], v[78:79]
  v_pk_add_f32 v[40:41], v[40:41], v[80:81]
  v_pk_add_f32 v[42:43], v[42:43], v[82:83]
  v_pk_add_f32 v[44:45], v[44:45], v[84:85]
  v_pk_add_f32 v[46:47], v[46:47], v[86:87]
  v_pk_add_f32 v[40:41], v[40:41], v[88:89]
  v_pk_add_f32 v[42:43], v[42:43], v[90:91]
  v_pk_add_f32 v[44:45], v[44:45], v[92:93]
  v_pk_add_f32 v[46:47], v[46:47], v[94:95]
  v_pk_add_f32 v[40:41], v[40:41], v[96:97]
  v_pk_add_f32 v[42:43], v[42:43], v[98:99]
  v_pk_add_f32 v[44:45], v[44:45], v[100:101]
  v_pk_add_f32 v[46:47], v[46:47], v[102:103]
  v_cvt_pk_bf16_f32 v40, v40, v40
  v_lshlrev_b32 v40, 16, v40
  v_cvt_pk_bf16_f32 v41, v41, v41
  v_lshlrev_b32 v41, 16, v41
  v_cvt_pk_bf16_f32 v42, v42, v42
  v_lshlrev_b32 v42, 16, v42
  v_cvt_pk_bf16_f32 v43, v43, v43
  v_lshlrev_b32 v43, 16, v43
  v_cvt_pk_bf16_f32 v44, v44, v44
  v_lshlrev_b32 v44, 16, v44
  v_cvt_pk_bf16_f32 v45, v45, v45
  v_lshlrev_b32 v45, 16, v45
  v_cvt_pk_bf16_f32 v46, v46, v46
  v_lshlrev_b32 v46, 16, v46
  v_cvt_pk_bf16_f32 v47, v47, v47
  v_lshlrev_b32 v47, 16, v47
  v_lshlrev_b32 v8, 16, v104
  v_and_b32 v9, 0xffff0000, v104
  v_add_f32 v8, v8, v40
  v_add_f32 v9, v9, v41
  v_cvt_pk_bf16_f32 v104, v8, v9
  v_lshlrev_b32 v8, 16, v104
  v_and_b32 v9, 0xffff0000, v104
  v_lshlrev_b32 v10, 16, v105
  v_and_b32 v11, 0xffff0000, v105
  v_add_f32 v10, v10, v42
  v_add_f32 v11, v11, v43
  v_cvt_pk_bf16_f32 v105, v10, v11
  v_lshlrev_b32 v10, 16, v105
  v_and_b32 v11, 0xffff0000, v105
  v_lshlrev_b32 v12, 16, v106
  v_and_b32 v13, 0xffff0000, v106
  v_add_f32 v12, v12, v44
  v_add_f32 v13, v13, v45
  v_cvt_pk_bf16_f32 v106, v12, v13
  v_lshlrev_b32 v12, 16, v106
  v_and_b32 v13, 0xffff0000, v106
  v_lshlrev_b32 v14, 16, v107
  v_and_b32 v15, 0xffff0000, v107
  v_add_f32 v14, v14, v46
  v_add_f32 v15, v15, v47
  v_cvt_pk_bf16_f32 v107, v14, v15
  v_lshlrev_b32 v14, 16, v107
  v_and_b32 v15, 0xffff0000, v107
  buffer_store_dwordx4 v[104:107], v3, s[4:7], 0 offen offset:0 sc1
  v_add_f32 v16, v8, v9
  v_add_f32 v16, v16, v10
  v_add_f32 v16, v16, v11
  v_add_f32 v16, v16, v12
  v_add_f32 v16, v16, v13
  v_add_f32 v16, v16, v14
  v_add_f32 v16, v16, v15
  s_nop 1
  v_add_f32_dpp v16, v16, v16 row_ror:1 row_mask:0xf bank_mask:0xf
  s_nop 1
  v_add_f32_dpp v16, v16, v16 row_ror:2 row_mask:0xf bank_mask:0xf
  s_nop 1
  v_add_f32_dpp v16, v16, v16 row_ror:4 row_mask:0xf bank_mask:0xf
  s_nop 1
  v_add_f32_dpp v16, v16, v16 row_ror:8 row_mask:0xf bank_mask:0xf
  s_nop 1
  v_mov_b32 v18, v16
  s_nop 1
  v_permlane16_swap_b32 v16, v18
  v_add_f32 v16, v16, v18
  v_mov_b32 v18, v16
  s_nop 1
  v_permlane32_swap_b32 v16, v18
  v_add_f32 v16, v16, v18
  v_mul_f32 v16, 0x3b000000, v16
  v_sub_f32 v18, v8, v16
  v_mul_f32 v17, v18, v18
  v_sub_f32 v18, v9, v16
  v_fmac_f32 v17, v18, v18
  v_sub_f32 v18, v10, v16
  v_fmac_f32 v17, v18, v18
  v_sub_f32 v18, v11, v16
  v_fmac_f32 v17, v18, v18
  v_sub_f32 v18, v12, v16
  v_fmac_f32 v17, v18, v18
  v_sub_f32 v18, v13, v16
  v_fmac_f32 v17, v18, v18
  v_sub_f32 v18, v14, v16
  v_fmac_f32 v17, v18, v18
  v_sub_f32 v18, v15, v16
  v_fmac_f32 v17, v18, v18
  s_nop 1
  v_add_f32_dpp v17, v17, v17 row_ror:1 row_mask:0xf bank_mask:0xf
  s_nop 1
  v_add_f32_dpp v17, v17, v17 row_ror:2 row_mask:0xf bank_mask:0xf
  s_nop 1
  v_add_f32_dpp v17, v17, v17 row_ror:4 row_mask:0xf bank_mask:0xf
  s_nop 1
  v_add_f32_dpp v17, v17, v17 row_ror:8 row_mask:0xf bank_mask:0xf
  s_nop 1
  v_mov_b32 v18, v17
  s_nop 1
  v_permlane16_swap_b32 v17, v18
  v_add_f32 v17, v17, v18
  v_mov_b32 v18, v17
  s_nop 1
  v_permlane32_swap_b32 v17, v18
  v_add_f32 v17, v17, v18
  v_mul_f32 v17, 0x3b000000, v17
  v_cvt_pk_bf16_f32 v17, v17, v17
  v_lshlrev_b32 v17, 16, v17
  v_cvt_pk_bf16_f32 v16, v16, v16
  v_lshlrev_b32 v16, 16, v16
  v_add_f32 v17, 0x3727c5ac, v17
  v_cvt_pk_bf16_f32 v17, v17, v17
  v_lshlrev_b32 v17, 16, v17
  v_sqrt_f32 v17, v17
  s_nop 0
  v_cvt_pk_bf16_f32 v17, v17, v17
  v_lshlrev_b32 v17, 16, v17
  v_rcp_f32 v18, v17
  s_nop 0
  v_fma_f32 v20, -v17, v18, 2.0
  v_mul_f32 v18, v18, v20
  v_sub_f32 v8, v8, v16
  v_cvt_pk_bf16_f32 v8, v8, v8
  v_lshlrev_b32 v8, 16, v8
  v_mul_f32 v20, v8, v18
  v_fma_f32 v21, -v20, v17, v8
  v_fma_f32 v8, v21, v18, v20
  v_sub_f32 v9, v9, v16
  v_cvt_pk_bf16_f32 v9, v9, v9
  v_lshlrev_b32 v9, 16, v9
  v_mul_f32 v20, v9, v18
  v_fma_f32 v21, -v20, v17, v9
  v_fma_f32 v9, v21, v18, v20
  v_sub_f32 v10, v10, v16
  v_cvt_pk_bf16_f32 v10, v10, v10
  v_lshlrev_b32 v10, 16, v10
  v_mul_f32 v20, v10, v18
  v_fma_f32 v21, -v20, v17, v10
  v_fma_f32 v10, v21, v18, v20
  v_sub_f32 v11, v11, v16
  v_cvt_pk_bf16_f32 v11, v11, v11
  v_lshlrev_b32 v11, 16, v11
  v_mul_f32 v20, v11, v18
  v_fma_f32 v21, -v20, v17, v11
  v_fma_f32 v11, v21, v18, v20
  v_sub_f32 v12, v12, v16
  v_cvt_pk_bf16_f32 v12, v12, v12
  v_lshlrev_b32 v12, 16, v12
  v_mul_f32 v20, v12, v18
  v_fma_f32 v21, -v20, v17, v12
  v_fma_f32 v12, v21, v18, v20
  v_sub_f32 v13, v13, v16
  v_cvt_pk_bf16_f32 v13, v13, v13
  v_lshlrev_b32 v13, 16, v13
  v_mul_f32 v20, v13, v18
  v_fma_f32 v21, -v20, v17, v13
  v_fma_f32 v13, v21, v18, v20
  v_sub_f32 v14, v14, v16
  v_cvt_pk_bf16_f32 v14, v14, v14
  v_lshlrev_b32 v14, 16, v14
  v_mul_f32 v20, v14, v18
  v_fma_f32 v21, -v20, v17, v14
  v_fma_f32 v14, v21, v18, v20
  v_sub_f32 v15, v15, v16
  v_cvt_pk_bf16_f32 v15, v15, v15
  v_lshlrev_b32 v15, 16, v15
  v_mul_f32 v20, v15, v18
  v_fma_f32 v21, -v20, v17, v15
  v_fma_f32 v15, v21, v18, v20
  v_cvt_pk_bf16_f32 v40, v8, v9
  v_cvt_pk_bf16_f32 v41, v10, v11
  v_cvt_pk_bf16_f32 v42, v12, v13
  v_cvt_pk_bf16_f32 v43, v14, v15
  buffer_store_dwordx4 v[40:43], v4, s[4:7], 0 offen offset:0 sc1
  s_waitcnt vmcnt(2)
  v_pk_add_f32 v[108:109], v[108:109], v[116:117]
  v_pk_add_f32 v[110:111], v[110:111], v[118:119]
  v_pk_add_f32 v[112:113], v[112:113], v[120:121]
  v_pk_add_f32 v[114:115], v[114:115], v[122:123]
  v_pk_add_f32 v[108:109], v[108:109], v[124:125]
  v_pk_add_f32 v[110:111], v[110:111], v[126:127]
  v_pk_add_f32 v[112:113], v[112:113], v[128:129]
  v_pk_add_f32 v[114:115], v[114:115], v[130:131]
  v_pk_add_f32 v[108:109], v[108:109], v[132:133]
  v_pk_add_f32 v[110:111], v[110:111], v[134:135]
  v_pk_add_f32 v[112:113], v[112:113], v[136:137]
  v_pk_add_f32 v[114:115], v[114:115], v[138:139]
  v_pk_add_f32 v[108:109], v[108:109], v[140:141]
  v_pk_add_f32 v[110:111], v[110:111], v[142:143]
  v_pk_add_f32 v[112:113], v[112:113], v[144:145]
  v_pk_add_f32 v[114:115], v[114:115], v[146:147]
  v_pk_add_f32 v[108:109], v[108:109], v[148:149]
  v_pk_add_f32 v[110:111], v[110:111], v[150:151]
  v_pk_add_f32 v[112:113], v[112:113], v[152:153]
  v_pk_add_f32 v[114:115], v[114:115], v[154:155]
  v_pk_add_f32 v[108:109], v[108:109], v[156:157]
  v_pk_add_f32 v[110:111], v[110:111], v[158:159]
  v_pk_add_f32 v[112:113], v[112:113], v[160:161]
  v_pk_add_f32 v[114:115], v[114:115], v[162:163]
  v_pk_add_f32 v[108:109], v[108:109], v[164:165]
  v_pk_add_f32 v[110:111], v[110:111], v[166:167]
  v_pk_add_f32 v[112:113], v[112:113], v[168:169]
  v_pk_add_f32 v[114:115], v[114:115], v[170:171]
  v_cvt_pk_bf16_f32 v108, v108, v108
  v_lshlrev_b32 v108, 16, v108
  v_cvt_pk_bf16_f32 v109, v109, v109
  v_lshlrev_b32 v109, 16, v109
  v_cvt_pk_bf16_f32 v110, v110, v110
  v_lshlrev_b32 v110, 16, v110
  v_cvt_pk_bf16_f32 v111, v111, v111
  v_lshlrev_b32 v111, 16, v111
  v_cvt_pk_bf16_f32 v112, v112, v112
  v_lshlrev_b32 v112, 16, v112
  v_cvt_pk_bf16_f32 v113, v113, v113
  v_lshlrev_b32 v113, 16, v113
  v_cvt_pk_bf16_f32 v114, v114, v114
  v_lshlrev_b32 v114, 16, v114
  v_cvt_pk_bf16_f32 v115, v115, v115
  v_lshlrev_b32 v115, 16, v115
  v_lshlrev_b32 v8, 16, v172
  v_and_b32 v9, 0xffff0000, v172
  v_add_f32 v8, v8, v108
  v_add_f32 v9, v9, v109
  v_cvt_pk_bf16_f32 v172, v8, v9
  v_lshlrev_b32 v8, 16, v172
  v_and_b32 v9, 0xffff0000, v172
  v_lshlrev_b32 v10, 16, v173
  v_and_b32 v11, 0xffff0000, v173
  v_add_f32 v10, v10, v110
  v_add_f32 v11, v11, v111
  v_cvt_pk_bf16_f32 v173, v10, v11
  v_lshlrev_b32 v10, 16, v173
  v_and_b32 v11, 0xffff0000, v173
  v_lshlrev_b32 v12, 16, v174
  v_and_b32 v13, 0xffff0000, v174
  v_add_f32 v12, v12, v112
  v_add_f32 v13, v13, v113
  v_cvt_pk_bf16_f32 v174, v12, v13
  v_lshlrev_b32 v12, 16, v174
  v_and_b32 v13, 0xffff0000, v174
  v_lshlrev_b32 v14, 16, v175
  v_and_b32 v15, 0xffff0000, v175
  v_add_f32 v14, v14, v114
  v_add_f32 v15, v15, v115
  v_cvt_pk_bf16_f32 v175, v14, v15
  v_lshlrev_b32 v14, 16, v175
  v_and_b32 v15, 0xffff0000, v175
  buffer_store_dwordx4 v[172:175], v3, s[4:7], 0 offen offset:1024 sc1
  v_add_f32 v16, v8, v9
  v_add_f32 v16, v16, v10
  v_add_f32 v16, v16, v11
  v_add_f32 v16, v16, v12
  v_add_f32 v16, v16, v13
  v_add_f32 v16, v16, v14
  v_add_f32 v16, v16, v15
  s_nop 1
  v_add_f32_dpp v16, v16, v16 row_ror:1 row_mask:0xf bank_mask:0xf
  s_nop 1
  v_add_f32_dpp v16, v16, v16 row_ror:2 row_mask:0xf bank_mask:0xf
  s_nop 1
  v_add_f32_dpp v16, v16, v16 row_ror:4 row_mask:0xf bank_mask:0xf
  s_nop 1
  v_add_f32_dpp v16, v16, v16 row_ror:8 row_mask:0xf bank_mask:0xf
  s_nop 1
  v_mov_b32 v18, v16
  s_nop 1
  v_permlane16_swap_b32 v16, v18
  v_add_f32 v16, v16, v18
  v_mov_b32 v18, v16
  s_nop 1
  v_permlane32_swap_b32 v16, v18
  v_add_f32 v16, v16, v18
  v_mul_f32 v16, 0x3b000000, v16
  v_sub_f32 v18, v8, v16
  v_mul_f32 v17, v18, v18
  v_sub_f32 v18, v9, v16
  v_fmac_f32 v17, v18, v18
  v_sub_f32 v18, v10, v16
  v_fmac_f32 v17, v18, v18
  v_sub_f32 v18, v11, v16
  v_fmac_f32 v17, v18, v18
  v_sub_f32 v18, v12, v16
  v_fmac_f32 v17, v18, v18
  v_sub_f32 v18, v13, v16
  v_fmac_f32 v17, v18, v18
  v_sub_f32 v18, v14, v16
  v_fmac_f32 v17, v18, v18
  v_sub_f32 v18, v15, v16
  v_fmac_f32 v17, v18, v18
  s_nop 1
  v_add_f32_dpp v17, v17, v17 row_ror:1 row_mask:0xf bank_mask:0xf
  s_nop 1
  v_add_f32_dpp v17, v17, v17 row_ror:2 row_mask:0xf bank_mask:0xf
  s_nop 1
  v_add_f32_dpp v17, v17, v17 row_ror:4 row_mask:0xf bank_mask:0xf
  s_nop 1
  v_add_f32_dpp v17, v17, v17 row_ror:8 row_mask:0xf bank_mask:0xf
  s_nop 1
  v_mov_b32 v18, v17
  s_nop 1
  v_permlane16_swap_b32 v17, v18
  v_add_f32 v17, v17, v18
  v_mov_b32 v18, v17
  s_nop 1
  v_permlane32_swap_b32 v17, v18
  v_add_f32 v17, v17, v18
  v_mul_f32 v17, 0x3b000000, v17
  v_cvt_pk_bf16_f32 v17, v17, v17
  v_lshlrev_b32 v17, 16, v17
  v_cvt_pk_bf16_f32 v16, v16, v16
  v_lshlrev_b32 v16, 16, v16
  v_add_f32 v17, 0x3727c5ac, v17
  v_cvt_pk_bf16_f32 v17, v17, v17
  v_lshlrev_b32 v17, 16, v17
  v_sqrt_f32 v17, v17
  s_nop 0
  v_cvt_pk_bf16_f32 v17, v17, v17
  v_lshlrev_b32 v17, 16, v17
  v_rcp_f32 v18, v17
  s_nop 0
  v_fma_f32 v20, -v17, v18, 2.0
  v_mul_f32 v18, v18, v20
  v_sub_f32 v8, v8, v16
  v_cvt_pk_bf16_f32 v8, v8, v8
  v_lshlrev_b32 v8, 16, v8
  v_mul_f32 v20, v8, v18
  v_fma_f32 v21, -v20, v17, v8
  v_fma_f32 v8, v21, v18, v20
  v_sub_f32 v9, v9, v16
  v_cvt_pk_bf16_f32 v9, v9, v9
  v_lshlrev_b32 v9, 16, v9
  v_mul_f32 v20, v9, v18
  v_fma_f32 v21, -v20, v17, v9
  v_fma_f32 v9, v21, v18, v20
  v_sub_f32 v10, v10, v16
  v_cvt_pk_bf16_f32 v10, v10, v10
  v_lshlrev_b32 v10, 16, v10
  v_mul_f32 v20, v10, v18
  v_fma_f32 v21, -v20, v17, v10
  v_fma_f32 v10, v21, v18, v20
  v_sub_f32 v11, v11, v16
  v_cvt_pk_bf16_f32 v11, v11, v11
  v_lshlrev_b32 v11, 16, v11
  v_mul_f32 v20, v11, v18
  v_fma_f32 v21, -v20, v17, v11
  v_fma_f32 v11, v21, v18, v20
  v_sub_f32 v12, v12, v16
  v_cvt_pk_bf16_f32 v12, v12, v12
  v_lshlrev_b32 v12, 16, v12
  v_mul_f32 v20, v12, v18
  v_fma_f32 v21, -v20, v17, v12
  v_fma_f32 v12, v21, v18, v20
  v_sub_f32 v13, v13, v16
  v_cvt_pk_bf16_f32 v13, v13, v13
  v_lshlrev_b32 v13, 16, v13
  v_mul_f32 v20, v13, v18
  v_fma_f32 v21, -v20, v17, v13
  v_fma_f32 v13, v21, v18, v20
  v_sub_f32 v14, v14, v16
  v_cvt_pk_bf16_f32 v14, v14, v14
  v_lshlrev_b32 v14, 16, v14
  v_mul_f32 v20, v14, v18
  v_fma_f32 v21, -v20, v17, v14
  v_fma_f32 v14, v21, v18, v20
  v_sub_f32 v15, v15, v16
  v_cvt_pk_bf16_f32 v15, v15, v15
  v_lshlrev_b32 v15, 16, v15
  v_mul_f32 v20, v15, v18
  v_fma_f32 v21, -v20, v17, v15
  v_fma_f32 v15, v21, v18, v20
  v_cvt_pk_bf16_f32 v108, v8, v9
  v_cvt_pk_bf16_f32 v109, v10, v11
  v_cvt_pk_bf16_f32 v110, v12, v13
  v_cvt_pk_bf16_f32 v111, v14, v15
  buffer_store_dwordx4 v[108:111], v4, s[4:7], 0 offen offset:1024 sc1
  s_waitcnt vmcnt(0)
  s_barrier
  s_cmp_lg_u32 s18, 0
  s_cbranch_scc1 L_sig_55
  s_lshl_b32 s60, s26, 8
  s_lshl_b32 s61, s23, 2
  s_add_u32 s60, s60, s61
  s_add_u32 s60, s60, 98705408
  v_mov_b32 v2, s60
  v_mov_b32 v3, s69
  s_mov_b64 exec, 1
  buffer_store_dword v3, v2, s[4:7], 0 offen sc1
  s_mov_b64 exec, -1

L_sig_55:
  s_branch L_worker
L_task_gu:
  s_mov_b32 s23, s27
  s_cmp_lg_u32 s18, 0
  s_cbranch_scc1 L_wo_57
  s_lshl_b32 s60, s26, 8
  s_add_u32 s60, s60, 98705408
  v_lshlrev_b32 v2, 2, v1
  v_add_u32 v2, s60, v2
  s_mov_b32 s62, 0

  s_mov_b64 exec, 0xffff
L_wt_56:
  buffer_load_dword v3, v2, s[4:7], 0 offen sc1
  s_waitcnt vmcnt(0)
  v_cmp_ne_u32 vcc, s69, v3
  s_cbranch_vccz L_wo_57
  s_sleep 1
  s_add_u32 s62, s62, 1
  s_cmp_lt_u32 s62, 0x100000
  s_cbranch_scc1 L_wt_56

L_wo_57:
  s_mov_b64 exec, -1
  s_barrier
  s_and_b32 s25, s27, 1
  s_lshr_b32 s27, s27, 1
  s_mov_b32 s38, 1024
  s_mov_b32 s39, 2752
  s_lshl_b32 s30, s26, 17
  s_lshl_b32 s34, s25, 16
  s_add_u32 s30, s30, s34
  s_add_u32 s30, s30, 81788928
  s_lshl_b32 s31, s27, 7

  s_mov_b32 s8, s88
  s_mov_b32 s9, s89
  s_mov_b32 s10, 1409024
  s_mov_b32 s11, 0x00020000
  s_mov_b32 s12, s90
  s_mov_b32 s13, s91
  s_mov_b32 s14, 1409024
  s_mov_b32 s15, 0x00020000
  s_lshr_b32 s36, s18, 1
  s_and_b32 s37, s18, 1
  v_lshrrev_b32 v17, 3, v1
  v_mul_lo_u32 v2, v17, s38
  v_and_b32 v18, 7, v1
  v_lshrrev_b32 v19, 4, v1
  v_xor_b32 v18, v18, v19
  v_lshl_add_u32 v2, v18, 4, v2
  v_xor_b32 v3, 64, v2

  v_lshrrev_b32 v17, 3, v1
  v_mul_lo_u32 v4, v17, s39
  v_lshrrev_b32 v18, 4, v1
  v_and_b32 v18, 1, v18
  v_lshlrev_b32 v18, 2, v18
  v_and_b32 v19, 7, v1
  v_xor_b32 v19, v19, v18
  v_lshl_add_u32 v4, v19, 4, v4
  v_and_b32 v17, 31, v1
  v_lshrrev_b32 v18, 1, v17
  v_and_b32 v18, 7, v18
  v_lshrrev_b32 v19, 5, v1
  v_xor_b32 v18, v18, v19
  s_mul_i32 s34, s36, 4096
  v_lshlrev_b32 v17, 7, v17
  v_add_u32 v17, s34, v17

  v_xor_b32 v19, 0, v18
  v_lshl_add_u32 v5, v19, 4, v17
  v_add_u32 v9, 73728, v5
  v_xor_b32 v19, 2, v18
  v_lshl_add_u32 v6, v19, 4, v17
  v_add_u32 v10, 73728, v6
  v_xor_b32 v19, 4, v18
  v_lshl_add_u32 v7, v19, 4, v17
  v_add_u32 v11, 73728, v7
  v_xor_b32 v19, 6, v18
  v_lshl_add_u32 v8, v19, 4, v17
  v_add_u32 v12, 73728, v8
  v_lshrrev_b32 v17, 5, v1
  v_lshlrev_b32 v17, 3, v17
  v_lshrrev_b32 v18, 2, v1
  v_and_b32 v18, 3, v18
  v_add_u32 v17, v17, v18
  v_lshlrev_b32 v17, 7, v17
  v_lshrrev_b32 v18, 1, v18
  v_lshl_add_u32 v17, v18, 6, v17
  v_lshrrev_b32 v18, 4, v1
  v_and_b32 v18, 1, v18
  v_lshl_add_u32 v17, v18, 5, v17
  v_and_b32 v18, 3, v1
  v_lshl_add_u32 v17, v18, 3, v17
  s_lshl_b32 s34, s37, 6
  v_xor_b32 v17, s34, v17
  s_mov_b32 s34, 8192
  v_add_u32 v13, s34, v17
  v_xor_b32 v14, 64, v13
  v_add_u32 v15, 73728, v13
  v_add_u32 v16, 73728, v14

  s_mov_b32 s40, s30
  s_mul_i32 s34, s18, s38
  s_mul_i32 s34, s34, 16
  s_add_u32 s40, s40, s34
  s_mov_b32 s41, s31
  s_mov_b32 s42, s31
  s_mul_i32 s34, s18, s39
  s_lshl_b32 s34, s34, 4
  s_add_u32 s41, s41, s34
  s_add_u32 s42, s42, s34
  s_lshl_b32 s35, s18, 10
  s_mul_i32 s48, s38, 0
  s_mul_i32 s49, s38, 8
  s_lshl_b32 s56, s39, 3
  s_lshl_b32 s57, s39, 6
  s_mul_i32 s34, s18, 2048
  s_add_u32 s34, s34, 0
  s_add_u32 m0, s34, 0
  s_add_u32 s35, s40, s48
  buffer_load_dwordx4 v2, s[4:7], s35 offen sc1 lds
  s_add_u32 m0, s34, 1024
  s_add_u32 s35, s40, s49
  buffer_load_dwordx4 v3, s[4:7], s35 offen sc1 lds
  s_add_u32 s40, s40, 128
  s_lshl_b32 s34, s18, 11
  s_add_u32 s34, s34, 8192
  s_add_u32 m0, s34, 0
  s_nop 0
  buffer_load_dwordx4 v4, s[8:11], s41 offen lds
  s_add_u32 m0, s34, 1024
  s_add_u32 s35, s41, s56
  buffer_load_dwordx4 v4, s[8:11], s35 offen lds
  s_add_u32 s41, s41, s57
  s_add_u32 m0, s34, 8192
  s_nop 0
  buffer_load_dwordx4 v4, s[12:15], s42 offen lds
  s_add_u32 m0, s34, 9216
  s_add_u32 s35, s42, s56
  buffer_load_dwordx4 v4, s[12:15], s35 offen lds
  s_add_u32 s42, s42, s57
  s_mul_i32 s34, s18, 2048
  s_add_u32 s34, s34, 24576
  s_add_u32 m0, s34, 0
  s_add_u32 s35, s40, s48
  buffer_load_dwordx4 v2, s[4:7], s35 offen sc1 lds
  s_add_u32 m0, s34, 1024
  s_add_u32 s35, s40, s49
  buffer_load_dwordx4 v3, s[4:7], s35 offen sc1 lds
  s_add_u32 s40, s40, 128
  s_lshl_b32 s34, s18, 11
  s_add_u32 s34, s34, 32768
  s_add_u32 m0, s34, 0
  s_nop 0
  buffer_load_dwordx4 v4, s[8:11], s41 offen lds
  s_add_u32 m0, s34, 1024
  s_add_u32 s35, s41, s56
  buffer_load_dwordx4 v4, s[8:11], s35 offen lds
  s_add_u32 s41, s41, s57
  s_add_u32 m0, s34, 8192
  s_nop 0
  buffer_load_dwordx4 v4, s[12:15], s42 offen lds
  s_add_u32 m0, s34, 9216
  s_add_u32 s35, s42, s56
  buffer_load_dwordx4 v4, s[12:15], s35 offen lds
  s_add_u32 s42, s42, s57
  s_mul_i32 s34, s18, 2048
  s_add_u32 s34, s34, 49152
  s_add_u32 m0, s34, 0
  s_add_u32 s35, s40, s48
  buffer_load_dwordx4 v2, s[4:7], s35 offen sc1 lds
  s_add_u32 m0, s34, 1024
  s_add_u32 s35, s40, s49
  buffer_load_dwordx4 v3, s[4:7], s35 offen sc1 lds
  s_add_u32 s40, s40, 128
  s_lshl_b32 s34, s18, 11
  s_add_u32 s34, s34, 57344
  s_add_u32 m0, s34, 0
  s_nop 0
  buffer_load_dwordx4 v4, s[8:11], s41 offen lds
  s_add_u32 m0, s34, 1024
  s_add_u32 s35, s41, s56
  buffer_load_dwordx4 v4, s[8:11], s35 offen lds
  s_add_u32 s41, s41, s57
  s_add_u32 m0, s34, 8192
  s_nop 0
  buffer_load_dwordx4 v4, s[12:15], s42 offen lds
  s_add_u32 m0, s34, 9216
  s_add_u32 s35, s42, s56
  buffer_load_dwordx4 v4, s[12:15], s35 offen lds
  s_add_u32 s42, s42, s57
  s_mul_i32 s34, s18, 2048
  s_add_u32 s34, s34, 73728
  s_add_u32 m0, s34, 0
  s_add_u32 s35, s40, s48
  buffer_load_dwordx4 v2, s[4:7], s35 offen sc1 lds
  s_add_u32 m0, s34, 1024
  s_add_u32 s35, s40, s49
  buffer_load_dwordx4 v3, s[4:7], s35 offen sc1 lds
  s_add_u32 s40, s40, 128
  s_lshl_b32 s34, s18, 11
  s_add_u32 s34, s34, 81920
  s_add_u32 m0, s34, 0
  s_nop 0
  buffer_load_dwordx4 v4, s[8:11], s41 offen lds
  s_add_u32 m0, s34, 1024
  s_add_u32 s35, s41, s56
  buffer_load_dwordx4 v4, s[8:11], s35 offen lds
  s_add_u32 s41, s41, s57
  s_add_u32 m0, s34, 8192
  s_nop 0
  buffer_load_dwordx4 v4, s[12:15], s42 offen lds
  s_add_u32 m0, s34, 9216
  s_add_u32 s35, s42, s56
  buffer_load_dwordx4 v4, s[12:15], s35 offen lds
  s_add_u32 s42, s42, s57
  s_mul_i32 s34, s18, 2048
  s_add_u32 s34, s34, 98304
  s_add_u32 m0, s34, 0
  s_add_u32 s35, s40, s48
  buffer_load_dwordx4 v2, s[4:7], s35 offen sc1 lds
  s_add_u32 m0, s34, 1024
  s_add_u32 s35, s40, s49
  buffer_load_dwordx4 v3, s[4:7], s35 offen sc1 lds
  s_add_u32 s40, s40, 128
  s_lshl_b32 s34, s18, 11
  s_add_u32 s34, s34, 106496
  s_add_u32 m0, s34, 0
  s_nop 0
  buffer_load_dwordx4 v4, s[8:11], s41 offen lds
  s_add_u32 m0, s34, 1024
  s_add_u32 s35, s41, s56
  buffer_load_dwordx4 v4, s[8:11], s35 offen lds
  s_add_u32 s41, s41, s57
  s_add_u32 m0, s34, 8192
  s_nop 0
  buffer_load_dwordx4 v4, s[12:15], s42 offen lds
  s_add_u32 m0, s34, 9216
  s_add_u32 s35, s42, s56
  buffer_load_dwordx4 v4, s[12:15], s35 offen lds
  s_add_u32 s42, s42, s57
  s_waitcnt vmcnt(24)
  s_barrier
  s_mul_i32 s34, s18, 2048
  s_add_u32 s34, s34, 122880
  s_add_u32 m0, s34, 0
  s_add_u32 s35, s40, s48
  buffer_load_dwordx4 v2, s[4:7], s35 offen sc1 lds
  s_add_u32 m0, s34, 1024
  s_add_u32 s35, s40, s49
  buffer_load_dwordx4 v3, s[4:7], s35 offen sc1 lds
  s_add_u32 s40, s40, 128
  s_lshl_b32 s34, s18, 11
  s_add_u32 s34, s34, 131072
  s_add_u32 m0, s34, 0
  s_nop 0
  buffer_load_dwordx4 v4, s[8:11], s41 offen lds
  s_add_u32 m0, s34, 1024
  s_add_u32 s35, s41, s56
  buffer_load_dwordx4 v4, s[8:11], s35 offen lds
  s_add_u32 s41, s41, s57
  s_add_u32 m0, s34, 8192
  s_nop 0
  buffer_load_dwordx4 v4, s[12:15], s42 offen lds
  s_add_u32 m0, s34, 9216
  s_add_u32 s35, s42, s56
  buffer_load_dwordx4 v4, s[12:15], s35 offen lds
  s_add_u32 s42, s42, s57
  ds_read_b128 v[24:27], v5 offset:0
  ds_read_b64_tr_b16 v[32:33], v13 offset:0
  ds_read_b64_tr_b16 v[34:35], v13 offset:512
  ds_read_b64_tr_b16 v[36:37], v13 offset:8192
  ds_read_b64_tr_b16 v[38:39], v13 offset:8704
  ds_read_b128 v[28:31], v6 offset:0
  ds_read_b64_tr_b16 v[40:41], v13 offset:2048
  ds_read_b64_tr_b16 v[42:43], v13 offset:2560
  ds_read_b64_tr_b16 v[44:45], v13 offset:10240
  ds_read_b64_tr_b16 v[46:47], v13 offset:10752
  s_waitcnt lgkmcnt(5)
  v_mfma_f32_32x32x16_bf16 a[0:15], v[32:35], v[24:27], 0
  v_mfma_f32_32x32x16_bf16 a[16:31], v[36:39], v[24:27], 0
  ds_read_b128 v[24:27], v7 offset:0
  ds_read_b64_tr_b16 v[32:33], v13 offset:4096
  ds_read_b64_tr_b16 v[34:35], v13 offset:4608
  ds_read_b64_tr_b16 v[36:37], v13 offset:12288
  ds_read_b64_tr_b16 v[38:39], v13 offset:12800
  s_waitcnt lgkmcnt(5)
  v_mfma_f32_32x32x16_bf16 a[0:15], v[40:43], v[28:31], a[0:15]
  v_mfma_f32_32x32x16_bf16 a[16:31], v[44:47], v[28:31], a[16:31]
  ds_read_b128 v[28:31], v8 offset:0
  ds_read_b64_tr_b16 v[40:41], v13 offset:6144
  ds_read_b64_tr_b16 v[42:43], v13 offset:6656
  ds_read_b64_tr_b16 v[44:45], v13 offset:14336
  ds_read_b64_tr_b16 v[46:47], v13 offset:14848
  s_waitcnt lgkmcnt(5)
  v_mfma_f32_32x32x16_bf16 a[0:15], v[32:35], v[24:27], a[0:15]
  v_mfma_f32_32x32x16_bf16 a[16:31], v[36:39], v[24:27], a[16:31]
  s_waitcnt lgkmcnt(0)
  v_mfma_f32_32x32x16_bf16 a[0:15], v[40:43], v[28:31], a[0:15]
  v_mfma_f32_32x32x16_bf16 a[16:31], v[44:47], v[28:31], a[16:31]
  s_waitcnt vmcnt(24)
  s_barrier
  s_mul_i32 s34, s18, 2048
  s_add_u32 s34, s34, 0
  s_add_u32 m0, s34, 0
  s_add_u32 s35, s40, s48
  buffer_load_dwordx4 v2, s[4:7], s35 offen sc1 lds
  s_add_u32 m0, s34, 1024
  s_add_u32 s35, s40, s49
  buffer_load_dwordx4 v3, s[4:7], s35 offen sc1 lds
  s_add_u32 s40, s40, 128
  s_lshl_b32 s34, s18, 11
  s_add_u32 s34, s34, 8192
  s_add_u32 m0, s34, 0
  s_nop 0
  buffer_load_dwordx4 v4, s[8:11], s41 offen lds
  s_add_u32 m0, s34, 1024
  s_add_u32 s35, s41, s56
  buffer_load_dwordx4 v4, s[8:11], s35 offen lds
  s_add_u32 s41, s41, s57
  s_add_u32 m0, s34, 8192
  s_nop 0
  buffer_load_dwordx4 v4, s[12:15], s42 offen lds
  s_add_u32 m0, s34, 9216
  s_add_u32 s35, s42, s56
  buffer_load_dwordx4 v4, s[12:15], s35 offen lds
  s_add_u32 s42, s42, s57
  ds_read_b128 v[24:27], v5 offset:24576
  ds_read_b64_tr_b16 v[32:33], v13 offset:24576
  ds_read_b64_tr_b16 v[34:35], v13 offset:25088
  ds_read_b64_tr_b16 v[36:37], v13 offset:32768
  ds_read_b64_tr_b16 v[38:39], v13 offset:33280
  ds_read_b128 v[28:31], v6 offset:24576
  ds_read_b64_tr_b16 v[40:41], v13 offset:26624
  ds_read_b64_tr_b16 v[42:43], v13 offset:27136
  ds_read_b64_tr_b16 v[44:45], v13 offset:34816
  ds_read_b64_tr_b16 v[46:47], v13 offset:35328
  s_waitcnt lgkmcnt(5)
  v_mfma_f32_32x32x16_bf16 a[0:15], v[32:35], v[24:27], a[0:15]
  v_mfma_f32_32x32x16_bf16 a[16:31], v[36:39], v[24:27], a[16:31]
  ds_read_b128 v[24:27], v7 offset:24576
  ds_read_b64_tr_b16 v[32:33], v13 offset:28672
  ds_read_b64_tr_b16 v[34:35], v13 offset:29184
  ds_read_b64_tr_b16 v[36:37], v13 offset:36864
  ds_read_b64_tr_b16 v[38:39], v13 offset:37376
  s_waitcnt lgkmcnt(5)
  v_mfma_f32_32x32x16_bf16 a[0:15], v[40:43], v[28:31], a[0:15]
  v_mfma_f32_32x32x16_bf16 a[16:31], v[44:47], v[28:31], a[16:31]
  ds_read_b128 v[28:31], v8 offset:24576
  ds_read_b64_tr_b16 v[40:41], v13 offset:30720
  ds_read_b64_tr_b16 v[42:43], v13 offset:31232
  ds_read_b64_tr_b16 v[44:45], v13 offset:38912
  ds_read_b64_tr_b16 v[46:47], v13 offset:39424
  s_waitcnt lgkmcnt(5)
  v_mfma_f32_32x32x16_bf16 a[0:15], v[32:35], v[24:27], a[0:15]
  v_mfma_f32_32x32x16_bf16 a[16:31], v[36:39], v[24:27], a[16:31]
  s_waitcnt lgkmcnt(0)
  v_mfma_f32_32x32x16_bf16 a[0:15], v[40:43], v[28:31], a[0:15]
  v_mfma_f32_32x32x16_bf16 a[16:31], v[44:47], v[28:31], a[16:31]
  s_waitcnt vmcnt(24)
  s_barrier
  s_mul_i32 s34, s18, 2048
  s_add_u32 s34, s34, 24576
  s_add_u32 m0, s34, 0
  s_add_u32 s35, s40, s48
  buffer_load_dwordx4 v2, s[4:7], s35 offen sc1 lds
  s_add_u32 m0, s34, 1024
  s_add_u32 s35, s40, s49
  buffer_load_dwordx4 v3, s[4:7], s35 offen sc1 lds
  s_add_u32 s40, s40, 128
  s_lshl_b32 s34, s18, 11
  s_add_u32 s34, s34, 32768
  s_add_u32 m0, s34, 0
  s_nop 0
  buffer_load_dwordx4 v4, s[8:11], s41 offen lds
  s_add_u32 m0, s34, 1024
  s_add_u32 s35, s41, s56
  buffer_load_dwordx4 v4, s[8:11], s35 offen lds
  s_add_u32 s41, s41, s57
  s_add_u32 m0, s34, 8192
  s_nop 0
  buffer_load_dwordx4 v4, s[12:15], s42 offen lds
  s_add_u32 m0, s34, 9216
  s_add_u32 s35, s42, s56
  buffer_load_dwordx4 v4, s[12:15], s35 offen lds
  s_add_u32 s42, s42, s57
  ds_read_b128 v[24:27], v5 offset:49152
  ds_read_b64_tr_b16 v[32:33], v13 offset:49152
  ds_read_b64_tr_b16 v[34:35], v13 offset:49664
  ds_read_b64_tr_b16 v[36:37], v13 offset:57344
  ds_read_b64_tr_b16 v[38:39], v13 offset:57856
  ds_read_b128 v[28:31], v6 offset:49152
  ds_read_b64_tr_b16 v[40:41], v13 offset:51200
  ds_read_b64_tr_b16 v[42:43], v13 offset:51712
  ds_read_b64_tr_b16 v[44:45], v13 offset:59392
  ds_read_b64_tr_b16 v[46:47], v13 offset:59904
  s_waitcnt lgkmcnt(5)
  v_mfma_f32_32x32x16_bf16 a[0:15], v[32:35], v[24:27], a[0:15]
  v_mfma_f32_32x32x16_bf16 a[16:31], v[36:39], v[24:27], a[16:31]
  ds_read_b128 v[24:27], v7 offset:49152
  ds_read_b64_tr_b16 v[32:33], v13 offset:53248
  ds_read_b64_tr_b16 v[34:35], v13 offset:53760
  ds_read_b64_tr_b16 v[36:37], v13 offset:61440
  ds_read_b64_tr_b16 v[38:39], v13 offset:61952
  s_waitcnt lgkmcnt(5)
  v_mfma_f32_32x32x16_bf16 a[0:15], v[40:43], v[28:31], a[0:15]
  v_mfma_f32_32x32x16_bf16 a[16:31], v[44:47], v[28:31], a[16:31]
  ds_read_b128 v[28:31], v8 offset:49152
  ds_read_b64_tr_b16 v[40:41], v13 offset:55296
  ds_read_b64_tr_b16 v[42:43], v13 offset:55808
  ds_read_b64_tr_b16 v[44:45], v13 offset:63488
  ds_read_b64_tr_b16 v[46:47], v13 offset:64000
  s_waitcnt lgkmcnt(5)
  v_mfma_f32_32x32x16_bf16 a[0:15], v[32:35], v[24:27], a[0:15]
  v_mfma_f32_32x32x16_bf16 a[16:31], v[36:39], v[24:27], a[16:31]
  s_waitcnt lgkmcnt(0)
  v_mfma_f32_32x32x16_bf16 a[0:15], v[40:43], v[28:31], a[0:15]
  v_mfma_f32_32x32x16_bf16 a[16:31], v[44:47], v[28:31], a[16:31]
  s_waitcnt vmcnt(24)
  s_barrier
  ds_read_b128 v[24:27], v9 offset:0
  ds_read_b64_tr_b16 v[32:33], v15 offset:0
  ds_read_b64_tr_b16 v[34:35], v15 offset:512
  ds_read_b64_tr_b16 v[36:37], v15 offset:8192
  ds_read_b64_tr_b16 v[38:39], v15 offset:8704
  ds_read_b128 v[28:31], v10 offset:0
  ds_read_b64_tr_b16 v[40:41], v15 offset:2048
  ds_read_b64_tr_b16 v[42:43], v15 offset:2560
  ds_read_b64_tr_b16 v[44:45], v15 offset:10240
  ds_read_b64_tr_b16 v[46:47], v15 offset:10752
  s_waitcnt lgkmcnt(5)
  v_mfma_f32_32x32x16_bf16 a[0:15], v[32:35], v[24:27], a[0:15]
  v_mfma_f32_32x32x16_bf16 a[16:31], v[36:39], v[24:27], a[16:31]
  ds_read_b128 v[24:27], v11 offset:0
  ds_read_b64_tr_b16 v[32:33], v15 offset:4096
  ds_read_b64_tr_b16 v[34:35], v15 offset:4608
  ds_read_b64_tr_b16 v[36:37], v15 offset:12288
  ds_read_b64_tr_b16 v[38:39], v15 offset:12800
  s_waitcnt lgkmcnt(5)
  v_mfma_f32_32x32x16_bf16 a[0:15], v[40:43], v[28:31], a[0:15]
  v_mfma_f32_32x32x16_bf16 a[16:31], v[44:47], v[28:31], a[16:31]
  ds_read_b128 v[28:31], v12 offset:0
  ds_read_b64_tr_b16 v[40:41], v15 offset:6144
  ds_read_b64_tr_b16 v[42:43], v15 offset:6656
  ds_read_b64_tr_b16 v[44:45], v15 offset:14336
  ds_read_b64_tr_b16 v[46:47], v15 offset:14848
  s_waitcnt lgkmcnt(5)
  v_mfma_f32_32x32x16_bf16 a[0:15], v[32:35], v[24:27], a[0:15]
  v_mfma_f32_32x32x16_bf16 a[16:31], v[36:39], v[24:27], a[16:31]
  s_waitcnt lgkmcnt(0)
  v_mfma_f32_32x32x16_bf16 a[0:15], v[40:43], v[28:31], a[0:15]
  v_mfma_f32_32x32x16_bf16 a[16:31], v[44:47], v[28:31], a[16:31]
  s_waitcnt vmcnt(18)
  s_barrier
  ds_read_b128 v[24:27], v9 offset:24576
  ds_read_b64_tr_b16 v[32:33], v15 offset:24576
  ds_read_b64_tr_b16 v[34:35], v15 offset:25088
  ds_read_b64_tr_b16 v[36:37], v15 offset:32768
  ds_read_b64_tr_b16 v[38:39], v15 offset:33280
  ds_read_b128 v[28:31], v10 offset:24576
  ds_read_b64_tr_b16 v[40:41], v15 offset:26624
  ds_read_b64_tr_b16 v[42:43], v15 offset:27136
  ds_read_b64_tr_b16 v[44:45], v15 offset:34816
  ds_read_b64_tr_b16 v[46:47], v15 offset:35328
  s_waitcnt lgkmcnt(5)
  v_mfma_f32_32x32x16_bf16 a[0:15], v[32:35], v[24:27], a[0:15]
  v_mfma_f32_32x32x16_bf16 a[16:31], v[36:39], v[24:27], a[16:31]
  ds_read_b128 v[24:27], v11 offset:24576
  ds_read_b64_tr_b16 v[32:33], v15 offset:28672
  ds_read_b64_tr_b16 v[34:35], v15 offset:29184
  ds_read_b64_tr_b16 v[36:37], v15 offset:36864
  ds_read_b64_tr_b16 v[38:39], v15 offset:37376
  s_waitcnt lgkmcnt(5)
  v_mfma_f32_32x32x16_bf16 a[0:15], v[40:43], v[28:31], a[0:15]
  v_mfma_f32_32x32x16_bf16 a[16:31], v[44:47], v[28:31], a[16:31]
  ds_read_b128 v[28:31], v12 offset:24576
  ds_read_b64_tr_b16 v[40:41], v15 offset:30720
  ds_read_b64_tr_b16 v[42:43], v15 offset:31232
  ds_read_b64_tr_b16 v[44:45], v15 offset:38912
  ds_read_b64_tr_b16 v[46:47], v15 offset:39424
  s_waitcnt lgkmcnt(5)
  v_mfma_f32_32x32x16_bf16 a[0:15], v[32:35], v[24:27], a[0:15]
  v_mfma_f32_32x32x16_bf16 a[16:31], v[36:39], v[24:27], a[16:31]
  s_waitcnt lgkmcnt(0)
  v_mfma_f32_32x32x16_bf16 a[0:15], v[40:43], v[28:31], a[0:15]
  v_mfma_f32_32x32x16_bf16 a[16:31], v[44:47], v[28:31], a[16:31]
  s_waitcnt vmcnt(12)
  s_barrier
  ds_read_b128 v[24:27], v9 offset:49152
  ds_read_b64_tr_b16 v[32:33], v15 offset:49152
  ds_read_b64_tr_b16 v[34:35], v15 offset:49664
  ds_read_b64_tr_b16 v[36:37], v15 offset:57344
  ds_read_b64_tr_b16 v[38:39], v15 offset:57856
  ds_read_b128 v[28:31], v10 offset:49152
  ds_read_b64_tr_b16 v[40:41], v15 offset:51200
  ds_read_b64_tr_b16 v[42:43], v15 offset:51712
  ds_read_b64_tr_b16 v[44:45], v15 offset:59392
  ds_read_b64_tr_b16 v[46:47], v15 offset:59904
  s_waitcnt lgkmcnt(5)
  v_mfma_f32_32x32x16_bf16 a[0:15], v[32:35], v[24:27], a[0:15]
  v_mfma_f32_32x32x16_bf16 a[16:31], v[36:39], v[24:27], a[16:31]
  ds_read_b128 v[24:27], v11 offset:49152
  ds_read_b64_tr_b16 v[32:33], v15 offset:53248
  ds_read_b64_tr_b16 v[34:35], v15 offset:53760
  ds_read_b64_tr_b16 v[36:37], v15 offset:61440
  ds_read_b64_tr_b16 v[38:39], v15 offset:61952
  s_waitcnt lgkmcnt(5)
  v_mfma_f32_32x32x16_bf16 a[0:15], v[40:43], v[28:31], a[0:15]
  v_mfma_f32_32x32x16_bf16 a[16:31], v[44:47], v[28:31], a[16:31]
  ds_read_b128 v[28:31], v12 offset:49152
  ds_read_b64_tr_b16 v[40:41], v15 offset:55296
  ds_read_b64_tr_b16 v[42:43], v15 offset:55808
  ds_read_b64_tr_b16 v[44:45], v15 offset:63488
  ds_read_b64_tr_b16 v[46:47], v15 offset:64000
  s_waitcnt lgkmcnt(5)
  v_mfma_f32_32x32x16_bf16 a[0:15], v[32:35], v[24:27], a[0:15]
  v_mfma_f32_32x32x16_bf16 a[16:31], v[36:39], v[24:27], a[16:31]
  s_waitcnt lgkmcnt(0)
  v_mfma_f32_32x32x16_bf16 a[0:15], v[40:43], v[28:31], a[0:15]
  v_mfma_f32_32x32x16_bf16 a[16:31], v[44:47], v[28:31], a[16:31]
  s_waitcnt vmcnt(6)
  s_barrier
  ds_read_b128 v[24:27], v5 offset:0
  ds_read_b64_tr_b16 v[32:33], v13 offset:0
  ds_read_b64_tr_b16 v[34:35], v13 offset:512
  ds_read_b64_tr_b16 v[36:37], v13 offset:8192
  ds_read_b64_tr_b16 v[38:39], v13 offset:8704
  ds_read_b128 v[28:31], v6 offset:0
  ds_read_b64_tr_b16 v[40:41], v13 offset:2048
  ds_read_b64_tr_b16 v[42:43], v13 offset:2560
  ds_read_b64_tr_b16 v[44:45], v13 offset:10240
  ds_read_b64_tr_b16 v[46:47], v13 offset:10752
  s_waitcnt lgkmcnt(5)
  v_mfma_f32_32x32x16_bf16 a[0:15], v[32:35], v[24:27], a[0:15]
  v_mfma_f32_32x32x16_bf16 a[16:31], v[36:39], v[24:27], a[16:31]
  ds_read_b128 v[24:27], v7 offset:0
  ds_read_b64_tr_b16 v[32:33], v13 offset:4096
  ds_read_b64_tr_b16 v[34:35], v13 offset:4608
  ds_read_b64_tr_b16 v[36:37], v13 offset:12288
  ds_read_b64_tr_b16 v[38:39], v13 offset:12800
  s_waitcnt lgkmcnt(5)
  v_mfma_f32_32x32x16_bf16 a[0:15], v[40:43], v[28:31], a[0:15]
  v_mfma_f32_32x32x16_bf16 a[16:31], v[44:47], v[28:31], a[16:31]
  ds_read_b128 v[28:31], v8 offset:0
  ds_read_b64_tr_b16 v[40:41], v13 offset:6144
  ds_read_b64_tr_b16 v[42:43], v13 offset:6656
  ds_read_b64_tr_b16 v[44:45], v13 offset:14336
  ds_read_b64_tr_b16 v[46:47], v13 offset:14848
  s_waitcnt lgkmcnt(5)
  v_mfma_f32_32x32x16_bf16 a[0:15], v[32:35], v[24:27], a[0:15]
  v_mfma_f32_32x32x16_bf16 a[16:31], v[36:39], v[24:27], a[16:31]
  s_waitcnt lgkmcnt(0)
  v_mfma_f32_32x32x16_bf16 a[0:15], v[40:43], v[28:31], a[0:15]
  v_mfma_f32_32x32x16_bf16 a[16:31], v[44:47], v[28:31], a[16:31]
  s_waitcnt vmcnt(0)
  s_barrier
  ds_read_b128 v[24:27], v5 offset:24576
  ds_read_b64_tr_b16 v[32:33], v13 offset:24576
  ds_read_b64_tr_b16 v[34:35], v13 offset:25088
  ds_read_b64_tr_b16 v[36:37], v13 offset:32768
  ds_read_b64_tr_b16 v[38:39], v13 offset:33280
  ds_read_b128 v[28:31], v6 offset:24576
  ds_read_b64_tr_b16 v[40:41], v13 offset:26624
  ds_read_b64_tr_b16 v[42:43], v13 offset:27136
  ds_read_b64_tr_b16 v[44:45], v13 offset:34816
  ds_read_b64_tr_b16 v[46:47], v13 offset:35328
  s_waitcnt lgkmcnt(5)
  v_mfma_f32_32x32x16_bf16 a[0:15], v[32:35], v[24:27], a[0:15]
  v_mfma_f32_32x32x16_bf16 a[16:31], v[36:39], v[24:27], a[16:31]
  ds_read_b128 v[24:27], v7 offset:24576
  ds_read_b64_tr_b16 v[32:33], v13 offset:28672
  ds_read_b64_tr_b16 v[34:35], v13 offset:29184
  ds_read_b64_tr_b16 v[36:37], v13 offset:36864
  ds_read_b64_tr_b16 v[38:39], v13 offset:37376
  s_waitcnt lgkmcnt(5)
  v_mfma_f32_32x32x16_bf16 a[0:15], v[40:43], v[28:31], a[0:15]
  v_mfma_f32_32x32x16_bf16 a[16:31], v[44:47], v[28:31], a[16:31]
  ds_read_b128 v[28:31], v8 offset:24576
  ds_read_b64_tr_b16 v[40:41], v13 offset:30720
  ds_read_b64_tr_b16 v[42:43], v13 offset:31232
  ds_read_b64_tr_b16 v[44:45], v13 offset:38912
  ds_read_b64_tr_b16 v[46:47], v13 offset:39424
  s_waitcnt lgkmcnt(5)
  v_mfma_f32_32x32x16_bf16 a[0:15], v[32:35], v[24:27], a[0:15]
  v_mfma_f32_32x32x16_bf16 a[16:31], v[36:39], v[24:27], a[16:31]
  s_waitcnt lgkmcnt(0)
  v_mfma_f32_32x32x16_bf16 a[0:15], v[40:43], v[28:31], a[0:15]
  v_mfma_f32_32x32x16_bf16 a[16:31], v[44:47], v[28:31], a[16:31]
  s_nop 15
  s_barrier
  s_mul_i32 s34, s26, 360448
  s_mul_i32 s35, s25, 180224
  s_add_u32 s34, s34, s35
  s_mul_i32 s35, s18, 45056
  s_add_u32 s34, s34, s35
  s_lshl_b32 s35, s27, 7
  s_add_u32 s34, s34, s35
  s_add_u32 s34, s34, 83886080
  v_lshrrev_b32 v3, 3, v1
  v_and_b32 v4, 7, v1
  v_mul_u32_u24 v5, 2816, v3
  v_lshl_add_u32 v5, v4, 4, v5
  v_add_u32 v5, s34, v5
  s_mul_i32 s34, s18, 2304
  v_mul_u32_u24 v6, 144, v3
  v_lshl_add_u32 v6, v4, 4, v6
  v_add_u32 v6, s34, v6
  s_mul_i32 s34, s36, 4608
  s_lshl_b32 s35, s37, 6
  s_add_u32 s34, s34, s35
  v_and_b32 v2, 31, v1
  v_mul_u32_u24 v2, 144, v2
  v_lshrrev_b32 v3, 5, v1
  v_lshl_add_u32 v2, v3, 4, v2
  v_add_u32 v2, s34, v2
  s_lshl_b32 s34, s27, 6
  s_lshl_b32 s35, s37, 5
  s_add_u32 s34, s34, s35
  s_cmp_ge_u32 s34, 1376
  s_cselect_b32 s60, 0, 1.0
  s_mov_b32 s61, 0x3d372713
  s_mov_b32 s62, 0x40135761

  v_accvgpr_read_b32 v16, a0
  v_accvgpr_read_b32 v20, a16
  v_cvt_pk_bf16_f32 v16, v16, v16
  v_lshlrev_b32 v16, 16, v16
  v_cvt_pk_bf16_f32 v20, v20, v20
  v_lshlrev_b32 v20, 16, v20
  v_mul_f32 v24, v16, v16
  v_mul_f32 v24, v24, v16
  v_fma_f32 v24, v24, s61, v16
  v_mul_f32 v24, s62, v24
  v_exp_f32 v24, -v24
  s_nop 0
  v_add_f32 v24, 1.0, v24
  v_rcp_f32 v24, v24
  s_nop 0
  v_mul_f32 v16, v16, v24

  v_cvt_pk_bf16_f32 v16, v16, v16
  v_lshlrev_b32 v16, 16, v16
  v_mul_f32 v16, v16, v20
  v_mul_f32 v16, s60, v16
  v_accvgpr_read_b32 v17, a1
  v_accvgpr_read_b32 v21, a17
  v_cvt_pk_bf16_f32 v17, v17, v17
  v_lshlrev_b32 v17, 16, v17
  v_cvt_pk_bf16_f32 v21, v21, v21
  v_lshlrev_b32 v21, 16, v21
  v_mul_f32 v25, v17, v17
  v_mul_f32 v25, v25, v17
  v_fma_f32 v25, v25, s61, v17
  v_mul_f32 v25, s62, v25
  v_exp_f32 v25, -v25
  s_nop 0
  v_add_f32 v25, 1.0, v25
  v_rcp_f32 v25, v25
  s_nop 0
  v_mul_f32 v17, v17, v25

  v_cvt_pk_bf16_f32 v17, v17, v17
  v_lshlrev_b32 v17, 16, v17
  v_mul_f32 v17, v17, v21
  v_mul_f32 v17, s60, v17
  v_accvgpr_read_b32 v18, a2
  v_accvgpr_read_b32 v22, a18
  v_cvt_pk_bf16_f32 v18, v18, v18
  v_lshlrev_b32 v18, 16, v18
  v_cvt_pk_bf16_f32 v22, v22, v22
  v_lshlrev_b32 v22, 16, v22
  v_mul_f32 v26, v18, v18
  v_mul_f32 v26, v26, v18
  v_fma_f32 v26, v26, s61, v18
  v_mul_f32 v26, s62, v26
  v_exp_f32 v26, -v26
  s_nop 0
  v_add_f32 v26, 1.0, v26
  v_rcp_f32 v26, v26
  s_nop 0
  v_mul_f32 v18, v18, v26

  v_cvt_pk_bf16_f32 v18, v18, v18
  v_lshlrev_b32 v18, 16, v18
  v_mul_f32 v18, v18, v22
  v_mul_f32 v18, s60, v18
  v_accvgpr_read_b32 v19, a3
  v_accvgpr_read_b32 v23, a19
  v_cvt_pk_bf16_f32 v19, v19, v19
  v_lshlrev_b32 v19, 16, v19
  v_cvt_pk_bf16_f32 v23, v23, v23
  v_lshlrev_b32 v23, 16, v23
  v_mul_f32 v27, v19, v19
  v_mul_f32 v27, v27, v19
  v_fma_f32 v27, v27, s61, v19
  v_mul_f32 v27, s62, v27
  v_exp_f32 v27, -v27
  s_nop 0
  v_add_f32 v27, 1.0, v27
  v_rcp_f32 v27, v27
  s_nop 0
  v_mul_f32 v19, v19, v27

  v_cvt_pk_bf16_f32 v19, v19, v19
  v_lshlrev_b32 v19, 16, v19
  v_mul_f32 v19, v19, v23
  v_mul_f32 v19, s60, v19
  v_cvt_pk_bf16_f32 v8, v16, v17
  v_cvt_pk_bf16_f32 v9, v18, v19
  v_accvgpr_read_b32 v16, a4
  v_accvgpr_read_b32 v20, a20
  v_cvt_pk_bf16_f32 v16, v16, v16
  v_lshlrev_b32 v16, 16, v16
  v_cvt_pk_bf16_f32 v20, v20, v20
  v_lshlrev_b32 v20, 16, v20
  v_mul_f32 v24, v16, v16
  v_mul_f32 v24, v24, v16
  v_fma_f32 v24, v24, s61, v16
  v_mul_f32 v24, s62, v24
  v_exp_f32 v24, -v24
  s_nop 0
  v_add_f32 v24, 1.0, v24
  v_rcp_f32 v24, v24
  s_nop 0
  v_mul_f32 v16, v16, v24

  v_cvt_pk_bf16_f32 v16, v16, v16
  v_lshlrev_b32 v16, 16, v16
  v_mul_f32 v16, v16, v20
  v_mul_f32 v16, s60, v16
  v_accvgpr_read_b32 v17, a5
  v_accvgpr_read_b32 v21, a21
  v_cvt_pk_bf16_f32 v17, v17, v17
  v_lshlrev_b32 v17, 16, v17
  v_cvt_pk_bf16_f32 v21, v21, v21
  v_lshlrev_b32 v21, 16, v21
  v_mul_f32 v25, v17, v17
  v_mul_f32 v25, v25, v17
  v_fma_f32 v25, v25, s61, v17
  v_mul_f32 v25, s62, v25
  v_exp_f32 v25, -v25
  s_nop 0
  v_add_f32 v25, 1.0, v25
  v_rcp_f32 v25, v25
  s_nop 0
  v_mul_f32 v17, v17, v25

  v_cvt_pk_bf16_f32 v17, v17, v17
  v_lshlrev_b32 v17, 16, v17
  v_mul_f32 v17, v17, v21
  v_mul_f32 v17, s60, v17
  v_accvgpr_read_b32 v18, a6
  v_accvgpr_read_b32 v22, a22
  v_cvt_pk_bf16_f32 v18, v18, v18
  v_lshlrev_b32 v18, 16, v18
  v_cvt_pk_bf16_f32 v22, v22, v22
  v_lshlrev_b32 v22, 16, v22
  v_mul_f32 v26, v18, v18
  v_mul_f32 v26, v26, v18
  v_fma_f32 v26, v26, s61, v18
  v_mul_f32 v26, s62, v26
  v_exp_f32 v26, -v26
  s_nop 0
  v_add_f32 v26, 1.0, v26
  v_rcp_f32 v26, v26
  s_nop 0
  v_mul_f32 v18, v18, v26

  v_cvt_pk_bf16_f32 v18, v18, v18
  v_lshlrev_b32 v18, 16, v18
  v_mul_f32 v18, v18, v22
  v_mul_f32 v18, s60, v18
  v_accvgpr_read_b32 v19, a7
  v_accvgpr_read_b32 v23, a23
  v_cvt_pk_bf16_f32 v19, v19, v19
  v_lshlrev_b32 v19, 16, v19
  v_cvt_pk_bf16_f32 v23, v23, v23
  v_lshlrev_b32 v23, 16, v23
  v_mul_f32 v27, v19, v19
  v_mul_f32 v27, v27, v19
  v_fma_f32 v27, v27, s61, v19
  v_mul_f32 v27, s62, v27
  v_exp_f32 v27, -v27
  s_nop 0
  v_add_f32 v27, 1.0, v27
  v_rcp_f32 v27, v27
  s_nop 0
  v_mul_f32 v19, v19, v27

  v_cvt_pk_bf16_f32 v19, v19, v19
  v_lshlrev_b32 v19, 16, v19
  v_mul_f32 v19, v19, v23
  v_mul_f32 v19, s60, v19
  v_cvt_pk_bf16_f32 v10, v16, v17
  v_cvt_pk_bf16_f32 v11, v18, v19
  s_nop 1
  v_permlane32_swap_b32 v8, v10
  v_permlane32_swap_b32 v9, v11
  ds_write_b128 v2, v[8:11] offset:0
  v_accvgpr_read_b32 v16, a8
  v_accvgpr_read_b32 v20, a24
  v_cvt_pk_bf16_f32 v16, v16, v16
  v_lshlrev_b32 v16, 16, v16
  v_cvt_pk_bf16_f32 v20, v20, v20
  v_lshlrev_b32 v20, 16, v20
  v_mul_f32 v24, v16, v16
  v_mul_f32 v24, v24, v16
  v_fma_f32 v24, v24, s61, v16
  v_mul_f32 v24, s62, v24
  v_exp_f32 v24, -v24
  s_nop 0
  v_add_f32 v24, 1.0, v24
  v_rcp_f32 v24, v24
  s_nop 0
  v_mul_f32 v16, v16, v24

  v_cvt_pk_bf16_f32 v16, v16, v16
  v_lshlrev_b32 v16, 16, v16
  v_mul_f32 v16, v16, v20
  v_mul_f32 v16, s60, v16
  v_accvgpr_read_b32 v17, a9
  v_accvgpr_read_b32 v21, a25
  v_cvt_pk_bf16_f32 v17, v17, v17
  v_lshlrev_b32 v17, 16, v17
  v_cvt_pk_bf16_f32 v21, v21, v21
  v_lshlrev_b32 v21, 16, v21
  v_mul_f32 v25, v17, v17
  v_mul_f32 v25, v25, v17
  v_fma_f32 v25, v25, s61, v17
  v_mul_f32 v25, s62, v25
  v_exp_f32 v25, -v25
  s_nop 0
  v_add_f32 v25, 1.0, v25
  v_rcp_f32 v25, v25
  s_nop 0
  v_mul_f32 v17, v17, v25

  v_cvt_pk_bf16_f32 v17, v17, v17
  v_lshlrev_b32 v17, 16, v17
  v_mul_f32 v17, v17, v21
  v_mul_f32 v17, s60, v17
  v_accvgpr_read_b32 v18, a10
  v_accvgpr_read_b32 v22, a26
  v_cvt_pk_bf16_f32 v18, v18, v18
  v_lshlrev_b32 v18, 16, v18
  v_cvt_pk_bf16_f32 v22, v22, v22
  v_lshlrev_b32 v22, 16, v22
  v_mul_f32 v26, v18, v18
  v_mul_f32 v26, v26, v18
  v_fma_f32 v26, v26, s61, v18
  v_mul_f32 v26, s62, v26
  v_exp_f32 v26, -v26
  s_nop 0
  v_add_f32 v26, 1.0, v26
  v_rcp_f32 v26, v26
  s_nop 0
  v_mul_f32 v18, v18, v26

  v_cvt_pk_bf16_f32 v18, v18, v18
  v_lshlrev_b32 v18, 16, v18
  v_mul_f32 v18, v18, v22
  v_mul_f32 v18, s60, v18
  v_accvgpr_read_b32 v19, a11
  v_accvgpr_read_b32 v23, a27
  v_cvt_pk_bf16_f32 v19, v19, v19
  v_lshlrev_b32 v19, 16, v19
  v_cvt_pk_bf16_f32 v23, v23, v23
  v_lshlrev_b32 v23, 16, v23
  v_mul_f32 v27, v19, v19
  v_mul_f32 v27, v27, v19
  v_fma_f32 v27, v27, s61, v19
  v_mul_f32 v27, s62, v27
  v_exp_f32 v27, -v27
  s_nop 0
  v_add_f32 v27, 1.0, v27
  v_rcp_f32 v27, v27
  s_nop 0
  v_mul_f32 v19, v19, v27

  v_cvt_pk_bf16_f32 v19, v19, v19
  v_lshlrev_b32 v19, 16, v19
  v_mul_f32 v19, v19, v23
  v_mul_f32 v19, s60, v19
  v_cvt_pk_bf16_f32 v12, v16, v17
  v_cvt_pk_bf16_f32 v13, v18, v19
  v_accvgpr_read_b32 v16, a12
  v_accvgpr_read_b32 v20, a28
  v_cvt_pk_bf16_f32 v16, v16, v16
  v_lshlrev_b32 v16, 16, v16
  v_cvt_pk_bf16_f32 v20, v20, v20
  v_lshlrev_b32 v20, 16, v20
  v_mul_f32 v24, v16, v16
  v_mul_f32 v24, v24, v16
  v_fma_f32 v24, v24, s61, v16
  v_mul_f32 v24, s62, v24
  v_exp_f32 v24, -v24
  s_nop 0
  v_add_f32 v24, 1.0, v24
  v_rcp_f32 v24, v24
  s_nop 0
  v_mul_f32 v16, v16, v24

  v_cvt_pk_bf16_f32 v16, v16, v16
  v_lshlrev_b32 v16, 16, v16
  v_mul_f32 v16, v16, v20
  v_mul_f32 v16, s60, v16
  v_accvgpr_read_b32 v17, a13
  v_accvgpr_read_b32 v21, a29
  v_cvt_pk_bf16_f32 v17, v17, v17
  v_lshlrev_b32 v17, 16, v17
  v_cvt_pk_bf16_f32 v21, v21, v21
  v_lshlrev_b32 v21, 16, v21
  v_mul_f32 v25, v17, v17
  v_mul_f32 v25, v25, v17
  v_fma_f32 v25, v25, s61, v17
  v_mul_f32 v25, s62, v25
  v_exp_f32 v25, -v25
  s_nop 0
  v_add_f32 v25, 1.0, v25
  v_rcp_f32 v25, v25
  s_nop 0
  v_mul_f32 v17, v17, v25

  v_cvt_pk_bf16_f32 v17, v17, v17
  v_lshlrev_b32 v17, 16, v17
  v_mul_f32 v17, v17, v21
  v_mul_f32 v17, s60, v17
  v_accvgpr_read_b32 v18, a14
  v_accvgpr_read_b32 v22, a30
  v_cvt_pk_bf16_f32 v18, v18, v18
  v_lshlrev_b32 v18, 16, v18
  v_cvt_pk_bf16_f32 v22, v22, v22
  v_lshlrev_b32 v22, 16, v22
  v_mul_f32 v26, v18, v18
  v_mul_f32 v26, v26, v18
  v_fma_f32 v26, v26, s61, v18
  v_mul_f32 v26, s62, v26
  v_exp_f32 v26, -v26
  s_nop 0
  v_add_f32 v26, 1.0, v26
  v_rcp_f32 v26, v26
  s_nop 0
  v_mul_f32 v18, v18, v26

  v_cvt_pk_bf16_f32 v18, v18, v18
  v_lshlrev_b32 v18, 16, v18
  v_mul_f32 v18, v18, v22
  v_mul_f32 v18, s60, v18
  v_accvgpr_read_b32 v19, a15
  v_accvgpr_read_b32 v23, a31
  v_cvt_pk_bf16_f32 v19, v19, v19
  v_lshlrev_b32 v19, 16, v19
  v_cvt_pk_bf16_f32 v23, v23, v23
  v_lshlrev_b32 v23, 16, v23
  v_mul_f32 v27, v19, v19
  v_mul_f32 v27, v27, v19
  v_fma_f32 v27, v27, s61, v19
  v_mul_f32 v27, s62, v27
  v_exp_f32 v27, -v27
  s_nop 0
  v_add_f32 v27, 1.0, v27
  v_rcp_f32 v27, v27
  s_nop 0
  v_mul_f32 v19, v19, v27

  v_cvt_pk_bf16_f32 v19, v19, v19
  v_lshlrev_b32 v19, 16, v19
  v_mul_f32 v19, v19, v23
  v_mul_f32 v19, s60, v19
  v_cvt_pk_bf16_f32 v14, v16, v17
  v_cvt_pk_bf16_f32 v15, v18, v19
  s_nop 1
  v_permlane32_swap_b32 v12, v14
  v_permlane32_swap_b32 v13, v15
  ds_write_b128 v2, v[12:15] offset:32
  s_waitcnt lgkmcnt(0)
  s_barrier
  ds_read_b128 v[8:11], v6
  ds_read_b128 v[12:15], v6 offset:1152
  s_mov_b32 s34, 22528
  s_waitcnt lgkmcnt(1)
  buffer_store_dwordx4 v[8:11], v5, s[4:7], 0 offen sc1
  s_waitcnt lgkmcnt(0)
  buffer_store_dwordx4 v[12:15], v5, s[4:7], s34 offen sc1

  s_waitcnt vmcnt(0)
  s_barrier
  s_cmp_lg_u32 s18, 0
  s_cbranch_scc1 L_sig_58
  s_lshl_b32 s60, s26, 8
  s_lshl_b32 s61, s23, 2
  s_add_u32 s60, s60, s61
  s_add_u32 s60, s60, 98709504
  v_mov_b32 v2, s60
  v_mov_b32 v3, s69
  s_mov_b64 exec, 1
  buffer_store_dword v3, v2, s[4:7], 0 offen sc1
  s_mov_b64 exec, -1

L_sig_58:
  s_branch L_worker
L_task_dn:
  s_mov_b32 s23, s27
  s_cmp_lg_u32 s18, 0
  s_cbranch_scc1 L_wo_60
  s_lshl_b32 s60, s26, 8
  s_add_u32 s60, s60, 98709504
  v_lshlrev_b32 v2, 2, v1
  v_add_u32 v2, s60, v2
  s_mov_b32 s62, 0

  s_mov_b32 exec_lo, -1
  s_mov_b32 exec_hi, 0xfff
L_wt_59:
  buffer_load_dword v3, v2, s[4:7], 0 offen sc1
  s_waitcnt vmcnt(0)
  v_cmp_ne_u32 vcc, s69, v3
  s_cbranch_vccz L_wo_60
  s_sleep 1
  s_add_u32 s62, s62, 1
  s_cmp_lt_u32 s62, 0x100000
  s_cbranch_scc1 L_wt_59

L_wo_60:
  s_mov_b64 exec, -1
  s_barrier
  s_lshr_b32 s25, s27, 3
  s_and_b32 s27, s27, 7
  s_mov_b32 s38, 2816
  s_mov_b32 s39, 1024
  s_mul_i32 s30, s26, 360448
  s_mul_i32 s34, s25, 1408
  s_add_u32 s30, s30, s34
  s_add_u32 s30, s30, 83886080
  s_lshl_b32 s31, s27, 7
  s_mul_i32 s34, s25, 720896
  s_add_u32 s31, s31, s34

  s_mov_b32 s12, s92
  s_mov_b32 s13, s93
  s_mov_b32 s14, 1409024
  s_mov_b32 s15, 0x00020000
  s_lshr_b32 s36, s18, 1
  s_and_b32 s37, s18, 1
  v_lshrrev_b32 v17, 3, v1
  v_mul_lo_u32 v2, v17, s38
  v_and_b32 v18, 7, v1
  v_lshrrev_b32 v19, 4, v1
  v_xor_b32 v18, v18, v19
  v_lshl_add_u32 v2, v18, 4, v2
  v_xor_b32 v3, 64, v2

  v_lshrrev_b32 v17, 3, v1
  v_mul_lo_u32 v4, v17, s39
  v_lshrrev_b32 v18, 4, v1
  v_and_b32 v18, 1, v18
  v_lshlrev_b32 v18, 2, v18
  v_and_b32 v19, 7, v1
  v_xor_b32 v19, v19, v18
  v_lshl_add_u32 v4, v19, 4, v4
  v_and_b32 v17, 31, v1
  v_lshrrev_b32 v18, 1, v17
  v_and_b32 v18, 7, v18
  v_lshrrev_b32 v19, 5, v1
  v_xor_b32 v18, v18, v19
  s_mul_i32 s34, s36, 8192
  v_lshlrev_b32 v17, 7, v17
  v_add_u32 v17, s34, v17

  v_xor_b32 v19, 0, v18
  v_lshl_add_u32 v5, v19, 4, v17
  v_add_u32 v9, 73728, v5
  v_xor_b32 v19, 2, v18
  v_lshl_add_u32 v6, v19, 4, v17
  v_add_u32 v10, 73728, v6
  v_xor_b32 v19, 4, v18
  v_lshl_add_u32 v7, v19, 4, v17
  v_add_u32 v11, 73728, v7
  v_xor_b32 v19, 6, v18
  v_lshl_add_u32 v8, v19, 4, v17
  v_add_u32 v12, 73728, v8
  v_lshrrev_b32 v17, 5, v1
  v_lshlrev_b32 v17, 3, v17
  v_lshrrev_b32 v18, 2, v1
  v_and_b32 v18, 3, v18
  v_add_u32 v17, v17, v18
  v_lshlrev_b32 v17, 7, v17
  v_lshrrev_b32 v18, 1, v18
  v_lshl_add_u32 v17, v18, 6, v17
  v_lshrrev_b32 v18, 4, v1
  v_and_b32 v18, 1, v18
  v_lshl_add_u32 v17, v18, 5, v17
  v_and_b32 v18, 3, v1
  v_lshl_add_u32 v17, v18, 3, v17
  s_lshl_b32 s34, s37, 6
  v_xor_b32 v17, s34, v17
  s_mov_b32 s34, 16384
  v_add_u32 v13, s34, v17
  v_xor_b32 v14, 64, v13
  v_add_u32 v15, 73728, v13
  v_add_u32 v16, 73728, v14

  s_mov_b32 s40, s30
  s_mul_i32 s34, s18, s38
  s_mul_i32 s34, s34, 32
  s_add_u32 s40, s40, s34
  s_mov_b32 s41, s31
  s_mul_i32 s34, s18, s39
  s_lshl_b32 s34, s34, 4
  s_add_u32 s41, s41, s34
  s_lshl_b32 s35, s18, 10
  s_mul_i32 s48, s38, 0
  s_mul_i32 s49, s38, 8
  s_mul_i32 s50, s38, 16
  s_mul_i32 s51, s38, 24
  s_lshl_b32 s56, s39, 3
  s_lshl_b32 s57, s39, 6
  s_mul_i32 s34, s18, 4096
  s_add_u32 s34, s34, 0
  s_add_u32 m0, s34, 0
  s_add_u32 s35, s40, s48
  buffer_load_dwordx4 v2, s[4:7], s35 offen sc1 lds
  s_add_u32 m0, s34, 1024
  s_add_u32 s35, s40, s49
  buffer_load_dwordx4 v3, s[4:7], s35 offen sc1 lds
  s_add_u32 m0, s34, 2048
  s_add_u32 s35, s40, s50
  buffer_load_dwordx4 v2, s[4:7], s35 offen sc1 lds
  s_add_u32 m0, s34, 3072
  s_add_u32 s35, s40, s51
  buffer_load_dwordx4 v3, s[4:7], s35 offen sc1 lds
  s_add_u32 s40, s40, 128
  s_lshl_b32 s34, s18, 11
  s_add_u32 s34, s34, 16384
  s_add_u32 m0, s34, 0
  s_nop 0
  buffer_load_dwordx4 v4, s[12:15], s41 offen lds
  s_add_u32 m0, s34, 1024
  s_add_u32 s35, s41, s56
  buffer_load_dwordx4 v4, s[12:15], s35 offen lds
  s_add_u32 s41, s41, s57
  s_mul_i32 s34, s18, 4096
  s_add_u32 s34, s34, 24576
  s_add_u32 m0, s34, 0
  s_add_u32 s35, s40, s48
  buffer_load_dwordx4 v2, s[4:7], s35 offen sc1 lds
  s_add_u32 m0, s34, 1024
  s_add_u32 s35, s40, s49
  buffer_load_dwordx4 v3, s[4:7], s35 offen sc1 lds
  s_add_u32 m0, s34, 2048
  s_add_u32 s35, s40, s50
  buffer_load_dwordx4 v2, s[4:7], s35 offen sc1 lds
  s_add_u32 m0, s34, 3072
  s_add_u32 s35, s40, s51
  buffer_load_dwordx4 v3, s[4:7], s35 offen sc1 lds
  s_add_u32 s40, s40, 128
  s_lshl_b32 s34, s18, 11
  s_add_u32 s34, s34, 40960
  s_add_u32 m0, s34, 0
  s_nop 0
  buffer_load_dwordx4 v4, s[12:15], s41 offen lds
  s_add_u32 m0, s34, 1024
  s_add_u32 s35, s41, s56
  buffer_load_dwordx4 v4, s[12:15], s35 offen lds
  s_add_u32 s41, s41, s57
  s_mul_i32 s34, s18, 4096
  s_add_u32 s34, s34, 49152
  s_add_u32 m0, s34, 0
  s_add_u32 s35, s40, s48
  buffer_load_dwordx4 v2, s[4:7], s35 offen sc1 lds
  s_add_u32 m0, s34, 1024
  s_add_u32 s35, s40, s49
  buffer_load_dwordx4 v3, s[4:7], s35 offen sc1 lds
  s_add_u32 m0, s34, 2048
  s_add_u32 s35, s40, s50
  buffer_load_dwordx4 v2, s[4:7], s35 offen sc1 lds
  s_add_u32 m0, s34, 3072
  s_add_u32 s35, s40, s51
  buffer_load_dwordx4 v3, s[4:7], s35 offen sc1 lds
  s_add_u32 s40, s40, 128
  s_lshl_b32 s34, s18, 11
  s_add_u32 s34, s34, 65536
  s_add_u32 m0, s34, 0
  s_nop 0
  buffer_load_dwordx4 v4, s[12:15], s41 offen lds
  s_add_u32 m0, s34, 1024
  s_add_u32 s35, s41, s56
  buffer_load_dwordx4 v4, s[12:15], s35 offen lds
  s_add_u32 s41, s41, s57
  s_mul_i32 s34, s18, 4096
  s_add_u32 s34, s34, 73728
  s_add_u32 m0, s34, 0
  s_add_u32 s35, s40, s48
  buffer_load_dwordx4 v2, s[4:7], s35 offen sc1 lds
  s_add_u32 m0, s34, 1024
  s_add_u32 s35, s40, s49
  buffer_load_dwordx4 v3, s[4:7], s35 offen sc1 lds
  s_add_u32 m0, s34, 2048
  s_add_u32 s35, s40, s50
  buffer_load_dwordx4 v2, s[4:7], s35 offen sc1 lds
  s_add_u32 m0, s34, 3072
  s_add_u32 s35, s40, s51
  buffer_load_dwordx4 v3, s[4:7], s35 offen sc1 lds
  s_add_u32 s40, s40, 128
  s_lshl_b32 s34, s18, 11
  s_add_u32 s34, s34, 90112
  s_add_u32 m0, s34, 0
  s_nop 0
  buffer_load_dwordx4 v4, s[12:15], s41 offen lds
  s_add_u32 m0, s34, 1024
  s_add_u32 s35, s41, s56
  buffer_load_dwordx4 v4, s[12:15], s35 offen lds
  s_add_u32 s41, s41, s57
  s_mul_i32 s34, s18, 4096
  s_add_u32 s34, s34, 98304
  s_add_u32 m0, s34, 0
  s_add_u32 s35, s40, s48
  buffer_load_dwordx4 v2, s[4:7], s35 offen sc1 lds
  s_add_u32 m0, s34, 1024
  s_add_u32 s35, s40, s49
  buffer_load_dwordx4 v3, s[4:7], s35 offen sc1 lds
  s_add_u32 m0, s34, 2048
  s_add_u32 s35, s40, s50
  buffer_load_dwordx4 v2, s[4:7], s35 offen sc1 lds
  s_add_u32 m0, s34, 3072
  s_add_u32 s35, s40, s51
  buffer_load_dwordx4 v3, s[4:7], s35 offen sc1 lds
  s_add_u32 s40, s40, 128
  s_lshl_b32 s34, s18, 11
  s_add_u32 s34, s34, 114688
  s_add_u32 m0, s34, 0
  s_nop 0
  buffer_load_dwordx4 v4, s[12:15], s41 offen lds
  s_add_u32 m0, s34, 1024
  s_add_u32 s35, s41, s56
  buffer_load_dwordx4 v4, s[12:15], s35 offen lds
  s_add_u32 s41, s41, s57
  s_waitcnt vmcnt(24)
  s_barrier
  s_mul_i32 s34, s18, 4096
  s_add_u32 s34, s34, 122880
  s_add_u32 m0, s34, 0
  s_add_u32 s35, s40, s48
  buffer_load_dwordx4 v2, s[4:7], s35 offen sc1 lds
  s_add_u32 m0, s34, 1024
  s_add_u32 s35, s40, s49
  buffer_load_dwordx4 v3, s[4:7], s35 offen sc1 lds
  s_add_u32 m0, s34, 2048
  s_add_u32 s35, s40, s50
  buffer_load_dwordx4 v2, s[4:7], s35 offen sc1 lds
  s_add_u32 m0, s34, 3072
  s_add_u32 s35, s40, s51
  buffer_load_dwordx4 v3, s[4:7], s35 offen sc1 lds
  s_add_u32 s40, s40, 128
  s_lshl_b32 s34, s18, 11
  s_add_u32 s34, s34, 139264
  s_add_u32 m0, s34, 0
  s_nop 0
  buffer_load_dwordx4 v4, s[12:15], s41 offen lds
  s_add_u32 m0, s34, 1024
  s_add_u32 s35, s41, s56
  buffer_load_dwordx4 v4, s[12:15], s35 offen lds
  s_add_u32 s41, s41, s57
  ds_read_b128 v[24:27], v5 offset:0
  ds_read_b128 v[28:31], v5 offset:4096
  ds_read_b64_tr_b16 v[40:41], v13 offset:0
  ds_read_b64_tr_b16 v[42:43], v13 offset:512
  ds_read_b128 v[32:35], v6 offset:0
  ds_read_b128 v[36:39], v6 offset:4096
  ds_read_b64_tr_b16 v[44:45], v13 offset:2048
  ds_read_b64_tr_b16 v[46:47], v13 offset:2560
  s_waitcnt lgkmcnt(4)
  v_mfma_f32_32x32x16_bf16 a[0:15], v[40:43], v[24:27], 0
  v_mfma_f32_32x32x16_bf16 a[16:31], v[40:43], v[28:31], 0
  ds_read_b128 v[24:27], v7 offset:0
  ds_read_b128 v[28:31], v7 offset:4096
  ds_read_b64_tr_b16 v[40:41], v13 offset:4096
  ds_read_b64_tr_b16 v[42:43], v13 offset:4608
  s_waitcnt lgkmcnt(4)
  v_mfma_f32_32x32x16_bf16 a[0:15], v[44:47], v[32:35], a[0:15]
  v_mfma_f32_32x32x16_bf16 a[16:31], v[44:47], v[36:39], a[16:31]
  ds_read_b128 v[32:35], v8 offset:0
  ds_read_b128 v[36:39], v8 offset:4096
  ds_read_b64_tr_b16 v[44:45], v13 offset:6144
  ds_read_b64_tr_b16 v[46:47], v13 offset:6656
  s_waitcnt lgkmcnt(4)
  v_mfma_f32_32x32x16_bf16 a[0:15], v[40:43], v[24:27], a[0:15]
  v_mfma_f32_32x32x16_bf16 a[16:31], v[40:43], v[28:31], a[16:31]
  s_waitcnt lgkmcnt(0)
  v_mfma_f32_32x32x16_bf16 a[0:15], v[44:47], v[32:35], a[0:15]
  v_mfma_f32_32x32x16_bf16 a[16:31], v[44:47], v[36:39], a[16:31]
  s_waitcnt vmcnt(24)
  s_barrier
  s_mul_i32 s34, s18, 4096
  s_add_u32 s34, s34, 0
  s_add_u32 m0, s34, 0
  s_add_u32 s35, s40, s48
  buffer_load_dwordx4 v2, s[4:7], s35 offen sc1 lds
  s_add_u32 m0, s34, 1024
  s_add_u32 s35, s40, s49
  buffer_load_dwordx4 v3, s[4:7], s35 offen sc1 lds
  s_add_u32 m0, s34, 2048
  s_add_u32 s35, s40, s50
  buffer_load_dwordx4 v2, s[4:7], s35 offen sc1 lds
  s_add_u32 m0, s34, 3072
  s_add_u32 s35, s40, s51
  buffer_load_dwordx4 v3, s[4:7], s35 offen sc1 lds
  s_add_u32 s40, s40, 128
  s_lshl_b32 s34, s18, 11
  s_add_u32 s34, s34, 16384
  s_add_u32 m0, s34, 0
  s_nop 0
  buffer_load_dwordx4 v4, s[12:15], s41 offen lds
  s_add_u32 m0, s34, 1024
  s_add_u32 s35, s41, s56
  buffer_load_dwordx4 v4, s[12:15], s35 offen lds
  s_add_u32 s41, s41, s57
  ds_read_b128 v[24:27], v5 offset:24576
  ds_read_b128 v[28:31], v5 offset:28672
  ds_read_b64_tr_b16 v[40:41], v13 offset:24576
  ds_read_b64_tr_b16 v[42:43], v13 offset:25088
  ds_read_b128 v[32:35], v6 offset:24576
  ds_read_b128 v[36:39], v6 offset:28672
  ds_read_b64_tr_b16 v[44:45], v13 offset:26624
  ds_read_b64_tr_b16 v[46:47], v13 offset:27136
  s_waitcnt lgkmcnt(4)
  v_mfma_f32_32x32x16_bf16 a[0:15], v[40:43], v[24:27], a[0:15]
  v_mfma_f32_32x32x16_bf16 a[16:31], v[40:43], v[28:31], a[16:31]
  ds_read_b128 v[24:27], v7 offset:24576
  ds_read_b128 v[28:31], v7 offset:28672
  ds_read_b64_tr_b16 v[40:41], v13 offset:28672
  ds_read_b64_tr_b16 v[42:43], v13 offset:29184
  s_waitcnt lgkmcnt(4)
  v_mfma_f32_32x32x16_bf16 a[0:15], v[44:47], v[32:35], a[0:15]
  v_mfma_f32_32x32x16_bf16 a[16:31], v[44:47], v[36:39], a[16:31]
  ds_read_b128 v[32:35], v8 offset:24576
  ds_read_b128 v[36:39], v8 offset:28672
  ds_read_b64_tr_b16 v[44:45], v13 offset:30720
  ds_read_b64_tr_b16 v[46:47], v13 offset:31232
  s_waitcnt lgkmcnt(4)
  v_mfma_f32_32x32x16_bf16 a[0:15], v[40:43], v[24:27], a[0:15]
  v_mfma_f32_32x32x16_bf16 a[16:31], v[40:43], v[28:31], a[16:31]
  s_waitcnt lgkmcnt(0)
  v_mfma_f32_32x32x16_bf16 a[0:15], v[44:47], v[32:35], a[0:15]
  v_mfma_f32_32x32x16_bf16 a[16:31], v[44:47], v[36:39], a[16:31]
  s_waitcnt vmcnt(24)
  s_barrier
  s_mul_i32 s34, s18, 4096
  s_add_u32 s34, s34, 24576
  s_add_u32 m0, s34, 0
  s_add_u32 s35, s40, s48
  buffer_load_dwordx4 v2, s[4:7], s35 offen sc1 lds
  s_add_u32 m0, s34, 1024
  s_add_u32 s35, s40, s49
  buffer_load_dwordx4 v3, s[4:7], s35 offen sc1 lds
  s_add_u32 m0, s34, 2048
  s_add_u32 s35, s40, s50
  buffer_load_dwordx4 v2, s[4:7], s35 offen sc1 lds
  s_add_u32 m0, s34, 3072
  s_add_u32 s35, s40, s51
  buffer_load_dwordx4 v3, s[4:7], s35 offen sc1 lds
  s_add_u32 s40, s40, 128
  s_lshl_b32 s34, s18, 11
  s_add_u32 s34, s34, 40960
  s_add_u32 m0, s34, 0
  s_nop 0
  buffer_load_dwordx4 v4, s[12:15], s41 offen lds
  s_add_u32 m0, s34, 1024
  s_add_u32 s35, s41, s56
  buffer_load_dwordx4 v4, s[12:15], s35 offen lds
  s_add_u32 s41, s41, s57
  ds_read_b128 v[24:27], v5 offset:49152
  ds_read_b128 v[28:31], v5 offset:53248
  ds_read_b64_tr_b16 v[40:41], v13 offset:49152
  ds_read_b64_tr_b16 v[42:43], v13 offset:49664
  ds_read_b128 v[32:35], v6 offset:49152
  ds_read_b128 v[36:39], v6 offset:53248
  ds_read_b64_tr_b16 v[44:45], v13 offset:51200
  ds_read_b64_tr_b16 v[46:47], v13 offset:51712
  s_waitcnt lgkmcnt(4)
  v_mfma_f32_32x32x16_bf16 a[0:15], v[40:43], v[24:27], a[0:15]
  v_mfma_f32_32x32x16_bf16 a[16:31], v[40:43], v[28:31], a[16:31]
  ds_read_b128 v[24:27], v7 offset:49152
  ds_read_b128 v[28:31], v7 offset:53248
  ds_read_b64_tr_b16 v[40:41], v13 offset:53248
  ds_read_b64_tr_b16 v[42:43], v13 offset:53760
  s_waitcnt lgkmcnt(4)
  v_mfma_f32_32x32x16_bf16 a[0:15], v[44:47], v[32:35], a[0:15]
  v_mfma_f32_32x32x16_bf16 a[16:31], v[44:47], v[36:39], a[16:31]
  ds_read_b128 v[32:35], v8 offset:49152
  ds_read_b128 v[36:39], v8 offset:53248
  ds_read_b64_tr_b16 v[44:45], v13 offset:55296
  ds_read_b64_tr_b16 v[46:47], v13 offset:55808
  s_waitcnt lgkmcnt(4)
  v_mfma_f32_32x32x16_bf16 a[0:15], v[40:43], v[24:27], a[0:15]
  v_mfma_f32_32x32x16_bf16 a[16:31], v[40:43], v[28:31], a[16:31]
  s_waitcnt lgkmcnt(0)
  v_mfma_f32_32x32x16_bf16 a[0:15], v[44:47], v[32:35], a[0:15]
  v_mfma_f32_32x32x16_bf16 a[16:31], v[44:47], v[36:39], a[16:31]
  s_waitcnt vmcnt(24)
  s_barrier
  s_mul_i32 s34, s18, 4096
  s_add_u32 s34, s34, 49152
  s_add_u32 m0, s34, 0
  s_add_u32 s35, s40, s48
  buffer_load_dwordx4 v2, s[4:7], s35 offen sc1 lds
  s_add_u32 m0, s34, 1024
  s_add_u32 s35, s40, s49
  buffer_load_dwordx4 v3, s[4:7], s35 offen sc1 lds
  s_add_u32 m0, s34, 2048
  s_add_u32 s35, s40, s50
  buffer_load_dwordx4 v2, s[4:7], s35 offen sc1 lds
  s_add_u32 m0, s34, 3072
  s_add_u32 s35, s40, s51
  buffer_load_dwordx4 v3, s[4:7], s35 offen sc1 lds
  s_add_u32 s40, s40, 128
  s_lshl_b32 s34, s18, 11
  s_add_u32 s34, s34, 65536
  s_add_u32 m0, s34, 0
  s_nop 0
  buffer_load_dwordx4 v4, s[12:15], s41 offen lds
  s_add_u32 m0, s34, 1024
  s_add_u32 s35, s41, s56
  buffer_load_dwordx4 v4, s[12:15], s35 offen lds
  s_add_u32 s41, s41, s57
  ds_read_b128 v[24:27], v9 offset:0
  ds_read_b128 v[28:31], v9 offset:4096
  ds_read_b64_tr_b16 v[40:41], v15 offset:0
  ds_read_b64_tr_b16 v[42:43], v15 offset:512
  ds_read_b128 v[32:35], v10 offset:0
  ds_read_b128 v[36:39], v10 offset:4096
  ds_read_b64_tr_b16 v[44:45], v15 offset:2048
  ds_read_b64_tr_b16 v[46:47], v15 offset:2560
  s_waitcnt lgkmcnt(4)
  v_mfma_f32_32x32x16_bf16 a[0:15], v[40:43], v[24:27], a[0:15]
  v_mfma_f32_32x32x16_bf16 a[16:31], v[40:43], v[28:31], a[16:31]
  ds_read_b128 v[24:27], v11 offset:0
  ds_read_b128 v[28:31], v11 offset:4096
  ds_read_b64_tr_b16 v[40:41], v15 offset:4096
  ds_read_b64_tr_b16 v[42:43], v15 offset:4608
  s_waitcnt lgkmcnt(4)
  v_mfma_f32_32x32x16_bf16 a[0:15], v[44:47], v[32:35], a[0:15]
  v_mfma_f32_32x32x16_bf16 a[16:31], v[44:47], v[36:39], a[16:31]
  ds_read_b128 v[32:35], v12 offset:0
  ds_read_b128 v[36:39], v12 offset:4096
  ds_read_b64_tr_b16 v[44:45], v15 offset:6144
  ds_read_b64_tr_b16 v[46:47], v15 offset:6656
  s_waitcnt lgkmcnt(4)
  v_mfma_f32_32x32x16_bf16 a[0:15], v[40:43], v[24:27], a[0:15]
  v_mfma_f32_32x32x16_bf16 a[16:31], v[40:43], v[28:31], a[16:31]
  s_waitcnt lgkmcnt(0)
  v_mfma_f32_32x32x16_bf16 a[0:15], v[44:47], v[32:35], a[0:15]
  v_mfma_f32_32x32x16_bf16 a[16:31], v[44:47], v[36:39], a[16:31]
  s_waitcnt vmcnt(24)
  s_barrier
  s_mul_i32 s34, s18, 4096
  s_add_u32 s34, s34, 73728
  s_add_u32 m0, s34, 0
  s_add_u32 s35, s40, s48
  buffer_load_dwordx4 v2, s[4:7], s35 offen sc1 lds
  s_add_u32 m0, s34, 1024
  s_add_u32 s35, s40, s49
  buffer_load_dwordx4 v3, s[4:7], s35 offen sc1 lds
  s_add_u32 m0, s34, 2048
  s_add_u32 s35, s40, s50
  buffer_load_dwordx4 v2, s[4:7], s35 offen sc1 lds
  s_add_u32 m0, s34, 3072
  s_add_u32 s35, s40, s51
  buffer_load_dwordx4 v3, s[4:7], s35 offen sc1 lds
  s_add_u32 s40, s40, 128
  s_lshl_b32 s34, s18, 11
  s_add_u32 s34, s34, 90112
  s_add_u32 m0, s34, 0
  s_nop 0
  buffer_load_dwordx4 v4, s[12:15], s41 offen lds
  s_add_u32 m0, s34, 1024
  s_add_u32 s35, s41, s56
  buffer_load_dwordx4 v4, s[12:15], s35 offen lds
  s_add_u32 s41, s41, s57
  ds_read_b128 v[24:27], v9 offset:24576
  ds_read_b128 v[28:31], v9 offset:28672
  ds_read_b64_tr_b16 v[40:41], v15 offset:24576
  ds_read_b64_tr_b16 v[42:43], v15 offset:25088
  ds_read_b128 v[32:35], v10 offset:24576
  ds_read_b128 v[36:39], v10 offset:28672
  ds_read_b64_tr_b16 v[44:45], v15 offset:26624
  ds_read_b64_tr_b16 v[46:47], v15 offset:27136
  s_waitcnt lgkmcnt(4)
  v_mfma_f32_32x32x16_bf16 a[0:15], v[40:43], v[24:27], a[0:15]
  v_mfma_f32_32x32x16_bf16 a[16:31], v[40:43], v[28:31], a[16:31]
  ds_read_b128 v[24:27], v11 offset:24576
  ds_read_b128 v[28:31], v11 offset:28672
  ds_read_b64_tr_b16 v[40:41], v15 offset:28672
  ds_read_b64_tr_b16 v[42:43], v15 offset:29184
  s_waitcnt lgkmcnt(4)
  v_mfma_f32_32x32x16_bf16 a[0:15], v[44:47], v[32:35], a[0:15]
  v_mfma_f32_32x32x16_bf16 a[16:31], v[44:47], v[36:39], a[16:31]
  ds_read_b128 v[32:35], v12 offset:24576
  ds_read_b128 v[36:39], v12 offset:28672
  ds_read_b64_tr_b16 v[44:45], v15 offset:30720
  ds_read_b64_tr_b16 v[46:47], v15 offset:31232
  s_waitcnt lgkmcnt(4)
  v_mfma_f32_32x32x16_bf16 a[0:15], v[40:43], v[24:27], a[0:15]
  v_mfma_f32_32x32x16_bf16 a[16:31], v[40:43], v[28:31], a[16:31]
  s_waitcnt lgkmcnt(0)
  v_mfma_f32_32x32x16_bf16 a[0:15], v[44:47], v[32:35], a[0:15]
  v_mfma_f32_32x32x16_bf16 a[16:31], v[44:47], v[36:39], a[16:31]
  s_waitcnt vmcnt(24)
  s_barrier
  s_mul_i32 s34, s18, 4096
  s_add_u32 s34, s34, 98304
  s_add_u32 m0, s34, 0
  s_add_u32 s35, s40, s48
  buffer_load_dwordx4 v2, s[4:7], s35 offen sc1 lds
  s_add_u32 m0, s34, 1024
  s_add_u32 s35, s40, s49
  buffer_load_dwordx4 v3, s[4:7], s35 offen sc1 lds
  s_add_u32 m0, s34, 2048
  s_add_u32 s35, s40, s50
  buffer_load_dwordx4 v2, s[4:7], s35 offen sc1 lds
  s_add_u32 m0, s34, 3072
  s_add_u32 s35, s40, s51
  buffer_load_dwordx4 v3, s[4:7], s35 offen sc1 lds
  s_add_u32 s40, s40, 128
  s_lshl_b32 s34, s18, 11
  s_add_u32 s34, s34, 114688
  s_add_u32 m0, s34, 0
  s_nop 0
  buffer_load_dwordx4 v4, s[12:15], s41 offen lds
  s_add_u32 m0, s34, 1024
  s_add_u32 s35, s41, s56
  buffer_load_dwordx4 v4, s[12:15], s35 offen lds
  s_add_u32 s41, s41, s57
  ds_read_b128 v[24:27], v9 offset:49152
  ds_read_b128 v[28:31], v9 offset:53248
  ds_read_b64_tr_b16 v[40:41], v15 offset:49152
  ds_read_b64_tr_b16 v[42:43], v15 offset:49664
  ds_read_b128 v[32:35], v10 offset:49152
  ds_read_b128 v[36:39], v10 offset:53248
  ds_read_b64_tr_b16 v[44:45], v15 offset:51200
  ds_read_b64_tr_b16 v[46:47], v15 offset:51712
  s_waitcnt lgkmcnt(4)
  v_mfma_f32_32x32x16_bf16 a[0:15], v[40:43], v[24:27], a[0:15]
  v_mfma_f32_32x32x16_bf16 a[16:31], v[40:43], v[28:31], a[16:31]
  ds_read_b128 v[24:27], v11 offset:49152
  ds_read_b128 v[28:31], v11 offset:53248
  ds_read_b64_tr_b16 v[40:41], v15 offset:53248
  ds_read_b64_tr_b16 v[42:43], v15 offset:53760
  s_waitcnt lgkmcnt(4)
  v_mfma_f32_32x32x16_bf16 a[0:15], v[44:47], v[32:35], a[0:15]
  v_mfma_f32_32x32x16_bf16 a[16:31], v[44:47], v[36:39], a[16:31]
  ds_read_b128 v[32:35], v12 offset:49152
  ds_read_b128 v[36:39], v12 offset:53248
  ds_read_b64_tr_b16 v[44:45], v15 offset:55296
  ds_read_b64_tr_b16 v[46:47], v15 offset:55808
  s_waitcnt lgkmcnt(4)
  v_mfma_f32_32x32x16_bf16 a[0:15], v[40:43], v[24:27], a[0:15]
  v_mfma_f32_32x32x16_bf16 a[16:31], v[40:43], v[28:31], a[16:31]
  s_waitcnt lgkmcnt(0)
  v_mfma_f32_32x32x16_bf16 a[0:15], v[44:47], v[32:35], a[0:15]
  v_mfma_f32_32x32x16_bf16 a[16:31], v[44:47], v[36:39], a[16:31]
  s_waitcnt vmcnt(24)
  s_barrier
  ds_read_b128 v[24:27], v5 offset:0
  ds_read_b128 v[28:31], v5 offset:4096
  ds_read_b64_tr_b16 v[40:41], v13 offset:0
  ds_read_b64_tr_b16 v[42:43], v13 offset:512
  ds_read_b128 v[32:35], v6 offset:0
  ds_read_b128 v[36:39], v6 offset:4096
  ds_read_b64_tr_b16 v[44:45], v13 offset:2048
  ds_read_b64_tr_b16 v[46:47], v13 offset:2560
  s_waitcnt lgkmcnt(4)
  v_mfma_f32_32x32x16_bf16 a[0:15], v[40:43], v[24:27], a[0:15]
  v_mfma_f32_32x32x16_bf16 a[16:31], v[40:43], v[28:31], a[16:31]
  ds_read_b128 v[24:27], v7 offset:0
  ds_read_b128 v[28:31], v7 offset:4096
  ds_read_b64_tr_b16 v[40:41], v13 offset:4096
  ds_read_b64_tr_b16 v[42:43], v13 offset:4608
  s_waitcnt lgkmcnt(4)
  v_mfma_f32_32x32x16_bf16 a[0:15], v[44:47], v[32:35], a[0:15]
  v_mfma_f32_32x32x16_bf16 a[16:31], v[44:47], v[36:39], a[16:31]
  ds_read_b128 v[32:35], v8 offset:0
  ds_read_b128 v[36:39], v8 offset:4096
  ds_read_b64_tr_b16 v[44:45], v13 offset:6144
  ds_read_b64_tr_b16 v[46:47], v13 offset:6656
  s_waitcnt lgkmcnt(4)
  v_mfma_f32_32x32x16_bf16 a[0:15], v[40:43], v[24:27], a[0:15]
  v_mfma_f32_32x32x16_bf16 a[16:31], v[40:43], v[28:31], a[16:31]
  s_waitcnt lgkmcnt(0)
  v_mfma_f32_32x32x16_bf16 a[0:15], v[44:47], v[32:35], a[0:15]
  v_mfma_f32_32x32x16_bf16 a[16:31], v[44:47], v[36:39], a[16:31]
  s_waitcnt vmcnt(18)
  s_barrier
  ds_read_b128 v[24:27], v5 offset:24576
  ds_read_b128 v[28:31], v5 offset:28672
  ds_read_b64_tr_b16 v[40:41], v13 offset:24576
  ds_read_b64_tr_b16 v[42:43], v13 offset:25088
  ds_read_b128 v[32:35], v6 offset:24576
  ds_read_b128 v[36:39], v6 offset:28672
  ds_read_b64_tr_b16 v[44:45], v13 offset:26624
  ds_read_b64_tr_b16 v[46:47], v13 offset:27136
  s_waitcnt lgkmcnt(4)
  v_mfma_f32_32x32x16_bf16 a[0:15], v[40:43], v[24:27], a[0:15]
  v_mfma_f32_32x32x16_bf16 a[16:31], v[40:43], v[28:31], a[16:31]
  ds_read_b128 v[24:27], v7 offset:24576
  ds_read_b128 v[28:31], v7 offset:28672
  ds_read_b64_tr_b16 v[40:41], v13 offset:28672
  ds_read_b64_tr_b16 v[42:43], v13 offset:29184
  s_waitcnt lgkmcnt(4)
  v_mfma_f32_32x32x16_bf16 a[0:15], v[44:47], v[32:35], a[0:15]
  v_mfma_f32_32x32x16_bf16 a[16:31], v[44:47], v[36:39], a[16:31]
  ds_read_b128 v[32:35], v8 offset:24576
  ds_read_b128 v[36:39], v8 offset:28672
  ds_read_b64_tr_b16 v[44:45], v13 offset:30720
  ds_read_b64_tr_b16 v[46:47], v13 offset:31232
  s_waitcnt lgkmcnt(4)
  v_mfma_f32_32x32x16_bf16 a[0:15], v[40:43], v[24:27], a[0:15]
  v_mfma_f32_32x32x16_bf16 a[16:31], v[40:43], v[28:31], a[16:31]
  s_waitcnt lgkmcnt(0)
  v_mfma_f32_32x32x16_bf16 a[0:15], v[44:47], v[32:35], a[0:15]
  v_mfma_f32_32x32x16_bf16 a[16:31], v[44:47], v[36:39], a[16:31]
  s_waitcnt vmcnt(12)
  s_barrier
  ds_read_b128 v[24:27], v5 offset:49152
  ds_read_b128 v[28:31], v5 offset:53248
  ds_read_b64_tr_b16 v[40:41], v13 offset:49152
  ds_read_b64_tr_b16 v[42:43], v13 offset:49664
  ds_read_b128 v[32:35], v6 offset:49152
  ds_read_b128 v[36:39], v6 offset:53248
  ds_read_b64_tr_b16 v[44:45], v13 offset:51200
  ds_read_b64_tr_b16 v[46:47], v13 offset:51712
  s_waitcnt lgkmcnt(4)
  v_mfma_f32_32x32x16_bf16 a[0:15], v[40:43], v[24:27], a[0:15]
  v_mfma_f32_32x32x16_bf16 a[16:31], v[40:43], v[28:31], a[16:31]
  ds_read_b128 v[24:27], v7 offset:49152
  ds_read_b128 v[28:31], v7 offset:53248
  ds_read_b64_tr_b16 v[40:41], v13 offset:53248
  ds_read_b64_tr_b16 v[42:43], v13 offset:53760
  s_waitcnt lgkmcnt(4)
  v_mfma_f32_32x32x16_bf16 a[0:15], v[44:47], v[32:35], a[0:15]
  v_mfma_f32_32x32x16_bf16 a[16:31], v[44:47], v[36:39], a[16:31]
  ds_read_b128 v[32:35], v8 offset:49152
  ds_read_b128 v[36:39], v8 offset:53248
  ds_read_b64_tr_b16 v[44:45], v13 offset:55296
  ds_read_b64_tr_b16 v[46:47], v13 offset:55808
  s_waitcnt lgkmcnt(4)
  v_mfma_f32_32x32x16_bf16 a[0:15], v[40:43], v[24:27], a[0:15]
  v_mfma_f32_32x32x16_bf16 a[16:31], v[40:43], v[28:31], a[16:31]
  s_waitcnt lgkmcnt(0)
  v_mfma_f32_32x32x16_bf16 a[0:15], v[44:47], v[32:35], a[0:15]
  v_mfma_f32_32x32x16_bf16 a[16:31], v[44:47], v[36:39], a[16:31]
  s_waitcnt vmcnt(6)
  s_barrier
  ds_read_b128 v[24:27], v9 offset:0
  ds_read_b128 v[28:31], v9 offset:4096
  ds_read_b64_tr_b16 v[40:41], v15 offset:0
  ds_read_b64_tr_b16 v[42:43], v15 offset:512
  ds_read_b128 v[32:35], v10 offset:0
  ds_read_b128 v[36:39], v10 offset:4096
  ds_read_b64_tr_b16 v[44:45], v15 offset:2048
  ds_read_b64_tr_b16 v[46:47], v15 offset:2560
  s_waitcnt lgkmcnt(4)
  v_mfma_f32_32x32x16_bf16 a[0:15], v[40:43], v[24:27], a[0:15]
  v_mfma_f32_32x32x16_bf16 a[16:31], v[40:43], v[28:31], a[16:31]
  ds_read_b128 v[24:27], v11 offset:0
  ds_read_b128 v[28:31], v11 offset:4096
  ds_read_b64_tr_b16 v[40:41], v15 offset:4096
  ds_read_b64_tr_b16 v[42:43], v15 offset:4608
  s_waitcnt lgkmcnt(4)
  v_mfma_f32_32x32x16_bf16 a[0:15], v[44:47], v[32:35], a[0:15]
  v_mfma_f32_32x32x16_bf16 a[16:31], v[44:47], v[36:39], a[16:31]
  ds_read_b128 v[32:35], v12 offset:0
  ds_read_b128 v[36:39], v12 offset:4096
  ds_read_b64_tr_b16 v[44:45], v15 offset:6144
  ds_read_b64_tr_b16 v[46:47], v15 offset:6656
  s_waitcnt lgkmcnt(4)
  v_mfma_f32_32x32x16_bf16 a[0:15], v[40:43], v[24:27], a[0:15]
  v_mfma_f32_32x32x16_bf16 a[16:31], v[40:43], v[28:31], a[16:31]
  s_waitcnt lgkmcnt(0)
  v_mfma_f32_32x32x16_bf16 a[0:15], v[44:47], v[32:35], a[0:15]
  v_mfma_f32_32x32x16_bf16 a[16:31], v[44:47], v[36:39], a[16:31]
  s_waitcnt vmcnt(0)
  s_barrier
  ds_read_b128 v[24:27], v9 offset:24576
  ds_read_b128 v[28:31], v9 offset:28672
  ds_read_b64_tr_b16 v[40:41], v15 offset:24576
  ds_read_b64_tr_b16 v[42:43], v15 offset:25088
  ds_read_b128 v[32:35], v10 offset:24576
  ds_read_b128 v[36:39], v10 offset:28672
  ds_read_b64_tr_b16 v[44:45], v15 offset:26624
  ds_read_b64_tr_b16 v[46:47], v15 offset:27136
  s_waitcnt lgkmcnt(4)
  v_mfma_f32_32x32x16_bf16 a[0:15], v[40:43], v[24:27], a[0:15]
  v_mfma_f32_32x32x16_bf16 a[16:31], v[40:43], v[28:31], a[16:31]
  ds_read_b128 v[24:27], v11 offset:24576
  ds_read_b128 v[28:31], v11 offset:28672
  ds_read_b64_tr_b16 v[40:41], v15 offset:28672
  ds_read_b64_tr_b16 v[42:43], v15 offset:29184
  s_waitcnt lgkmcnt(4)
  v_mfma_f32_32x32x16_bf16 a[0:15], v[44:47], v[32:35], a[0:15]
  v_mfma_f32_32x32x16_bf16 a[16:31], v[44:47], v[36:39], a[16:31]
  ds_read_b128 v[32:35], v12 offset:24576
  ds_read_b128 v[36:39], v12 offset:28672
  ds_read_b64_tr_b16 v[44:45], v15 offset:30720
  ds_read_b64_tr_b16 v[46:47], v15 offset:31232
  s_waitcnt lgkmcnt(4)
  v_mfma_f32_32x32x16_bf16 a[0:15], v[40:43], v[24:27], a[0:15]
  v_mfma_f32_32x32x16_bf16 a[16:31], v[40:43], v[28:31], a[16:31]
  s_waitcnt lgkmcnt(0)
  v_mfma_f32_32x32x16_bf16 a[0:15], v[44:47], v[32:35], a[0:15]
  v_mfma_f32_32x32x16_bf16 a[16:31], v[44:47], v[36:39], a[16:31]
  s_nop 15
  s_barrier
  s_mul_i32 s34, s26, 524288
  s_lshl_b32 s35, s25, 18
  s_add_u32 s34, s34, s35
  s_lshl_b32 s35, s36, 17
  s_add_u32 s34, s34, s35
  s_lshl_b32 s35, s27, 8
  s_add_u32 s34, s34, s35
  s_lshl_b32 s35, s37, 7
  s_add_u32 s34, s34, s35
  s_add_u32 s34, s34, 167772160
  s_mul_i32 s35, s18, 9216
  v_and_b32 v2, 31, v1
  v_mul_u32_u24 v2, 144, v2
  v_lshrrev_b32 v3, 5, v1
  v_lshl_add_u32 v2, v3, 4, v2
  v_add_u32 v2, s35, v2
  v_lshrrev_b32 v3, 3, v1
  v_and_b32 v4, 7, v1
  v_mul_u32_u24 v5, 144, v3
  v_lshl_add_u32 v5, v4, 4, v5
  v_add_u32 v5, s35, v5
  v_lshlrev_b32 v6, 11, v3
  v_lshl_add_u32 v6, v4, 4, v6
  v_add_u32 v6, s34, v6

  ds_write_b128 v2, a[0:3] offset:0
  ds_write_b128 v2, a[4:7] offset:32
  ds_write_b128 v2, a[8:11] offset:64
  ds_write_b128 v2, a[12:15] offset:96
  ds_write_b128 v2, a[16:19] offset:4608
  ds_write_b128 v2, a[20:23] offset:4640
  ds_write_b128 v2, a[24:27] offset:4672
  ds_write_b128 v2, a[28:31] offset:4704
  s_waitcnt lgkmcnt(0)
  ds_read_b128 v[8:11], v5 offset:0
  ds_read_b128 v[12:15], v5 offset:1152
  ds_read_b128 v[16:19], v5 offset:2304
  ds_read_b128 v[20:23], v5 offset:3456
  ds_read_b128 v[24:27], v5 offset:4608
  ds_read_b128 v[28:31], v5 offset:5760
  ds_read_b128 v[32:35], v5 offset:6912
  ds_read_b128 v[36:39], v5 offset:8064
  s_waitcnt lgkmcnt(7)
  s_mov_b32 s35, 0
  buffer_store_dwordx4 v[8:11], v6, s[4:7], s35 offen sc1
  s_waitcnt lgkmcnt(6)
  s_mov_b32 s35, 16384
  buffer_store_dwordx4 v[12:15], v6, s[4:7], s35 offen sc1
  s_waitcnt lgkmcnt(5)
  s_mov_b32 s35, 32768
  buffer_store_dwordx4 v[16:19], v6, s[4:7], s35 offen sc1
  s_waitcnt lgkmcnt(4)
  s_mov_b32 s35, 49152
  buffer_store_dwordx4 v[20:23], v6, s[4:7], s35 offen sc1
  s_waitcnt lgkmcnt(3)
  s_mov_b32 s35, 65536
  buffer_store_dwordx4 v[24:27], v6, s[4:7], s35 offen sc1
  s_waitcnt lgkmcnt(2)
  s_mov_b32 s35, 81920
  buffer_store_dwordx4 v[28:31], v6, s[4:7], s35 offen sc1
  s_waitcnt lgkmcnt(1)
  s_mov_b32 s35, 98304
  buffer_store_dwordx4 v[32:35], v6, s[4:7], s35 offen sc1
  s_waitcnt lgkmcnt(0)
  s_mov_b32 s35, 114688
  buffer_store_dwordx4 v[36:39], v6, s[4:7], s35 offen sc1
  s_waitcnt vmcnt(0)
  s_barrier
  s_cmp_lg_u32 s18, 0
  s_cbranch_scc1 L_sig_61
  s_lshl_b32 s60, s26, 8
  s_lshl_b32 s61, s23, 2
  s_add_u32 s60, s60, s61
  s_add_u32 s60, s60, 98713600
  v_mov_b32 v2, s60
  v_mov_b32 v3, s69
  s_mov_b64 exec, 1
  buffer_store_dword v3, v2, s[4:7], 0 offen sc1
  s_mov_b64 exec, -1

L_sig_61:
  s_branch L_worker
L_task_fin:
  s_mov_b32 s23, s27
  s_cmp_lg_u32 s18, 0
  s_cbranch_scc1 L_wo_63
  s_lshl_b32 s60, s26, 8
  s_add_u32 s60, s60, 98713600
  v_lshlrev_b32 v2, 2, v1
  v_add_u32 v2, s60, v2
  s_mov_b32 s62, 0

  s_mov_b64 exec, 0xffff
L_wt_62:
  buffer_load_dword v3, v2, s[4:7], 0 offen sc1
  s_waitcnt vmcnt(0)
  v_cmp_ne_u32 vcc, s69, v3
  s_cbranch_vccz L_wo_63
  s_sleep 1
  s_add_u32 s62, s62, 1
  s_cmp_lt_u32 s62, 0x100000
  s_cbranch_scc1 L_wt_62

L_wo_63:
  s_mov_b64 exec, -1
  s_barrier
  s_mov_b32 s8, s94
  s_mov_b32 s9, s95
  s_mov_b32 s10, 2097152
  s_mov_b32 s11, 0x00020000
  s_lshl_b32 s34, s27, 4
  s_lshl_b32 s35, s18, 2
  s_add_u32 s34, s34, s35
  s_lshl_b32 s35, s26, 7
  s_add_u32 s35, s35, s34
  s_lshl_b32 s35, s35, 10
  v_lshlrev_b32 v2, 4, v1
  v_add_u32 v2, s35, v2
  v_add_u32 v3, 79691776, v2
  s_lshl_b32 s35, s26, 19
  s_lshl_b32 s34, s34, 11
  s_add_u32 s34, s34, s35
  s_add_u32 s34, s34, 167772160
  v_lshlrev_b32 v4, 5, v1
  v_add_u32 v4, s34, v4
  v_add_u32 v5, 262144, v4

  buffer_load_dwordx4 v[16:19], v4, s[4:7], 0 offen offset:0 sc1
  buffer_load_dwordx4 v[20:23], v4, s[4:7], 0 offen offset:16 sc1
  buffer_load_dwordx4 v[24:27], v5, s[4:7], 0 offen offset:0 sc1
  buffer_load_dwordx4 v[28:31], v5, s[4:7], 0 offen offset:16 sc1
  buffer_load_dwordx4 v[32:35], v3, s[4:7], 0 offen offset:0 sc1
  buffer_load_dwordx4 v[36:39], v4, s[4:7], 0 offen offset:2048 sc1
  buffer_load_dwordx4 v[40:43], v4, s[4:7], 0 offen offset:2064 sc1
  buffer_load_dwordx4 v[44:47], v5, s[4:7], 0 offen offset:2048 sc1
  buffer_load_dwordx4 v[48:51], v5, s[4:7], 0 offen offset:2064 sc1
  buffer_load_dwordx4 v[52:55], v3, s[4:7], 0 offen offset:1024 sc1
  v_add_u32 v6, 4096, v4
  v_add_u32 v7, 4096, v5
  buffer_load_dwordx4 v[56:59], v6, s[4:7], 0 offen offset:0 sc1
  buffer_load_dwordx4 v[60:63], v6, s[4:7], 0 offen offset:16 sc1
  buffer_load_dwordx4 v[64:67], v7, s[4:7], 0 offen offset:0 sc1
  buffer_load_dwordx4 v[68:71], v7, s[4:7], 0 offen offset:16 sc1
  buffer_load_dwordx4 v[72:75], v3, s[4:7], 0 offen offset:2048 sc1
  buffer_load_dwordx4 v[76:79], v6, s[4:7], 0 offen offset:2048 sc1
  buffer_load_dwordx4 v[80:83], v6, s[4:7], 0 offen offset:2064 sc1
  buffer_load_dwordx4 v[84:87], v7, s[4:7], 0 offen offset:2048 sc1
  buffer_load_dwordx4 v[88:91], v7, s[4:7], 0 offen offset:2064 sc1
  buffer_load_dwordx4 v[92:95], v3, s[4:7], 0 offen offset:3072 sc1
  s_waitcnt vmcnt(15)
  v_add_f32 v16, v16, v24
  v_cvt_pk_bf16_f32 v16, v16, v16
  v_lshlrev_b32 v16, 16, v16
  v_add_f32 v17, v17, v25
  v_cvt_pk_bf16_f32 v17, v17, v17
  v_lshlrev_b32 v17, 16, v17
  v_add_f32 v18, v18, v26
  v_cvt_pk_bf16_f32 v18, v18, v18
  v_lshlrev_b32 v18, 16, v18
  v_add_f32 v19, v19, v27
  v_cvt_pk_bf16_f32 v19, v19, v19
  v_lshlrev_b32 v19, 16, v19
  v_add_f32 v20, v20, v28
  v_cvt_pk_bf16_f32 v20, v20, v20
  v_lshlrev_b32 v20, 16, v20
  v_add_f32 v21, v21, v29
  v_cvt_pk_bf16_f32 v21, v21, v21
  v_lshlrev_b32 v21, 16, v21
  v_add_f32 v22, v22, v30
  v_cvt_pk_bf16_f32 v22, v22, v22
  v_lshlrev_b32 v22, 16, v22
  v_add_f32 v23, v23, v31
  v_cvt_pk_bf16_f32 v23, v23, v23
  v_lshlrev_b32 v23, 16, v23
  v_lshlrev_b32 v8, 16, v32
  v_and_b32 v9, 0xffff0000, v32
  v_add_f32 v8, v8, v16
  v_add_f32 v9, v9, v17
  v_cvt_pk_bf16_f32 v32, v8, v9
  v_lshlrev_b32 v8, 16, v33
  v_and_b32 v9, 0xffff0000, v33
  v_add_f32 v8, v8, v18
  v_add_f32 v9, v9, v19
  v_cvt_pk_bf16_f32 v33, v8, v9
  v_lshlrev_b32 v8, 16, v34
  v_and_b32 v9, 0xffff0000, v34
  v_add_f32 v8, v8, v20
  v_add_f32 v9, v9, v21
  v_cvt_pk_bf16_f32 v34, v8, v9
  v_lshlrev_b32 v8, 16, v35
  v_and_b32 v9, 0xffff0000, v35
  v_add_f32 v8, v8, v22
  v_add_f32 v9, v9, v23
  v_cvt_pk_bf16_f32 v35, v8, v9
  buffer_store_dwordx4 v[32:35], v2, s[8:11], 0 offen offset:0
  s_waitcnt vmcnt(11)
  v_add_f32 v36, v36, v44
  v_cvt_pk_bf16_f32 v36, v36, v36
  v_lshlrev_b32 v36, 16, v36
  v_add_f32 v37, v37, v45
  v_cvt_pk_bf16_f32 v37, v37, v37
  v_lshlrev_b32 v37, 16, v37
  v_add_f32 v38, v38, v46
  v_cvt_pk_bf16_f32 v38, v38, v38
  v_lshlrev_b32 v38, 16, v38
  v_add_f32 v39, v39, v47
  v_cvt_pk_bf16_f32 v39, v39, v39
  v_lshlrev_b32 v39, 16, v39
  v_add_f32 v40, v40, v48
  v_cvt_pk_bf16_f32 v40, v40, v40
  v_lshlrev_b32 v40, 16, v40
  v_add_f32 v41, v41, v49
  v_cvt_pk_bf16_f32 v41, v41, v41
  v_lshlrev_b32 v41, 16, v41
  v_add_f32 v42, v42, v50
  v_cvt_pk_bf16_f32 v42, v42, v42
  v_lshlrev_b32 v42, 16, v42
  v_add_f32 v43, v43, v51
  v_cvt_pk_bf16_f32 v43, v43, v43
  v_lshlrev_b32 v43, 16, v43
  v_lshlrev_b32 v8, 16, v52
  v_and_b32 v9, 0xffff0000, v52
  v_add_f32 v8, v8, v36
  v_add_f32 v9, v9, v37
  v_cvt_pk_bf16_f32 v52, v8, v9
  v_lshlrev_b32 v8, 16, v53
  v_and_b32 v9, 0xffff0000, v53
  v_add_f32 v8, v8, v38
  v_add_f32 v9, v9, v39
  v_cvt_pk_bf16_f32 v53, v8, v9
  v_lshlrev_b32 v8, 16, v54
  v_and_b32 v9, 0xffff0000, v54
  v_add_f32 v8, v8, v40
  v_add_f32 v9, v9, v41
  v_cvt_pk_bf16_f32 v54, v8, v9
  v_lshlrev_b32 v8, 16, v55
  v_and_b32 v9, 0xffff0000, v55
  v_add_f32 v8, v8, v42
  v_add_f32 v9, v9, v43
  v_cvt_pk_bf16_f32 v55, v8, v9
  buffer_store_dwordx4 v[52:55], v2, s[8:11], 0 offen offset:1024
  s_waitcnt vmcnt(7)
  v_add_f32 v56, v56, v64
  v_cvt_pk_bf16_f32 v56, v56, v56
  v_lshlrev_b32 v56, 16, v56
  v_add_f32 v57, v57, v65
  v_cvt_pk_bf16_f32 v57, v57, v57
  v_lshlrev_b32 v57, 16, v57
  v_add_f32 v58, v58, v66
  v_cvt_pk_bf16_f32 v58, v58, v58
  v_lshlrev_b32 v58, 16, v58
  v_add_f32 v59, v59, v67
  v_cvt_pk_bf16_f32 v59, v59, v59
  v_lshlrev_b32 v59, 16, v59
  v_add_f32 v60, v60, v68
  v_cvt_pk_bf16_f32 v60, v60, v60
  v_lshlrev_b32 v60, 16, v60
  v_add_f32 v61, v61, v69
  v_cvt_pk_bf16_f32 v61, v61, v61
  v_lshlrev_b32 v61, 16, v61
  v_add_f32 v62, v62, v70
  v_cvt_pk_bf16_f32 v62, v62, v62
  v_lshlrev_b32 v62, 16, v62
  v_add_f32 v63, v63, v71
  v_cvt_pk_bf16_f32 v63, v63, v63
  v_lshlrev_b32 v63, 16, v63
  v_lshlrev_b32 v8, 16, v72
  v_and_b32 v9, 0xffff0000, v72
  v_add_f32 v8, v8, v56
  v_add_f32 v9, v9, v57
  v_cvt_pk_bf16_f32 v72, v8, v9
  v_lshlrev_b32 v8, 16, v73
  v_and_b32 v9, 0xffff0000, v73
  v_add_f32 v8, v8, v58
  v_add_f32 v9, v9, v59
  v_cvt_pk_bf16_f32 v73, v8, v9
  v_lshlrev_b32 v8, 16, v74
  v_and_b32 v9, 0xffff0000, v74
  v_add_f32 v8, v8, v60
  v_add_f32 v9, v9, v61
  v_cvt_pk_bf16_f32 v74, v8, v9
  v_lshlrev_b32 v8, 16, v75
  v_and_b32 v9, 0xffff0000, v75
  v_add_f32 v8, v8, v62
  v_add_f32 v9, v9, v63
  v_cvt_pk_bf16_f32 v75, v8, v9
  buffer_store_dwordx4 v[72:75], v2, s[8:11], 0 offen offset:2048
  s_waitcnt vmcnt(3)
  v_add_f32 v76, v76, v84
  v_cvt_pk_bf16_f32 v76, v76, v76
  v_lshlrev_b32 v76, 16, v76
  v_add_f32 v77, v77, v85
  v_cvt_pk_bf16_f32 v77, v77, v77
  v_lshlrev_b32 v77, 16, v77
  v_add_f32 v78, v78, v86
  v_cvt_pk_bf16_f32 v78, v78, v78
  v_lshlrev_b32 v78, 16, v78
  v_add_f32 v79, v79, v87
  v_cvt_pk_bf16_f32 v79, v79, v79
  v_lshlrev_b32 v79, 16, v79
  v_add_f32 v80, v80, v88
  v_cvt_pk_bf16_f32 v80, v80, v80
  v_lshlrev_b32 v80, 16, v80
  v_add_f32 v81, v81, v89
  v_cvt_pk_bf16_f32 v81, v81, v81
  v_lshlrev_b32 v81, 16, v81
  v_add_f32 v82, v82, v90
  v_cvt_pk_bf16_f32 v82, v82, v82
  v_lshlrev_b32 v82, 16, v82
  v_add_f32 v83, v83, v91
  v_cvt_pk_bf16_f32 v83, v83, v83
  v_lshlrev_b32 v83, 16, v83
  v_lshlrev_b32 v8, 16, v92
  v_and_b32 v9, 0xffff0000, v92
  v_add_f32 v8, v8, v76
  v_add_f32 v9, v9, v77
  v_cvt_pk_bf16_f32 v92, v8, v9
  v_lshlrev_b32 v8, 16, v93
  v_and_b32 v9, 0xffff0000, v93
  v_add_f32 v8, v8, v78
  v_add_f32 v9, v9, v79
  v_cvt_pk_bf16_f32 v93, v8, v9
  v_lshlrev_b32 v8, 16, v94
  v_and_b32 v9, 0xffff0000, v94
  v_add_f32 v8, v8, v80
  v_add_f32 v9, v9, v81
  v_cvt_pk_bf16_f32 v94, v8, v9
  v_lshlrev_b32 v8, 16, v95
  v_and_b32 v9, 0xffff0000, v95
  v_add_f32 v8, v8, v82
  v_add_f32 v9, v9, v83
  v_cvt_pk_bf16_f32 v95, v8, v9
  buffer_store_dwordx4 v[92:95], v2, s[8:11], 0 offen offset:3072
  s_waitcnt vmcnt(0)
  s_barrier
  s_branch L_worker
L_rec_end:
  s_endpgm
.section .rodata,"a"
.p2align 6
.amdhsa_kernel sequential_preLN__memory_aug_recurrent_mem_tr__glu_gated_geglu__prompt_kernel
  .amdhsa_next_free_vgpr 512
  .amdhsa_next_free_sgpr 102
  .amdhsa_accum_offset 256
  .amdhsa_group_segment_fixed_size 0
  .amdhsa_kernarg_size 112
  .amdhsa_user_sgpr_count 2
  .amdhsa_user_sgpr_kernarg_segment_ptr 1
  .amdhsa_system_sgpr_workgroup_id_x 1
.end_amdhsa_kernel
```
